```python
import torch

def _softmax(x, axis=-1):
    return torch.softmax(x, dim=axis)
def _gelu(x):
    return torch.nn.functional.gelu(x, approximate="tanh")
def _silu(x):
    return torch.nn.functional.silu(x)
def _sigmoid(x):
    return torch.sigmoid(x)
def _layernorm(x, axis=-1, eps=1e-5):
    m = x.mean(dim=axis, keepdim=True)
    v = x.var(dim=axis, keepdim=True, unbiased=False)
    return (x - m) / torch.sqrt(v + eps)
def _scatter_add(tgt, idx, src, axis=0):
    return tgt.clone().index_add_(axis, idx, src)
def _segment_sum(src, seg, n):
    out = torch.zeros((n,) + src.shape[1:], dtype=src.dtype)
    return out.index_add_(0, seg, src)
def _pad(x, pw):
    flat = tuple(v for pair in reversed(pw) for v in pair)
    return torch.nn.functional.pad(x, flat)

kernel_name = 'sequential_preLN__sliding_local_dilated__mixer_s_mlp__prompt'

def setup_inputs():

    _w = (lambda a: (lambda t: t.to(torch.bfloat16) if t.is_floating_point() else t)(torch.as_tensor(a)))
    def _A_setup():
        B, S, D = 1, 2048, 640
        return {
            "x": _w((lambda *s: torch.randn(*s, dtype=torch.bfloat16) * 0.05)(B, S, D)),
            "wqkv": _w((lambda *s: torch.randn(*s, dtype=torch.bfloat16) * 0.05)(D, 3 * D)),
            "wo": _w((lambda *s: torch.randn(*s, dtype=torch.bfloat16) * 0.05)(D, D)),
        }
    _A_in = _A_setup()

    def _B_setup():
        B, S, D, F = 1, 2048, 640, 1728
        return {
            "x":  _w((lambda *s: torch.randn(*s, dtype=torch.bfloat16) * 0.05)(B, S, D)),
            "w1": _w((lambda *s: torch.randn(*s, dtype=torch.bfloat16) * 3.2)(D, D) * (D ** -0.5)),
            "w2": _w((lambda *s: torch.randn(*s, dtype=torch.bfloat16) * 3.2)(D, D) * (D ** -0.5)),
            "w3": _w((lambda *s: torch.randn(*s, dtype=torch.bfloat16) * 3.2)(D, F) * (D ** -0.5)),
            "w4": _w((lambda *s: torch.randn(*s, dtype=torch.bfloat16) * 1.6)(F, D) * (F ** -0.5)),
        }
    _B_in = _B_setup()

    return {
        "A_x": _A_in["x"],
        "A_wqkv": _A_in["wqkv"],
        "A_wo": _A_in["wo"],
        "B_x": _B_in["x"],
        "B_w1": _B_in["w1"],
        "B_w2": _B_in["w2"],
        "B_w3": _B_in["w3"],
        "B_w4": _B_in["w4"],
    }

def reference(A_x, A_wqkv, A_wo, B_x, B_w1, B_w2, B_w3, B_w4):
    def _A_ref(x, wqkv, wo):
        B, S, D = x.shape
        H = 32; Dh = D // H
        W, dil = 8, 2
        qkv = (lambda x, *d: x.permute(*d))((x @ wqkv).reshape(B, S, 3, H, Dh), 2, 0, 3, 1, 4)
        q, k, v = qkv[0], qkv[1], qkv[2]
        scale = Dh ** -0.5
        pos = torch.arange(S)
        off = torch.arange(W) * dil
        idx = pos[:, None] - off[None, :]
        mask = idx >= 0
        idx_c = torch.where(mask, idx, 0).reshape(-1)
        kg = k[:, :, idx_c, :].reshape(B, H, S, W, Dh)
        vg = v[:, :, idx_c, :].reshape(B, H, S, W, Dh)
        logits = torch.einsum("bhsd,bhswd->bhsw", q, kg) * scale
        logits = torch.where(mask[None, None, :, :], logits, -1e9)
        attn = _softmax(logits, axis=-1)
        o = torch.einsum("bhsw,bhswd->bhsd", attn, vg)
        return (lambda x, *d: x.permute(*d))(o, 0, 2, 1, 3).reshape(B, S, D) @ wo

    def _B_ref(x, w1, w2, w3, w4):
        B, S, D = x.shape
        h = _gelu(_layernorm(x, axis=-1) @ w1)
        c = D // 4
        g0 = _pad(h[:, :, 0*c:1*c], ((0, 0), (1, 0), (0, 0)))[:, :S, :]
        g1 = _pad(h[:, :, 1*c:2*c], ((0, 0), (0, 1), (0, 0)))[:, 1:, :]
        g2 = _pad(h[:, :, 2*c:3*c], ((0, 0), (2, 0), (0, 0)))[:, :S, :]
        g3 = _pad(h[:, :, 3*c:   ], ((0, 0), (0, 2), (0, 0)))[:, 2:, :]
        hs = torch.concatenate([g0, g1, g2, g3], axis=-1) @ w2
        x1 = x + hs
        h2 = _gelu(_layernorm(x1, axis=-1) @ w3) @ w4
        return x1 + h2

    x = A_x
    h = x + _A_ref(_layernorm(x, axis=-1), A_wqkv, A_wo)
    h2 = h + _B_ref(_layernorm(h, axis=-1), B_w1, B_w2, B_w3, B_w4)
    return h2
```

```asm
; @launch grid=(256,1,1) block=(512,1,1) lds=163840
.amdgcn_target "amdgcn-amd-amdhsa--gfx950"
.text
.globl sequential_preLN__sliding_local_dilated__mixer_s_mlp__prompt_kernel
.p2align 8
.type sequential_preLN__sliding_local_dilated__mixer_s_mlp__prompt_kernel,@function
sequential_preLN__sliding_local_dilated__mixer_s_mlp__prompt_kernel:
    s_load_dwordx16 s[16:31], s[0:1], 0
    s_load_dwordx4 s[32:35], s[0:1], 64
    s_load_dwordx2 s[36:37], s[0:1], 80
    s_cmp_ge_u32 s2, 256
    s_cbranch_scc1 L_end
    s_and_b32 s38, s2, 7
    s_lshr_b32 s39, s2, 3
    v_lshrrev_b32 v1, 6, v0
    s_nop 0
    v_readfirstlane_b32 s40, v1
    v_and_b32 v0, 63, v0
    v_lshrrev_b32 v1, 4, v0
    v_and_b32 v2, 15, v0
    s_mul_i32 s43, s39, 26
    s_lshr_b32 s43, s43, 8
    s_mul_i32 s3, s43, 10
    s_sub_u32 s44, s39, s3
    s_mul_i32 s56, s43, 6
    s_cmp_eq_u32 s43, 2
    s_cselect_b32 s42, 11, s56
    s_and_b32 s45, s40, 1
    s_cmp_lt_u32 s40, 4
    s_cbranch_scc1 L_compute
    s_mul_i32 s3, s43, 7
    s_lshr_b32 s3, s3, 1
    s_add_u32 s3, s3, s38
    s_cmp_ge_u32 s3, 10
    s_cselect_b32 s52, 10, 0
    s_sub_u32 s56, s3, s52
    s_mul_i32 s56, s38, 5
    s_lshr_b32 s56, s56, 2
    s_cmp_ge_u32 s39, 30
    s_cbranch_scc1 L_hidle
    s_cmp_lt_u32 s40, 6
    s_cbranch_scc1 L_hA
    v_lshrrev_b32 v3, 3, v0
    v_and_b32 v4, 2, v3
    s_lshl_b32 s3, s45, 2
    v_or_b32 v4, s3, v4
    v_and_b32 v5, 7, v0
    v_xor_b32 v4, v4, v5
    v_lshlrev_b32 v4, 4, v4
    s_lshl_b32 s3, s45, 3
    v_add_u32 v5, s3, v3
    v_mul_u32_u24 v5, 3840, v5
    s_lshl_b32 s3, s44, 7
    v_add3_u32 v8, v4, v5, s3
    s_mul_i32 s54, s56, 245760
    s_lshl_b32 s55, s45, 10
    s_add_u32 s55, s55, 14336
    s_waitcnt lgkmcnt(0)
    s_mov_b32 s12, s18
    s_mov_b32 s13, s19
    s_mov_b32 s14, 2457600
    s_mov_b32 s15, 0x20000
    s_mov_b32 s49, 0
L_hBloop:
    s_add_u32 m0, s55, 0
    s_add_u32 s3, s54, 0
    buffer_load_dwordx4 v8, s[12:15], s3 offen  lds
    s_add_u32 m0, s55, 8192
    s_add_u32 s3, s54, 1280
    buffer_load_dwordx4 v8, s[12:15], s3 offen  lds
    s_add_u32 m0, s55, 16384
    s_add_u32 s3, s54, 2560
    buffer_load_dwordx4 v8, s[12:15], s3 offen  lds
    s_add_u32 m0, s55, 2048
    s_add_u32 s3, s54, 61440
    buffer_load_dwordx4 v8, s[12:15], s3 offen  lds
    s_add_u32 m0, s55, 10240
    s_add_u32 s3, s54, 62720
    buffer_load_dwordx4 v8, s[12:15], s3 offen  lds
    s_add_u32 m0, s55, 18432
    s_add_u32 s3, s54, 64000
    buffer_load_dwordx4 v8, s[12:15], s3 offen  lds
    s_add_u32 m0, s55, 4096
    s_add_u32 s3, s54, 122880
    buffer_load_dwordx4 v8, s[12:15], s3 offen  lds
    s_add_u32 m0, s55, 12288
    s_add_u32 s3, s54, 124160
    buffer_load_dwordx4 v8, s[12:15], s3 offen  lds
    s_add_u32 m0, s55, 20480
    s_add_u32 s3, s54, 125440
    buffer_load_dwordx4 v8, s[12:15], s3 offen  lds
    s_add_u32 m0, s55, 6144
    s_add_u32 s3, s54, 184320
    buffer_load_dwordx4 v8, s[12:15], s3 offen  lds
    s_add_u32 m0, s55, 14336
    s_add_u32 s3, s54, 185600
    buffer_load_dwordx4 v8, s[12:15], s3 offen  lds
    s_add_u32 m0, s55, 22528
    s_add_u32 s3, s54, 186880
    buffer_load_dwordx4 v8, s[12:15], s3 offen  lds
    s_add_u32 s54, s54, 245760
    s_cmp_eq_u32 s54, 2457600
    s_cmov_b32 s54, 0
    s_add_u32 s55, s55, 38912
    s_cmp_ge_u32 s55, 116736
    s_cselect_b32 s3, 116736, 0
    s_sub_u32 s55, s55, s3
    s_add_u32 s49, s49, 1
    s_cmp_eq_u32 s49, 1
    s_cbranch_scc1 L_hBloop
    s_cmp_eq_u32 s49, 10
    s_cbranch_scc1 L_hBout
    s_waitcnt vmcnt(12)
    s_barrier
    s_branch L_hBloop
L_hBout:
    s_cmp_ge_u32 s39, 14
    s_cselect_b32 s47, 1, 0
    s_mul_i32 s3, s47, 14
    s_sub_u32 s48, s39, s3
    v_lshrrev_b32 v3, 3, v0
    v_and_b32 v4, 6, v3
    v_and_b32 v5, 7, v0
    v_xor_b32 v4, v4, v5
    v_lshlrev_b32 v4, 4, v4
    s_lshl_b32 s3, s44, 7
    v_add_u32 v4, s3, v4
    v_mul_u32_u24 v9, 1280, v3
    v_add_u32 v9, v9, v4
    s_lshl_b32 s3, s45, 2
    v_add_u32 v3, s3, v1
    v_lshlrev_b32 v4, 1, v3
    v_xor_b32 v4, v4, v2
    v_lshlrev_b32 v4, 4, v4
    v_mul_u32_u24 v11, 3456, v1
    v_add_u32 v11, v11, v4
    s_lshl_b32 s3, s48, 8
    v_add_u32 v11, s3, v11
    v_add_u32 v4, s3, v4
    v_mov_b32 v5, 1073741824
    v_cmp_gt_u32 vcc, 3456, v4
    s_nop 1
    v_cndmask_b32 v11, v5, v11, vcc
    s_waitcnt vmcnt(12)
    s_barrier
    s_mov_b32 s12, s20
    s_mov_b32 s13, s21
    s_mov_b32 s14, 819200
    s_mov_b32 s15, 0x20000
    s_lshl_b32 s55, s45, 10
    s_add_u32 s55, s55, 147456
    s_mul_i32 s54, s45, 10240
    s_add_u32 s54, s54, 655360
    s_mov_b32 s49, 2
L_dm_1:
    s_add_u32 m0, s55, 0
    s_add_u32 s3, s54, 0
    buffer_load_dwordx4 v9, s[12:15], s3 offen  lds
    s_add_u32 m0, s55, 2048
    s_add_u32 s3, s54, 20480
    buffer_load_dwordx4 v9, s[12:15], s3 offen  lds
    s_add_u32 m0, s55, 4096
    s_add_u32 s3, s54, 40960
    buffer_load_dwordx4 v9, s[12:15], s3 offen  lds
    s_add_u32 m0, s55, 6144
    s_add_u32 s3, s54, 61440
    buffer_load_dwordx4 v9, s[12:15], s3 offen  lds
    s_add_u32 s55, s55, 8192
    s_add_u32 s54, s54, 81920
    s_sub_u32 s49, s49, 1
    s_cmp_lg_u32 s49, 0
    s_cbranch_scc1 L_dm_1
    s_waitcnt vmcnt(8)
    s_barrier
    s_mov_b32 s12, s20
    s_mov_b32 s13, s21
    s_mov_b32 s14, 819200
    s_mov_b32 s15, 0x20000
    s_lshl_b32 s55, s45, 10
    s_add_u32 s55, s55, 131072
    s_mul_i32 s54, s45, 10240
    s_add_u32 s54, s54, 491520
    s_mov_b32 s49, 2
L_dm_2:
    s_add_u32 m0, s55, 0
    s_add_u32 s3, s54, 0
    buffer_load_dwordx4 v9, s[12:15], s3 offen  lds
    s_add_u32 m0, s55, 2048
    s_add_u32 s3, s54, 20480
    buffer_load_dwordx4 v9, s[12:15], s3 offen  lds
    s_add_u32 m0, s55, 4096
    s_add_u32 s3, s54, 40960
    buffer_load_dwordx4 v9, s[12:15], s3 offen  lds
    s_add_u32 m0, s55, 6144
    s_add_u32 s3, s54, 61440
    buffer_load_dwordx4 v9, s[12:15], s3 offen  lds
    s_add_u32 s55, s55, 8192
    s_add_u32 s54, s54, 81920
    s_sub_u32 s49, s49, 1
    s_cmp_lg_u32 s49, 0
    s_cbranch_scc1 L_dm_2
    s_barrier
    s_mov_b32 s12, s20
    s_mov_b32 s13, s21
    s_mov_b32 s14, 819200
    s_mov_b32 s15, 0x20000
    s_lshl_b32 s55, s45, 10
    s_add_u32 s55, s55, 81920
    s_mul_i32 s54, s45, 10240
    s_add_u32 s54, s54, 0
    s_mov_b32 s49, 3
L_dm_3:
    s_add_u32 m0, s55, 0
    s_add_u32 s3, s54, 0
    buffer_load_dwordx4 v9, s[12:15], s3 offen  lds
    s_add_u32 m0, s55, 2048
    s_add_u32 s3, s54, 20480
    buffer_load_dwordx4 v9, s[12:15], s3 offen  lds
    s_add_u32 m0, s55, 4096
    s_add_u32 s3, s54, 40960
    buffer_load_dwordx4 v9, s[12:15], s3 offen  lds
    s_add_u32 m0, s55, 6144
    s_add_u32 s3, s54, 61440
    buffer_load_dwordx4 v9, s[12:15], s3 offen  lds
    s_add_u32 s55, s55, 8192
    s_add_u32 s54, s54, 81920
    s_sub_u32 s49, s49, 1
    s_cmp_lg_u32 s49, 0
    s_cbranch_scc1 L_dm_3
    s_lshl_b32 s3, s38, 22
    s_add_u32 s4, s36, s3
    s_addc_u32 s5, s37, 0
    s_mov_b32 s6, 4194304
    s_mov_b32 s7, 0x20000
    s_lshl_b32 s62, s40, 2
    s_lshr_b32 s62, 0x21303210, s62
    s_and_b32 s62, s62, 3
    s_lshr_b32 s63, s40, 2
    s_cmp_ge_u32 s44, 5
    s_cselect_b32 s3, 5, 0
    s_sub_u32 s3, s44, s3
    s_sub_u32 s52, 5, s3
    s_mul_i32 s3, s62, 5
    s_add_u32 s3, s3, s52
    s_sub_u32 s53, s3, 5
    s_min_u32 s3, s3, 16
    s_cmp_eq_u32 s62, 0
    s_cselect_b32 s53, 0, s53
    s_sub_u32 s41, s3, s53
    v_add_u32 v40, s53, v1
    v_mul_u32_u24 v100, 896, v40
    v_mov_b32 v42, 45056
    v_cmp_gt_u32 vcc, s41, v1
    v_add_u32 v102, 14336, v100
    s_nop 0
    v_cndmask_b32 v100, v42, v100, vcc
    v_cndmask_b32 v102, v42, v102, vcc
    v_lshl_add_u32 v100, v2, 3, v100
    v_lshl_add_u32 v102, v2, 3, v102
    v_mov_b32 v43, 1073741824
    s_lshl_b32 s3, s44, 4
    v_add_u32 v40, s3, v40
    s_mul_i32 s61, s63, 3
    s_add_u32 s61, s61, s42
    s_lshl_b32 s61, s61, 8
    s_add_u32 s61, s61, 16384
    v_lshrrev_b32 v44, 3, v40
    v_lshlrev_b32 v44, 2, v44
    v_and_or_b32 v44, v40, 3, v44
    v_mul_u32_u24 v44, 4608, v44
    v_and_b32 v45, 4, v40
    v_lshl_add_u32 v44, v45, 1, v44
    v_lshl_add_u32 v44, v2, 4, v44
    v_add_u32 v44, s61, v44
    v_cndmask_b32 v156, v43, v44, vcc
    s_cmp_eq_u32 s41, 5
    s_cselect_b32 s3, 16, 0
    v_cmp_gt_u32 vcc, s3, v0
    v_add_u32 v40, 4, v40
    v_lshrrev_b32 v44, 3, v40
    v_lshlrev_b32 v44, 2, v44
    v_and_or_b32 v44, v40, 3, v44
    v_mul_u32_u24 v44, 4608, v44
    v_and_b32 v45, 4, v40
    v_lshl_add_u32 v44, v45, 1, v44
    v_lshl_add_u32 v44, v2, 4, v44
    v_add_u32 v44, s61, v44
    v_cndmask_b32 v157, v43, v44, vcc
    s_add_u32 s3, s53, 4
    s_mul_i32 s3, s3, 896
    v_mov_b32 v44, s3
    v_add_u32 v45, 14336, v44
    v_cndmask_b32 v44, v42, v44, vcc
    v_cndmask_b32 v45, v42, v45, vcc
    v_lshl_add_u32 v101, v2, 3, v44
    v_lshl_add_u32 v103, v2, 3, v45
    v_and_b32 v44, 3, v2
    v_add_u32 v44, s53, v44
    v_mul_u32_u24 v44, 896, v44
    v_lshrrev_b32 v45, 2, v0
    v_lshl_add_u32 v44, v45, 3, v44
    v_add_u32 v104, 28672, v44
    v_and_b32 v40, 1, v2
    v_cmp_eq_u32 s[16:17], 1, v40
    v_lshl_add_u32 v44, v1, 2, v40
    v_add_u32 v45, 2, v2
    v_cmp_ge_u32 s[18:19], v44, v45
    v_cmp_ge_u32 s[22:23], v44, v2
    v_mov_b32 v40, 0xffff
    v_mov_b32 v44, 0xffff0000
    v_cndmask_b32 v40, v40, v44, s[16:17]
    v_cndmask_b32 v152, 0, v40, s[18:19]
    v_cndmask_b32 v153, 0, v40, s[22:23]
    v_cndmask_b32 v154, v40, 0, s[18:19]
    v_cndmask_b32 v155, v40, 0, s[22:23]
    s_cmp_eq_u32 s62, 0
    s_cselect_b32 s3, 0, 1
    s_cselect_b32 s61, -1, 1
    s_lshl_b32 s58, s39, 1
    s_add_u32 s58, s58, s3
    s_add_u32 s59, s58, s61
    s_mul_i32 s58, s58, 3072
    s_add_u32 s58, s58, 2080768
    s_mul_i32 s59, s59, 3072
    s_add_u32 s59, s59, 2080768
    s_mul_i32 s3, s63, 1536
    s_add_u32 s58, s58, s3
    s_add_u32 s59, s59, s3
    v_mul_u32_u24 v105, 12, v0
    s_mul_i32 s3, s63, 384
    v_add_u32 v100, s3, v100
    v_add_u32 v101, s3, v101
    v_add_u32 v102, s3, v102
    v_add_u32 v103, s3, v103
    v_add_u32 v104, s3, v104
    s_mov_b32 s12, s20
    s_mov_b32 s13, s21
    s_mov_b32 s14, 819200
    s_mov_b32 s15, 0x20000
    s_lshl_b32 s55, s45, 10
    s_add_u32 s55, s55, 106496
    s_mul_i32 s54, s45, 10240
    s_add_u32 s54, s54, 245760
    s_mov_b32 s49, 3
L_dm_4:
    s_add_u32 m0, s55, 0
    s_add_u32 s3, s54, 0
    buffer_load_dwordx4 v9, s[12:15], s3 offen  lds
    s_add_u32 m0, s55, 2048
    s_add_u32 s3, s54, 20480
    buffer_load_dwordx4 v9, s[12:15], s3 offen  lds
    s_add_u32 m0, s55, 4096
    s_add_u32 s3, s54, 40960
    buffer_load_dwordx4 v9, s[12:15], s3 offen  lds
    s_add_u32 m0, s55, 6144
    s_add_u32 s3, s54, 61440
    buffer_load_dwordx4 v9, s[12:15], s3 offen  lds
    s_add_u32 s55, s55, 8192
    s_add_u32 s54, s54, 81920
    s_sub_u32 s49, s49, 1
    s_cmp_lg_u32 s49, 0
    s_cbranch_scc1 L_dm_4
    v_mov_b32 v12, 66560
    ds_read_b32 v12, v12
    s_waitcnt lgkmcnt(0)
    v_readfirstlane_b32 s50, v12
    s_mov_b32 s94, 2
    s_branch L_att
L_hBret:
    s_waitcnt vmcnt(0)
    s_barrier
    s_mov_b32 s12, s24
    s_mov_b32 s13, s25
    s_mov_b32 s14, 819200
    s_mov_b32 s15, 0x20000
    s_lshl_b32 s55, s45, 10
    s_add_u32 s55, s55, 0
    s_mul_i32 s54, s45, 10240
    s_add_u32 s54, s54, 0
    s_mul_i32 s57, s38, 10
    s_lshr_b32 s57, s57, 3
    s_mul_i32 s3, s57, 8192
    s_add_u32 s55, s55, s3
    s_mul_i32 s3, s57, 81920
    s_add_u32 s54, s54, s3
    s_mov_b32 s49, 10
L_dm_5:
    s_add_u32 m0, s55, 0
    s_add_u32 s3, s54, 0
    buffer_load_dwordx4 v9, s[12:15], s3 offen  lds
    s_add_u32 m0, s55, 2048
    s_add_u32 s3, s54, 20480
    buffer_load_dwordx4 v9, s[12:15], s3 offen  lds
    s_add_u32 m0, s55, 4096
    s_add_u32 s3, s54, 40960
    buffer_load_dwordx4 v9, s[12:15], s3 offen  lds
    s_add_u32 m0, s55, 6144
    s_add_u32 s3, s54, 61440
    buffer_load_dwordx4 v9, s[12:15], s3 offen  lds
    s_add_u32 s55, s55, 8192
    s_add_u32 s54, s54, 81920
    s_add_u32 s57, s57, 1
    s_cmp_eq_u32 s57, 10
    s_cselect_b32 s3, 81920, 0
    s_cselect_b32 s53, 819200, 0
    s_sub_u32 s55, s55, s3
    s_sub_u32 s54, s54, s53
    s_sub_u32 s49, s49, 1
    s_cmp_lg_u32 s49, 0
    s_cbranch_scc1 L_dm_5
    s_barrier
    s_mov_b32 s12, s26
    s_mov_b32 s13, s27
    s_mov_b32 s14, 819200
    s_mov_b32 s15, 0x20000
    s_sub_u32 s3, s40, 4
    s_mul_i32 s3, s3, 10240
    s_add_u32 s3, s3, 0
    buffer_load_dwordx4 v[40:43], v9, s[12:15], s3 offen
    s_add_u32 s3, s3, 40960
    buffer_load_dwordx4 v[44:47], v9, s[12:15], s3 offen
    s_add_u32 s3, s3, 40960
    buffer_load_dwordx4 v[48:51], v9, s[12:15], s3 offen
    s_add_u32 s3, s3, 40960
    buffer_load_dwordx4 v[52:55], v9, s[12:15], s3 offen
    s_add_u32 s3, s3, 40960
    buffer_load_dwordx4 v[56:59], v9, s[12:15], s3 offen
    s_add_u32 s3, s3, 40960
    buffer_load_dwordx4 v[60:63], v9, s[12:15], s3 offen
    s_add_u32 s3, s3, 40960
    buffer_load_dwordx4 v[64:67], v9, s[12:15], s3 offen
    s_add_u32 s3, s3, 40960
    buffer_load_dwordx4 v[68:71], v9, s[12:15], s3 offen
    s_add_u32 s3, s3, 40960
    buffer_load_dwordx4 v[72:75], v9, s[12:15], s3 offen
    s_add_u32 s3, s3, 40960
    buffer_load_dwordx4 v[76:79], v9, s[12:15], s3 offen
    s_add_u32 s3, s3, 40960
    buffer_load_dwordx4 v[80:83], v9, s[12:15], s3 offen
    s_add_u32 s3, s3, 40960
    buffer_load_dwordx4 v[84:87], v9, s[12:15], s3 offen
    s_add_u32 s3, s3, 40960
    s_waitcnt vmcnt(12)
    s_barrier
    s_barrier
    s_sub_u32 s3, s40, 4
    s_lshl_b32 s3, s3, 10
    s_add_u32 s3, s3, 81920
    v_lshl_add_u32 v3, v0, 4, s3
    v_add_u32 v4, 40960, v3
    s_waitcnt vmcnt(0)
    ds_write_b128 v3, v[40:43] offset:0
    ds_write_b128 v3, v[44:47] offset:4096
    ds_write_b128 v3, v[48:51] offset:8192
    ds_write_b128 v3, v[52:55] offset:12288
    ds_write_b128 v3, v[56:59] offset:16384
    ds_write_b128 v3, v[60:63] offset:20480
    ds_write_b128 v3, v[64:67] offset:24576
    ds_write_b128 v3, v[68:71] offset:28672
    ds_write_b128 v3, v[72:75] offset:32768
    ds_write_b128 v3, v[76:79] offset:36864
    ds_write_b128 v4, v[80:83] offset:0
    ds_write_b128 v4, v[84:87] offset:4096
    s_mov_b32 s12, s26
    s_mov_b32 s13, s27
    s_mov_b32 s14, 819200
    s_mov_b32 s15, 0x20000
    s_lshl_b32 s55, s45, 10
    s_add_u32 s55, s55, 131072
    s_mul_i32 s54, s45, 10240
    s_add_u32 s54, s54, 491520
    s_mul_i32 s57, s38, 4
    s_lshr_b32 s57, s57, 3
    s_mul_i32 s3, s57, 8192
    s_add_u32 s55, s55, s3
    s_mul_i32 s3, s57, 81920
    s_add_u32 s54, s54, s3
    s_mov_b32 s49, 4
L_dm_6:
    s_add_u32 m0, s55, 0
    s_add_u32 s3, s54, 0
    buffer_load_dwordx4 v9, s[12:15], s3 offen  lds
    s_add_u32 m0, s55, 2048
    s_add_u32 s3, s54, 20480
    buffer_load_dwordx4 v9, s[12:15], s3 offen  lds
    s_add_u32 m0, s55, 4096
    s_add_u32 s3, s54, 40960
    buffer_load_dwordx4 v9, s[12:15], s3 offen  lds
    s_add_u32 m0, s55, 6144
    s_add_u32 s3, s54, 61440
    buffer_load_dwordx4 v9, s[12:15], s3 offen  lds
    s_add_u32 s55, s55, 8192
    s_add_u32 s54, s54, 81920
    s_add_u32 s57, s57, 1
    s_cmp_eq_u32 s57, 4
    s_cselect_b32 s3, 32768, 0
    s_cselect_b32 s53, 327680, 0
    s_sub_u32 s55, s55, s3
    s_sub_u32 s54, s54, s53
    s_sub_u32 s49, s49, 1
    s_cmp_lg_u32 s49, 0
    s_cbranch_scc1 L_dm_6
    s_waitcnt vmcnt(0)
    s_waitcnt lgkmcnt(0)
    s_lshl_b32 s56, s39, 1
    s_add_u32 s56, s56, s45
    s_cmp_ge_u32 s39, 28
    s_cbranch_scc1 L_hB28
    s_barrier
    s_mov_b32 s12, s28
    s_mov_b32 s13, s29
    s_mov_b32 s14, 2211840
    s_mov_b32 s15, 0x20000
    s_sub_u32 s3, s40, 4
    s_mul_i32 s3, s3, 13824
    s_add_u32 s3, s3, 0
    buffer_load_dwordx4 v[40:43], v11, s[12:15], s3 offen
    s_add_u32 s3, s3, 55296
    buffer_load_dwordx4 v[44:47], v11, s[12:15], s3 offen
    s_add_u32 s3, s3, 55296
    buffer_load_dwordx4 v[48:51], v11, s[12:15], s3 offen
    s_add_u32 s3, s3, 55296
    buffer_load_dwordx4 v[52:55], v11, s[12:15], s3 offen
    s_add_u32 s3, s3, 55296
    buffer_load_dwordx4 v[56:59], v11, s[12:15], s3 offen
    s_add_u32 s3, s3, 55296
    buffer_load_dwordx4 v[60:63], v11, s[12:15], s3 offen
    s_add_u32 s3, s3, 55296
    buffer_load_dwordx4 v[64:67], v11, s[12:15], s3 offen
    s_add_u32 s3, s3, 55296
    buffer_load_dwordx4 v[68:71], v11, s[12:15], s3 offen
    s_add_u32 s3, s3, 55296
    buffer_load_dwordx4 v[72:75], v11, s[12:15], s3 offen
    s_add_u32 s3, s3, 55296
    buffer_load_dwordx4 v[76:79], v11, s[12:15], s3 offen
    s_add_u32 s3, s3, 55296
    buffer_load_dwordx4 v[80:83], v11, s[12:15], s3 offen
    s_add_u32 s3, s3, 55296
    buffer_load_dwordx4 v[84:87], v11, s[12:15], s3 offen
    s_add_u32 s3, s3, 55296
    s_barrier
    s_barrier
    s_sub_u32 s3, s40, 4
    s_lshl_b32 s3, s3, 10
    s_add_u32 s3, s3, 0
    v_lshl_add_u32 v3, v0, 4, s3
    v_add_u32 v4, 40960, v3
    s_waitcnt vmcnt(0)
    ds_write_b128 v3, v[40:43] offset:0
    ds_write_b128 v3, v[44:47] offset:4096
    ds_write_b128 v3, v[48:51] offset:8192
    ds_write_b128 v3, v[52:55] offset:12288
    ds_write_b128 v3, v[56:59] offset:16384
    ds_write_b128 v3, v[60:63] offset:20480
    ds_write_b128 v3, v[64:67] offset:24576
    ds_write_b128 v3, v[68:71] offset:28672
    ds_write_b128 v3, v[72:75] offset:32768
    ds_write_b128 v3, v[76:79] offset:36864
    ds_write_b128 v4, v[80:83] offset:0
    ds_write_b128 v4, v[84:87] offset:4096
    s_mov_b32 s12, s28
    s_mov_b32 s13, s29
    s_mov_b32 s14, 2211840
    s_mov_b32 s15, 0x20000
    s_lshl_b32 s55, s45, 10
    s_add_u32 s55, s55, 49152
    s_mul_i32 s54, s45, 13824
    s_add_u32 s54, s54, 663552
    s_mul_i32 s57, s38, 4
    s_lshr_b32 s57, s57, 3
    s_mul_i32 s3, s57, 8192
    s_add_u32 s55, s55, s3
    s_mul_i32 s3, s57, 110592
    s_add_u32 s54, s54, s3
    s_mov_b32 s49, 4
L_dm_7:
    s_add_u32 m0, s55, 0
    s_add_u32 s3, s54, 0
    buffer_load_dwordx4 v11, s[12:15], s3 offen  lds
    s_add_u32 m0, s55, 2048
    s_add_u32 s3, s54, 27648
    buffer_load_dwordx4 v11, s[12:15], s3 offen  lds
    s_add_u32 m0, s55, 4096
    s_add_u32 s3, s54, 55296
    buffer_load_dwordx4 v11, s[12:15], s3 offen  lds
    s_add_u32 m0, s55, 6144
    s_add_u32 s3, s54, 82944
    buffer_load_dwordx4 v11, s[12:15], s3 offen  lds
    s_add_u32 s55, s55, 8192
    s_add_u32 s54, s54, 110592
    s_add_u32 s57, s57, 1
    s_cmp_eq_u32 s57, 4
    s_cselect_b32 s3, 32768, 0
    s_cselect_b32 s53, 442368, 0
    s_sub_u32 s55, s55, s3
    s_sub_u32 s54, s54, s53
    s_sub_u32 s49, s49, 1
    s_cmp_lg_u32 s49, 0
    s_cbranch_scc1 L_dm_7
    s_waitcnt vmcnt(0)
    s_waitcnt lgkmcnt(0)
    s_barrier
    s_barrier
    s_barrier
    s_mov_b32 s12, s28
    s_mov_b32 s13, s29
    s_mov_b32 s14, 2211840
    s_mov_b32 s15, 0x20000
    s_lshl_b32 s55, s45, 10
    s_add_u32 s55, s55, 81920
    s_mul_i32 s54, s45, 13824
    s_add_u32 s54, s54, 1105920
    s_mul_i32 s57, s38, 10
    s_lshr_b32 s57, s57, 3
    s_mul_i32 s3, s57, 8192
    s_add_u32 s55, s55, s3
    s_mul_i32 s3, s57, 110592
    s_add_u32 s54, s54, s3
    s_mov_b32 s49, 10
L_dm_8:
    s_add_u32 m0, s55, 0
    s_add_u32 s3, s54, 0
    buffer_load_dwordx4 v11, s[12:15], s3 offen  lds
    s_add_u32 m0, s55, 2048
    s_add_u32 s3, s54, 27648
    buffer_load_dwordx4 v11, s[12:15], s3 offen  lds
    s_add_u32 m0, s55, 4096
    s_add_u32 s3, s54, 55296
    buffer_load_dwordx4 v11, s[12:15], s3 offen  lds
    s_add_u32 m0, s55, 6144
    s_add_u32 s3, s54, 82944
    buffer_load_dwordx4 v11, s[12:15], s3 offen  lds
    s_add_u32 s55, s55, 8192
    s_add_u32 s54, s54, 110592
    s_add_u32 s57, s57, 1
    s_cmp_eq_u32 s57, 10
    s_cselect_b32 s3, 81920, 0
    s_cselect_b32 s53, 1105920, 0
    s_sub_u32 s55, s55, s3
    s_sub_u32 s54, s54, s53
    s_sub_u32 s49, s49, 1
    s_cmp_lg_u32 s49, 0
    s_cbranch_scc1 L_dm_8
    s_waitcnt vmcnt(0)
    s_barrier
    s_mov_b32 s12, s30
    s_mov_b32 s13, s31
    s_mov_b32 s14, 2211840
    s_mov_b32 s15, 0x20000
    s_lshl_b32 s55, s45, 10
    s_add_u32 s55, s55, 0
    s_mul_i32 s54, s45, 10240
    s_add_u32 s54, s54, 0
    s_mul_i32 s57, s38, 10
    s_lshr_b32 s57, s57, 3
    s_mul_i32 s3, s57, 8192
    s_add_u32 s55, s55, s3
    s_mul_i32 s3, s57, 81920
    s_add_u32 s54, s54, s3
    s_mov_b32 s49, 10
L_dm_9:
    s_waitcnt vmcnt(10)
    s_add_u32 m0, s55, 0
    s_add_u32 s3, s54, 0
    buffer_load_dwordx4 v9, s[12:15], s3 offen  lds
    s_add_u32 m0, s55, 2048
    s_add_u32 s3, s54, 20480
    buffer_load_dwordx4 v9, s[12:15], s3 offen  lds
    s_waitcnt vmcnt(10)
    s_add_u32 m0, s55, 4096
    s_add_u32 s3, s54, 40960
    buffer_load_dwordx4 v9, s[12:15], s3 offen  lds
    s_add_u32 m0, s55, 6144
    s_add_u32 s3, s54, 61440
    buffer_load_dwordx4 v9, s[12:15], s3 offen  lds
    s_add_u32 s55, s55, 8192
    s_add_u32 s54, s54, 81920
    s_add_u32 s57, s57, 1
    s_cmp_eq_u32 s57, 10
    s_cselect_b32 s3, 81920, 0
    s_cselect_b32 s53, 819200, 0
    s_sub_u32 s55, s55, s3
    s_sub_u32 s54, s54, s53
    s_sub_u32 s49, s49, 1
    s_cmp_lg_u32 s49, 0
    s_cbranch_scc1 L_dm_9
    s_waitcnt vmcnt(0)
    s_barrier
    s_barrier
    s_barrier
    s_mov_b32 s12, s30
    s_mov_b32 s13, s31
    s_mov_b32 s14, 2211840
    s_mov_b32 s15, 0x20000
    s_lshl_b32 s55, s45, 10
    s_add_u32 s55, s55, 81920
    s_mul_i32 s54, s45, 10240
    s_add_u32 s54, s54, 819200
    s_mul_i32 s57, s38, 10
    s_lshr_b32 s57, s57, 3
    s_mul_i32 s3, s57, 8192
    s_add_u32 s55, s55, s3
    s_mul_i32 s3, s57, 81920
    s_add_u32 s54, s54, s3
    s_mov_b32 s49, 10
L_dm_10:
    s_add_u32 m0, s55, 0
    s_add_u32 s3, s54, 0
    buffer_load_dwordx4 v9, s[12:15], s3 offen  lds
    s_add_u32 m0, s55, 2048
    s_add_u32 s3, s54, 20480
    buffer_load_dwordx4 v9, s[12:15], s3 offen  lds
    s_add_u32 m0, s55, 4096
    s_add_u32 s3, s54, 40960
    buffer_load_dwordx4 v9, s[12:15], s3 offen  lds
    s_add_u32 m0, s55, 6144
    s_add_u32 s3, s54, 61440
    buffer_load_dwordx4 v9, s[12:15], s3 offen  lds
    s_add_u32 s55, s55, 8192
    s_add_u32 s54, s54, 81920
    s_add_u32 s57, s57, 1
    s_cmp_eq_u32 s57, 10
    s_cselect_b32 s3, 81920, 0
    s_cselect_b32 s53, 819200, 0
    s_sub_u32 s55, s55, s3
    s_sub_u32 s54, s54, s53
    s_sub_u32 s49, s49, 1
    s_cmp_lg_u32 s49, 0
    s_cbranch_scc1 L_dm_10
    s_branch L_hB7
L_hB28:
    s_barrier
    s_barrier
    s_barrier
    s_barrier
    s_barrier
    s_barrier
    s_barrier
    s_mov_b32 s12, s30
    s_mov_b32 s13, s31
    s_mov_b32 s14, 2211840
    s_mov_b32 s15, 0x20000
    s_lshl_b32 s55, s45, 10
    s_add_u32 s55, s55, 0
    s_mul_i32 s54, s45, 10240
    s_add_u32 s54, s54, 0
    s_mul_i32 s57, s38, 10
    s_lshr_b32 s57, s57, 3
    s_mul_i32 s3, s57, 8192
    s_add_u32 s55, s55, s3
    s_mul_i32 s3, s57, 81920
    s_add_u32 s54, s54, s3
    s_mov_b32 s49, 10
L_dm_11:
    s_add_u32 m0, s55, 0
    s_add_u32 s3, s54, 0
    buffer_load_dwordx4 v9, s[12:15], s3 offen  lds
    s_add_u32 m0, s55, 2048
    s_add_u32 s3, s54, 20480
    buffer_load_dwordx4 v9, s[12:15], s3 offen  lds
    s_add_u32 m0, s55, 4096
    s_add_u32 s3, s54, 40960
    buffer_load_dwordx4 v9, s[12:15], s3 offen  lds
    s_add_u32 m0, s55, 6144
    s_add_u32 s3, s54, 61440
    buffer_load_dwordx4 v9, s[12:15], s3 offen  lds
    s_add_u32 s55, s55, 8192
    s_add_u32 s54, s54, 81920
    s_add_u32 s57, s57, 1
    s_cmp_eq_u32 s57, 10
    s_cselect_b32 s3, 81920, 0
    s_cselect_b32 s53, 819200, 0
    s_sub_u32 s55, s55, s3
    s_sub_u32 s54, s54, s53
    s_sub_u32 s49, s49, 1
    s_cmp_lg_u32 s49, 0
    s_cbranch_scc1 L_dm_11
    s_mov_b32 s12, s30
    s_mov_b32 s13, s31
    s_mov_b32 s14, 2211840
    s_mov_b32 s15, 0x20000
    s_lshl_b32 s55, s45, 10
    s_add_u32 s55, s55, 81920
    s_mul_i32 s54, s45, 10240
    s_add_u32 s54, s54, 819200
    s_mul_i32 s57, s38, 10
    s_lshr_b32 s57, s57, 3
    s_mul_i32 s3, s57, 8192
    s_add_u32 s55, s55, s3
    s_mul_i32 s3, s57, 81920
    s_add_u32 s54, s54, s3
    s_mov_b32 s49, 10
L_dm_12:
    s_add_u32 m0, s55, 0
    s_add_u32 s3, s54, 0
    buffer_load_dwordx4 v9, s[12:15], s3 offen  lds
    s_add_u32 m0, s55, 2048
    s_add_u32 s3, s54, 20480
    buffer_load_dwordx4 v9, s[12:15], s3 offen  lds
    s_add_u32 m0, s55, 4096
    s_add_u32 s3, s54, 40960
    buffer_load_dwordx4 v9, s[12:15], s3 offen  lds
    s_add_u32 m0, s55, 6144
    s_add_u32 s3, s54, 61440
    buffer_load_dwordx4 v9, s[12:15], s3 offen  lds
    s_add_u32 s55, s55, 8192
    s_add_u32 s54, s54, 81920
    s_add_u32 s57, s57, 1
    s_cmp_eq_u32 s57, 10
    s_cselect_b32 s3, 81920, 0
    s_cselect_b32 s53, 819200, 0
    s_sub_u32 s55, s55, s3
    s_sub_u32 s54, s54, s53
    s_sub_u32 s49, s49, 1
    s_cmp_lg_u32 s49, 0
    s_cbranch_scc1 L_dm_12
    s_waitcnt vmcnt(40)
    s_barrier
L_hB7:
    s_lshl_b32 s3, s45, 10
    s_add_u32 s3, s3, 0
    v_lshl_add_u32 v3, v0, 4, s3
    s_waitcnt vmcnt(0)
    s_barrier
    s_mov_b32 s12, s30
    s_mov_b32 s13, s31
    s_mov_b32 s14, 2211840
    s_mov_b32 s15, 0x20000
    s_lshl_b32 s55, s45, 10
    s_add_u32 s55, s55, 0
    s_mul_i32 s54, s45, 10240
    s_add_u32 s54, s54, 1638400
    s_mov_b32 s49, 2
L_dm_13:
    s_add_u32 m0, s55, 0
    s_add_u32 s3, s54, 0
    buffer_load_dwordx4 v9, s[12:15], s3 offen  lds
    s_add_u32 m0, s55, 2048
    s_add_u32 s3, s54, 20480
    buffer_load_dwordx4 v9, s[12:15], s3 offen  lds
    s_add_u32 m0, s55, 4096
    s_add_u32 s3, s54, 40960
    buffer_load_dwordx4 v9, s[12:15], s3 offen  lds
    s_add_u32 m0, s55, 6144
    s_add_u32 s3, s54, 61440
    buffer_load_dwordx4 v9, s[12:15], s3 offen  lds
    s_add_u32 m0, s55, 8192
    s_add_u32 s3, s54, 81920
    buffer_load_dwordx4 v9, s[12:15], s3 offen  lds
    s_add_u32 m0, s55, 10240
    s_add_u32 s3, s54, 102400
    buffer_load_dwordx4 v9, s[12:15], s3 offen  lds
    s_add_u32 m0, s55, 12288
    s_add_u32 s3, s54, 122880
    buffer_load_dwordx4 v9, s[12:15], s3 offen  lds
    s_add_u32 s55, s55, 14336
    s_add_u32 s54, s54, 143360
    s_sub_u32 s49, s49, 1
    s_cmp_lg_u32 s49, 0
    s_cbranch_scc1 L_dm_13
    s_mov_b32 s12, s30
    s_mov_b32 s13, s31
    s_mov_b32 s14, 2211840
    s_mov_b32 s15, 0x20000
    s_lshl_b32 s55, s45, 10
    s_add_u32 s55, s55, 40960
    s_mul_i32 s54, s45, 10240
    s_add_u32 s54, s54, 1925120
    s_mov_b32 s49, 2
L_dm_14:
    s_add_u32 m0, s55, 0
    s_add_u32 s3, s54, 0
    buffer_load_dwordx4 v9, s[12:15], s3 offen  lds
    s_add_u32 m0, s55, 2048
    s_add_u32 s3, s54, 20480
    buffer_load_dwordx4 v9, s[12:15], s3 offen  lds
    s_add_u32 m0, s55, 4096
    s_add_u32 s3, s54, 40960
    buffer_load_dwordx4 v9, s[12:15], s3 offen  lds
    s_add_u32 m0, s55, 6144
    s_add_u32 s3, s54, 61440
    buffer_load_dwordx4 v9, s[12:15], s3 offen  lds
    s_add_u32 m0, s55, 8192
    s_add_u32 s3, s54, 81920
    buffer_load_dwordx4 v9, s[12:15], s3 offen  lds
    s_add_u32 m0, s55, 10240
    s_add_u32 s3, s54, 102400
    buffer_load_dwordx4 v9, s[12:15], s3 offen  lds
    s_add_u32 m0, s55, 12288
    s_add_u32 s3, s54, 122880
    buffer_load_dwordx4 v9, s[12:15], s3 offen  lds
    s_add_u32 s55, s55, 14336
    s_add_u32 s54, s54, 143360
    s_sub_u32 s49, s49, 1
    s_cmp_lg_u32 s49, 0
    s_cbranch_scc1 L_dm_14
    s_waitcnt vmcnt(0)
    s_barrier
    s_barrier
    s_branch L_hfin
L_hA:
    v_lshrrev_b32 v3, 3, v0
    s_lshl_b32 s3, s45, 3
    v_add_u32 v3, s3, v3
    v_lshrrev_b32 v4, 1, v3
    v_and_b32 v5, 7, v0
    v_xor_b32 v4, v4, v5
    v_lshlrev_b32 v4, 4, v4
    s_lshl_b32 s3, s38, 8
    s_lshl_b32 s52, s42, 4
    s_add_u32 s3, s3, s52
    s_sub_u32 s3, s3, 24
    v_add_u32 v3, s3, v3
    s_movk_i32 s3, 2047
    v_mov_b32 v6, 1280
    v_med3_i32 v5, 0, v3, s3
    v_mad_u32_u24 v8, v5, v6, v4
    v_add_u32 v3, 16, v3
    v_med3_i32 v5, 0, v3, s3
    v_mad_u32_u24 v9, v5, v6, v4
    v_add_u32 v3, 16, v3
    v_med3_i32 v5, 0, v3, s3
    v_mad_u32_u24 v10, v5, v6, v4
    v_add_u32 v3, 16, v3
    v_med3_i32 v5, 0, v3, s3
    v_mad_u32_u24 v11, v5, v6, v4
    v_add_u32 v3, 16, v3
    v_med3_i32 v5, 0, v3, s3
    v_mad_u32_u24 v12, v5, v6, v4
    v_add_u32 v3, 16, v3
    v_med3_i32 v5, 0, v3, s3
    v_mad_u32_u24 v13, v5, v6, v4
    v_add_u32 v3, 16, v3
    v_med3_i32 v5, 0, v3, s3
    v_mad_u32_u24 v14, v5, v6, v4
    s_cmp_eq_u32 s43, 2
    s_cselect_b32 s3, 1073741824, 0
    v_add_u32 v8, s3, v8
    s_lshl_b32 s54, s56, 7
    s_lshl_b32 s55, s45, 10
    s_waitcnt lgkmcnt(0)
    s_mov_b32 s8, s16
    s_mov_b32 s9, s17
    s_mov_b32 s10, 2621440
    s_mov_b32 s11, 0x20000
    s_lshl_b32 s56, s39, 1
    s_add_u32 s56, s56, s45
    s_mov_b32 s49, 0
L_hApro:
    s_add_u32 m0, s55, 0
    s_nop 0
    buffer_load_dwordx4 v8, s[8:11], s54 offen lds
    s_add_u32 m0, s55, 2048
    s_nop 0
    buffer_load_dwordx4 v9, s[8:11], s54 offen lds
    s_add_u32 m0, s55, 4096
    s_nop 0
    buffer_load_dwordx4 v10, s[8:11], s54 offen lds
    s_add_u32 m0, s55, 6144
    s_nop 0
    buffer_load_dwordx4 v11, s[8:11], s54 offen lds
    s_add_u32 m0, s55, 8192
    s_nop 0
    buffer_load_dwordx4 v12, s[8:11], s54 offen lds
    s_add_u32 m0, s55, 10240
    s_nop 0
    buffer_load_dwordx4 v13, s[8:11], s54 offen lds
    s_add_u32 m0, s55, 12288
    s_nop 0
    buffer_load_dwordx4 v14, s[8:11], s54 offen lds
    s_add_u32 s54, s54, 128
    s_cmpk_eq_u32 s54, 1280
    s_cmov_b32 s54, 0
    s_add_u32 s55, s55, 38912
    s_cmp_ge_u32 s55, 116736
    s_cselect_b32 s3, 116736, 0
    s_sub_u32 s55, s55, s3
    s_add_u32 s49, s49, 1
    s_cmp_eq_u32 s49, 1
    s_cbranch_scc1 L_hApro
    s_cmp_eq_u32 s49, 3
    s_cbranch_scc1 L_hApr2
    s_waitcnt vmcnt(7)
    s_barrier
    s_branch L_hApro
L_hApr2:
    s_lshl_b32 s3, s38, 22
    s_add_u32 s4, s36, s3
    s_addc_u32 s5, s37, 0
    s_mov_b32 s6, 4194304
    s_mov_b32 s7, 0x20000
    s_getreg_b32 s51, hwreg(HW_REG_XCC_ID, 0, 4)
    s_or_b32 s51, s51, 0x80
    s_lshl_b32 s3, s38, 5
    v_mov_b32 v128, s3
    v_min_u32 v131, 29, v0
    v_lshlrev_b32 v131, 4, v131
    v_add_u32 v131, 5632, v131
    global_load_dword v129, v128, s[34:35] sc1
    v_lshlrev_b32 v24, 4, v0
    s_lshl_b32 s3, s42, 7
    s_add_u32 s3, s3, 3072
    v_min_u32 v25, 55, v0
    v_lshlrev_b32 v25, 4, v25
    v_add_u32 v26, 65536, v25
    v_add_u32 v25, s3, v25
    v_mov_b32 v28, -1
    v_mov_b32 v29, -1
    v_mov_b32 v30, -1
    v_mov_b32 v31, -1
    s_mov_b32 s60, 1073741824
    s_waitcnt vmcnt(8)
    s_barrier
L_hAloop:
    s_add_u32 m0, s55, 0
    s_nop 0
    buffer_load_dwordx4 v8, s[8:11], s54 offen lds
    s_add_u32 m0, s55, 2048
    s_nop 0
    buffer_load_dwordx4 v9, s[8:11], s54 offen lds
    s_add_u32 m0, s55, 4096
    s_nop 0
    buffer_load_dwordx4 v10, s[8:11], s54 offen lds
    s_add_u32 m0, s55, 6144
    s_nop 0
    buffer_load_dwordx4 v11, s[8:11], s54 offen lds
    s_add_u32 m0, s55, 8192
    s_nop 0
    buffer_load_dwordx4 v12, s[8:11], s54 offen lds
    s_add_u32 m0, s55, 10240
    s_nop 0
    buffer_load_dwordx4 v13, s[8:11], s54 offen lds
    s_add_u32 m0, s55, 12288
    s_nop 0
    buffer_load_dwordx4 v14, s[8:11], s54 offen lds
    s_add_u32 s54, s54, 128
    s_cmpk_eq_u32 s54, 1280
    s_cmov_b32 s54, 0
    s_add_u32 s55, s55, 38912
    s_cmp_ge_u32 s55, 116736
    s_cselect_b32 s3, 116736, 0
    s_sub_u32 s55, s55, s3
    s_add_u32 s49, s49, 1
    s_cmp_eq_u32 s49, 1
    s_cbranch_scc1 L_hAloop
    s_cmp_eq_u32 s49, 10
    s_cbranch_scc1 L_hAout
    s_bitcmp1_b32 176, s49
    s_cbranch_scc1 L_hAside
L_hAback:
    s_waitcnt vmcnt(7)
    s_barrier
    s_branch L_hAloop
L_hAside:
    s_cmp_lg_u32 s49, 4
    s_cbranch_scc1 L_hf_15
    s_waitcnt vmcnt(7)
    v_cmp_eq_u32 vcc, 0, v129
    s_cbranch_vccz L_hr_16
    global_load_dword v129, v128, s[34:35] sc1
    s_mov_b32 s62, 400000
L_sa_18:
    s_waitcnt vmcnt(0)
    v_cmp_eq_u32 vcc, 0, v129
    s_cbranch_vccz L_sb_19
    s_sub_u32 s62, s62, 1
    s_cbranch_scc1 L_end
    global_load_dword v129, v128, s[34:35] sc1
    s_branch L_sa_18
L_sb_19:
L_hr_16:
    s_cmp_ge_u32 s44, 5
    s_cselect_b32 s3, 5, 0
    s_sub_u32 s3, s44, s3
    s_lshl_b32 s52, s45, 2
    s_cmp_eq_u32 s3, s52
    s_cbranch_scc1 L_hs_17
    s_mul_i32 s3, s45, 3
    s_lshl_b32 s52, s39, 1
    s_add_u32 s3, s3, s52
    s_sub_u32 s3, s3, 1
    s_mul_i32 s3, s3, 3072
    s_add_u32 s60, s3, 2080768
    buffer_store_dwordx4 v[28:31], v24, s[4:7], s60 offen offset:0 sc1
    buffer_store_dwordx4 v[28:31], v24, s[4:7], s60 offen offset:1024 sc1
    buffer_store_dwordx4 v[28:31], v24, s[4:7], s60 offen offset:2048 sc1
L_hs_17:
    s_branch L_hAback
L_hf_15:
    s_cmp_lg_u32 s49, 5
    s_cbranch_scc1 L_hf_20
    s_getpc_b64 s[52:53]
L_pc_21:
    s_mul_i32 s3, s56, 768
    s_sub_u32 s3, s3, L_pc_21-sequential_preLN__sliding_local_dilated__mixer_s_mlp__prompt_kernel
    s_add_u32 s52, s52, s3
    s_addc_u32 s53, s53, 0
    s_ashr_i32 s3, s3, 31
    s_add_u32 s53, s53, s3
    s_load_dword s95, s[52:53], 0
    s_load_dword s95, s[52:53], 64
    s_load_dword s95, s[52:53], 128
    s_load_dword s95, s[52:53], 192
    s_load_dword s95, s[52:53], 256
    s_load_dword s95, s[52:53], 320
    s_load_dword s95, s[52:53], 384
    s_load_dword s95, s[52:53], 448
    s_load_dword s95, s[52:53], 512
    s_load_dword s95, s[52:53], 576
    s_load_dword s95, s[52:53], 640
    s_load_dword s95, s[52:53], 704
    s_branch L_hAback
L_hf_20:
    s_cmp_lg_u32 s49, 7
    s_cbranch_scc1 L_hf_22
    s_cmp_lg_u32 s45, 0
    s_cbranch_scc1 L_hm_23
    s_lshl_b32 s3, s39, 4
    s_add_u32 s3, s3, 5632
    v_mov_b32 v129, s3
    v_mov_b32 v130, s51
    s_mov_b64 exec, 1
    buffer_store_dword v130, v129, s[4:7], 0 offen sc1
    s_mov_b64 exec, -1
L_hm_23:
    s_branch L_hAback
L_hf_22:
    s_branch L_hAback
L_hAout:
    buffer_load_dword v129, v131, s[4:7], 0 offen sc1
    buffer_load_dwordx4 v[32:35], v25, s[4:7], 0 offen sc1
    buffer_load_dword v158, v24, s[4:7], 0 offen sc1
    v_min_u32 v38, 23, v0
    v_lshlrev_b32 v38, 7, v38
    buffer_load_dword v158, v38, s[4:7], s60 offen sc1
    s_waitcnt vmcnt(11)
    s_barrier
    s_waitcnt vmcnt(0)
    v_min3_u32 v36, v129, v33, v35
    v_cmp_eq_u32 vcc, 0, v36
    s_cbranch_vccz L_hl_24
    buffer_load_dword v129, v131, s[4:7], 0 offen sc1
    s_mov_b32 s62, 400000
L_sa_25:
    s_waitcnt vmcnt(0)
    v_cmp_eq_u32 vcc, 0, v129
    s_cbranch_vccz L_sb_26
    s_sub_u32 s62, s62, 1
    s_cbranch_scc1 L_end
    buffer_load_dword v129, v131, s[4:7], 0 offen sc1
    s_branch L_sa_25
L_sb_26:
    buffer_load_dwordx4 v[32:35], v25, s[4:7], 0 offen sc1
    s_mov_b32 s62, 400000
L_sa_27:
    s_waitcnt vmcnt(0)
    v_min_u32 v36, v33, v35
    v_cmp_eq_u32 vcc, 0, v36
    s_cbranch_vccz L_sb_28
    s_sub_u32 s62, s62, 1
    s_cbranch_scc1 L_end
    buffer_load_dwordx4 v[32:35], v25, s[4:7], 0 offen sc1
    s_branch L_sa_27
L_sb_28:
L_hl_24:
    v_cmp_ne_u32 vcc, s51, v129
    s_nop 0
    s_cmp_lg_u64 vcc, 0
    s_cselect_b32 s50, 1, 0
    v_mov_b32 v36, s50
    v_mov_b32 v37, 66560
    ds_write_b128 v26, v[32:35]
    ds_write_b32 v37, v36
    s_mov_b32 s12, s24
    s_mov_b32 s13, s25
    s_mov_b32 s14, 819200
    s_mov_b32 s15, 0x20000
    v_mul_u32_u24 v20, 1280, v0
    s_mul_i32 s3, s43, 192
    s_lshl_b32 s52, s45, 6
    s_add_u32 s3, s3, s52
    s_mul_i32 s3, s3, 1280
    s_lshl_b32 s52, s44, 7
    s_add_u32 s3, s3, s52
    buffer_load_dword v158, v20, s[12:15], s3 offen sc1
    s_add_u32 s3, s3, 163840
    buffer_load_dword v158, v20, s[12:15], s3 offen sc1
    s_waitcnt lgkmcnt(0)
    s_waitcnt vmcnt(2)
    s_barrier
    s_barrier
    s_getpc_b64 s[52:53]
L_pc_29:
    s_mul_i32 s3, s56, 768
    s_sub_u32 s3, s3, L_pc_29-sequential_preLN__sliding_local_dilated__mixer_s_mlp__prompt_kernel
    s_add_u32 s52, s52, s3
    s_addc_u32 s53, s53, 0
    s_ashr_i32 s3, s3, 31
    s_add_u32 s53, s53, s3
    s_load_dword s95, s[52:53], 0
    s_load_dword s95, s[52:53], 64
    s_load_dword s95, s[52:53], 128
    s_load_dword s95, s[52:53], 192
    s_load_dword s95, s[52:53], 256
    s_load_dword s95, s[52:53], 320
    s_load_dword s95, s[52:53], 384
    s_load_dword s95, s[52:53], 448
    s_load_dword s95, s[52:53], 512
    s_load_dword s95, s[52:53], 576
    s_load_dword s95, s[52:53], 640
    s_load_dword s95, s[52:53], 704
    s_lshl_b32 s62, s40, 2
    s_lshr_b32 s62, 0x21303210, s62
    s_and_b32 s62, s62, 3
    s_lshr_b32 s63, s40, 2
    s_cmp_ge_u32 s44, 5
    s_cselect_b32 s3, 5, 0
    s_sub_u32 s3, s44, s3
    s_sub_u32 s52, 5, s3
    s_mul_i32 s3, s62, 5
    s_add_u32 s3, s3, s52
    s_sub_u32 s53, s3, 5
    s_min_u32 s3, s3, 16
    s_cmp_eq_u32 s62, 0
    s_cselect_b32 s53, 0, s53
    s_sub_u32 s41, s3, s53
    v_add_u32 v40, s53, v1
    v_mul_u32_u24 v100, 896, v40
    v_mov_b32 v42, 45056
    v_cmp_gt_u32 vcc, s41, v1
    v_add_u32 v102, 14336, v100
    s_nop 0
    v_cndmask_b32 v100, v42, v100, vcc
    v_cndmask_b32 v102, v42, v102, vcc
    v_lshl_add_u32 v100, v2, 3, v100
    v_lshl_add_u32 v102, v2, 3, v102
    v_mov_b32 v43, 1073741824
    s_lshl_b32 s3, s44, 4
    v_add_u32 v40, s3, v40
    s_mul_i32 s61, s63, 3
    s_add_u32 s61, s61, s42
    s_lshl_b32 s61, s61, 8
    s_add_u32 s61, s61, 16384
    v_lshrrev_b32 v44, 3, v40
    v_lshlrev_b32 v44, 2, v44
    v_and_or_b32 v44, v40, 3, v44
    v_mul_u32_u24 v44, 4608, v44
    v_and_b32 v45, 4, v40
    v_lshl_add_u32 v44, v45, 1, v44
    v_lshl_add_u32 v44, v2, 4, v44
    v_add_u32 v44, s61, v44
    v_cndmask_b32 v156, v43, v44, vcc
    s_cmp_eq_u32 s41, 5
    s_cselect_b32 s3, 16, 0
    v_cmp_gt_u32 vcc, s3, v0
    v_add_u32 v40, 4, v40
    v_lshrrev_b32 v44, 3, v40
    v_lshlrev_b32 v44, 2, v44
    v_and_or_b32 v44, v40, 3, v44
    v_mul_u32_u24 v44, 4608, v44
    v_and_b32 v45, 4, v40
    v_lshl_add_u32 v44, v45, 1, v44
    v_lshl_add_u32 v44, v2, 4, v44
    v_add_u32 v44, s61, v44
    v_cndmask_b32 v157, v43, v44, vcc
    s_add_u32 s3, s53, 4
    s_mul_i32 s3, s3, 896
    v_mov_b32 v44, s3
    v_add_u32 v45, 14336, v44
    v_cndmask_b32 v44, v42, v44, vcc
    v_cndmask_b32 v45, v42, v45, vcc
    v_lshl_add_u32 v101, v2, 3, v44
    v_lshl_add_u32 v103, v2, 3, v45
    v_and_b32 v44, 3, v2
    v_add_u32 v44, s53, v44
    v_mul_u32_u24 v44, 896, v44
    v_lshrrev_b32 v45, 2, v0
    v_lshl_add_u32 v44, v45, 3, v44
    v_add_u32 v104, 28672, v44
    v_and_b32 v40, 1, v2
    v_cmp_eq_u32 s[16:17], 1, v40
    v_lshl_add_u32 v44, v1, 2, v40
    v_add_u32 v45, 2, v2
    v_cmp_ge_u32 s[18:19], v44, v45
    v_cmp_ge_u32 s[22:23], v44, v2
    v_mov_b32 v40, 0xffff
    v_mov_b32 v44, 0xffff0000
    v_cndmask_b32 v40, v40, v44, s[16:17]
    v_cndmask_b32 v152, 0, v40, s[18:19]
    v_cndmask_b32 v153, 0, v40, s[22:23]
    v_cndmask_b32 v154, v40, 0, s[18:19]
    v_cndmask_b32 v155, v40, 0, s[22:23]
    s_cmp_eq_u32 s62, 0
    s_cselect_b32 s3, 0, 1
    s_cselect_b32 s61, -1, 1
    s_lshl_b32 s58, s39, 1
    s_add_u32 s58, s58, s3
    s_add_u32 s59, s58, s61
    s_mul_i32 s58, s58, 3072
    s_add_u32 s58, s58, 2080768
    s_mul_i32 s59, s59, 3072
    s_add_u32 s59, s59, 2080768
    s_mul_i32 s3, s63, 1536
    s_add_u32 s58, s58, s3
    s_add_u32 s59, s59, s3
    v_mul_u32_u24 v105, 12, v0
    s_mul_i32 s3, s63, 384
    v_add_u32 v100, s3, v100
    v_add_u32 v101, s3, v101
    v_add_u32 v102, s3, v102
    v_add_u32 v103, s3, v103
    v_add_u32 v104, s3, v104
    s_mov_b32 s94, 1
    s_branch L_att
L_hAret:
    s_cmp_ge_u32 s39, 14
    s_cselect_b32 s47, 1, 0
    s_mul_i32 s3, s47, 14
    s_sub_u32 s48, s39, s3
    v_lshrrev_b32 v3, 3, v0
    v_and_b32 v4, 6, v3
    v_and_b32 v5, 7, v0
    v_xor_b32 v4, v4, v5
    v_lshlrev_b32 v4, 4, v4
    s_lshl_b32 s3, s44, 7
    v_add_u32 v4, s3, v4
    v_mul_u32_u24 v9, 1280, v3
    v_add_u32 v9, v9, v4
    s_lshl_b32 s3, s45, 2
    v_add_u32 v3, s3, v1
    v_lshlrev_b32 v4, 1, v3
    v_xor_b32 v4, v4, v2
    v_lshlrev_b32 v4, 4, v4
    v_mul_u32_u24 v11, 3456, v1
    v_add_u32 v11, v11, v4
    s_lshl_b32 s3, s48, 8
    v_add_u32 v11, s3, v11
    v_add_u32 v4, s3, v4
    v_mov_b32 v5, 1073741824
    v_cmp_gt_u32 vcc, 3456, v4
    s_nop 1
    v_cndmask_b32 v11, v5, v11, vcc
    s_mul_i32 s3, s56, 896
    s_add_u32 s3, s3, 0
    s_min_u32 s3, s3, 95360
    s_add_u32 s3, s3, 2265088
    s_add_u32 s52, s4, s3
    s_addc_u32 s53, s5, 0
    s_waitcnt lgkmcnt(0)
    s_load_dword s95, s[52:53], 0
    s_load_dword s95, s[52:53], 64
    s_load_dword s95, s[52:53], 128
    s_load_dword s95, s[52:53], 192
    s_load_dword s95, s[52:53], 256
    s_load_dword s95, s[52:53], 320
    s_load_dword s95, s[52:53], 384
    s_load_dword s95, s[52:53], 448
    s_load_dword s95, s[52:53], 512
    s_load_dword s95, s[52:53], 576
    s_load_dword s95, s[52:53], 640
    s_load_dword s95, s[52:53], 704
    s_load_dword s95, s[52:53], 768
    s_load_dword s95, s[52:53], 832
    s_mul_i32 s3, s56, 896
    s_add_u32 s3, s3, 53760
    s_min_u32 s3, s3, 95360
    s_add_u32 s3, s3, 2265088
    s_add_u32 s52, s4, s3
    s_addc_u32 s53, s5, 0
    s_waitcnt lgkmcnt(0)
    s_load_dword s95, s[52:53], 0
    s_load_dword s95, s[52:53], 64
    s_load_dword s95, s[52:53], 128
    s_load_dword s95, s[52:53], 192
    s_load_dword s95, s[52:53], 256
    s_load_dword s95, s[52:53], 320
    s_load_dword s95, s[52:53], 384
    s_load_dword s95, s[52:53], 448
    s_load_dword s95, s[52:53], 512
    s_load_dword s95, s[52:53], 576
    s_load_dword s95, s[52:53], 640
    s_load_dword s95, s[52:53], 704
    s_load_dword s95, s[52:53], 768
    s_load_dword s95, s[52:53], 832
    s_barrier
    s_mov_b32 s12, s26
    s_mov_b32 s13, s27
    s_mov_b32 s14, 819200
    s_mov_b32 s15, 0x20000
    s_sub_u32 s3, s40, 4
    s_mul_i32 s3, s3, 10240
    s_add_u32 s3, s3, 0
    buffer_load_dwordx4 v[40:43], v9, s[12:15], s3 offen
    s_add_u32 s3, s3, 40960
    buffer_load_dwordx4 v[44:47], v9, s[12:15], s3 offen
    s_add_u32 s3, s3, 40960
    buffer_load_dwordx4 v[48:51], v9, s[12:15], s3 offen
    s_add_u32 s3, s3, 40960
    buffer_load_dwordx4 v[52:55], v9, s[12:15], s3 offen
    s_add_u32 s3, s3, 40960
    buffer_load_dwordx4 v[56:59], v9, s[12:15], s3 offen
    s_add_u32 s3, s3, 40960
    buffer_load_dwordx4 v[60:63], v9, s[12:15], s3 offen
    s_add_u32 s3, s3, 40960
    buffer_load_dwordx4 v[64:67], v9, s[12:15], s3 offen
    s_add_u32 s3, s3, 40960
    buffer_load_dwordx4 v[68:71], v9, s[12:15], s3 offen
    s_add_u32 s3, s3, 40960
    buffer_load_dwordx4 v[72:75], v9, s[12:15], s3 offen
    s_add_u32 s3, s3, 40960
    buffer_load_dwordx4 v[76:79], v9, s[12:15], s3 offen
    s_add_u32 s3, s3, 40960
    buffer_load_dwordx4 v[80:83], v9, s[12:15], s3 offen
    s_add_u32 s3, s3, 40960
    buffer_load_dwordx4 v[84:87], v9, s[12:15], s3 offen
    s_add_u32 s3, s3, 40960
    s_barrier
    s_barrier
    s_sub_u32 s3, s40, 4
    s_lshl_b32 s3, s3, 10
    s_add_u32 s3, s3, 81920
    v_lshl_add_u32 v3, v0, 4, s3
    v_add_u32 v4, 40960, v3
    s_waitcnt vmcnt(0)
    ds_write_b128 v3, v[40:43] offset:0
    ds_write_b128 v3, v[44:47] offset:4096
    ds_write_b128 v3, v[48:51] offset:8192
    ds_write_b128 v3, v[52:55] offset:12288
    ds_write_b128 v3, v[56:59] offset:16384
    ds_write_b128 v3, v[60:63] offset:20480
    ds_write_b128 v3, v[64:67] offset:24576
    ds_write_b128 v3, v[68:71] offset:28672
    ds_write_b128 v3, v[72:75] offset:32768
    ds_write_b128 v3, v[76:79] offset:36864
    ds_write_b128 v4, v[80:83] offset:0
    ds_write_b128 v4, v[84:87] offset:4096
    s_waitcnt lgkmcnt(0)
    s_getpc_b64 s[52:53]
L_pc_30:
    s_mul_i32 s3, s56, 768
    s_sub_u32 s3, s3, L_pc_30-sequential_preLN__sliding_local_dilated__mixer_s_mlp__prompt_kernel
    s_add_u32 s52, s52, s3
    s_addc_u32 s53, s53, 0
    s_ashr_i32 s3, s3, 31
    s_add_u32 s53, s53, s3
    s_load_dword s95, s[52:53], 0
    s_load_dword s95, s[52:53], 64
    s_load_dword s95, s[52:53], 128
    s_load_dword s95, s[52:53], 192
    s_load_dword s95, s[52:53], 256
    s_load_dword s95, s[52:53], 320
    s_load_dword s95, s[52:53], 384
    s_load_dword s95, s[52:53], 448
    s_load_dword s95, s[52:53], 512
    s_load_dword s95, s[52:53], 576
    s_load_dword s95, s[52:53], 640
    s_load_dword s95, s[52:53], 704
    s_cmp_eq_u32 s43, 0
    s_cselect_b32 s41, 0, 10
    s_mul_i32 s57, s45, 3
    s_add_u32 s57, s57, s42
    s_mul_i32 s3, s57, 2560
    s_add_u32 s3, s3, 2269184
    v_lshlrev_b32 v20, 8, v1
    v_lshl_add_u32 v20, v2, 4, v20
    v_add_u32 v20, s3, v20
    v_mov_b32 v21, 1073741824
    v_cmp_gt_u32 vcc, 32, v0
    s_nop 1
    v_cndmask_b32 v21, v21, v20, vcc
    s_mov_b32 s62, 400000
    v_lshlrev_b32 v3, 3, v0
    s_lshl_b32 s3, s41, 1
    s_lshl_b32 s52, 20, 1
    s_bfm_b64 exec, s52, s3
L_po_31:
    buffer_load_dwordx2 v[126:127], v3, s[4:7], 0 offen offset:1024 sc1
    s_waitcnt vmcnt(0)
    v_and_b32 v126, v126, v127
    v_cmp_eq_u32 vcc, 0, v126
    s_cbranch_vccz L_pp_32
    s_sub_u32 s62, s62, 1
    s_cbranch_scc0 L_po_31
    s_endpgm
L_pp_32:
    s_mov_b64 exec, -1
    s_cmp_eq_u32 s50, 0
    s_cbranch_scc1 L_pq_33
    buffer_inv sc1
    s_waitcnt vmcnt(0)
L_pq_33:
    s_mov_b32 s52, 0
    buffer_load_dwordx4 v[40:43], v20, s[4:7], s52 offen sc1
    buffer_load_dwordx4 v[44:47], v20, s[4:7], s52 offen offset:1024 sc1
    buffer_load_dwordx4 v[48:51], v21, s[4:7], s52 offen offset:2048 sc1
    s_mov_b32 s52, 2560
    buffer_load_dwordx4 v[52:55], v20, s[4:7], s52 offen sc1
    buffer_load_dwordx4 v[56:59], v20, s[4:7], s52 offen offset:1024 sc1
    buffer_load_dwordx4 v[60:63], v21, s[4:7], s52 offen offset:2048 sc1
    s_mov_b32 s52, 5120
    buffer_load_dwordx4 v[64:67], v20, s[4:7], s52 offen sc1
    buffer_load_dwordx4 v[68:71], v20, s[4:7], s52 offen offset:1024 sc1
    buffer_load_dwordx4 v[72:75], v21, s[4:7], s52 offen offset:2048 sc1
    s_waitcnt vmcnt(0)
    v_pk_add_f32 v[40:41], v[40:41], v[42:43]
    v_pk_add_f32 v[44:45], v[44:45], v[46:47]
    v_pk_add_f32 v[48:49], v[48:49], v[50:51]
    v_pk_add_f32 v[52:53], v[52:53], v[54:55]
    v_pk_add_f32 v[56:57], v[56:57], v[58:59]
    v_pk_add_f32 v[60:61], v[60:61], v[62:63]
    v_pk_add_f32 v[64:65], v[64:65], v[66:67]
    v_pk_add_f32 v[68:69], v[68:69], v[70:71]
    v_pk_add_f32 v[72:73], v[72:73], v[74:75]
    v_pk_add_f32 v[40:41], v[40:41], v[44:45]
    v_pk_add_f32 v[52:53], v[52:53], v[56:57]
    v_pk_add_f32 v[64:65], v[64:65], v[68:69]
    v_pk_add_f32 v[40:41], v[40:41], v[48:49]
    v_pk_add_f32 v[52:53], v[52:53], v[60:61]
    v_pk_add_f32 v[64:65], v[64:65], v[72:73]
    v_mov_b32 v42, v40
    v_mov_b32 v43, v41
    v_mov_b32 v54, v52
    v_mov_b32 v55, v53
    v_mov_b32 v66, v64
    v_mov_b32 v67, v65
    v_permlane32_swap_b32 v40, v42
    v_permlane32_swap_b32 v41, v43
    v_permlane32_swap_b32 v52, v54
    v_permlane32_swap_b32 v53, v55
    v_permlane32_swap_b32 v64, v66
    v_permlane32_swap_b32 v65, v67
    v_pk_add_f32 v[40:41], v[40:41], v[42:43]
    v_pk_add_f32 v[52:53], v[52:53], v[54:55]
    v_pk_add_f32 v[64:65], v[64:65], v[66:67]
    v_mov_b32 v42, v40
    v_mov_b32 v43, v41
    v_mov_b32 v54, v52
    v_mov_b32 v55, v53
    v_mov_b32 v66, v64
    v_mov_b32 v67, v65
    v_permlane16_swap_b32 v40, v42
    v_permlane16_swap_b32 v41, v43
    v_permlane16_swap_b32 v52, v54
    v_permlane16_swap_b32 v53, v55
    v_permlane16_swap_b32 v64, v66
    v_permlane16_swap_b32 v65, v67
    v_pk_add_f32 v[40:41], v[40:41], v[42:43]
    v_pk_add_f32 v[52:53], v[52:53], v[54:55]
    v_pk_add_f32 v[64:65], v[64:65], v[66:67]
    v_mul_f32 v140, 0x3acccccd, v40
    v_mul_f32 v141, 0x3acccccd, v41
    v_mul_f32 v142, 0x3acccccd, v52
    v_mul_f32 v143, 0x3acccccd, v53
    v_mul_f32 v144, 0x3acccccd, v64
    v_mul_f32 v145, 0x3acccccd, v65
    v_fma_f32 v141, -v140, v140, v141
    v_fma_f32 v143, -v142, v142, v143
    v_fma_f32 v145, -v144, v144, v145
    v_max_f32 v141, 0, v141
    v_max_f32 v143, 0, v143
    v_max_f32 v145, 0, v145
    v_add_f32 v24, 0x3727c5ac, v141
    v_add_f32 v25, 0x3727c5ac, v143
    v_add_f32 v26, 0x3727c5ac, v145
    v_rsq_f32 v24, v24
    v_rsq_f32 v25, v25
    v_rsq_f32 v26, v26
    v_mul_f32 v28, v24, v24
    v_mul_f32 v29, v25, v25
    v_mul_f32 v30, v26, v26
    v_fmaak_f32 v28, v28, v141, 0x3727c5ac
    v_fmaak_f32 v29, v29, v143, 0x3727c5ac
    v_fmaak_f32 v30, v30, v145, 0x3727c5ac
    v_rsq_f32 v28, v28
    v_rsq_f32 v29, v29
    v_rsq_f32 v30, v30
    v_mov_b32 v141, v24
    v_mov_b32 v143, v25
    v_mov_b32 v145, v26
    v_mul_f32 v24, v24, v28
    v_mul_f32 v25, v25, v29
    v_mul_f32 v26, v26, v30
    v_mul_f32 v120, v24, v24
    v_rcp_f32 v122, v24
    v_mul_f32 v121, 0xc0135761, v24
    v_mul_f32 v120, v120, v24
    v_mul_f32 v120, 0xbdd2d3e8, v120
    v_mov_b32 v123, v140
    v_mul_f32 v124, v25, v25
    v_rcp_f32 v126, v25
    v_mul_f32 v125, 0xc0135761, v25
    v_mul_f32 v124, v124, v25
    v_mul_f32 v124, 0xbdd2d3e8, v124
    v_mov_b32 v127, v142
    v_mul_f32 v128, v26, v26
    v_rcp_f32 v130, v26
    v_mul_f32 v129, 0xc0135761, v26
    v_mul_f32 v128, v128, v26
    v_mul_f32 v128, 0xbdd2d3e8, v128
    v_mov_b32 v131, v144
    s_cmp_lg_u32 s44, 0
    s_cbranch_scc1 L_hs4
    s_lshl_b32 s3, s57, 7
    s_add_u32 s3, s3, 2265088
    v_lshl_add_u32 v22, v2, 3, s3
    s_cmp_eq_u32 s57, 11
    s_cbranch_scc1 L_hs3
    buffer_store_dwordx2 v[140:141], v22, s[4:7], 0 offen offset:0
L_hs3:
    buffer_store_dwordx2 v[142:143], v22, s[4:7], 0 offen offset:128
    buffer_store_dwordx2 v[144:145], v22, s[4:7], 0 offen offset:256
L_hs4:
    s_cmp_ge_u32 s39, 28
    s_cbranch_scc1 L_hA28a
    s_barrier
    s_mov_b32 s12, s28
    s_mov_b32 s13, s29
    s_mov_b32 s14, 2211840
    s_mov_b32 s15, 0x20000
    s_sub_u32 s3, s40, 4
    s_mul_i32 s3, s3, 13824
    s_add_u32 s3, s3, 0
    buffer_load_dwordx4 v[40:43], v11, s[12:15], s3 offen
    s_add_u32 s3, s3, 55296
    buffer_load_dwordx4 v[44:47], v11, s[12:15], s3 offen
    s_add_u32 s3, s3, 55296
    buffer_load_dwordx4 v[48:51], v11, s[12:15], s3 offen
    s_add_u32 s3, s3, 55296
    buffer_load_dwordx4 v[52:55], v11, s[12:15], s3 offen
    s_add_u32 s3, s3, 55296
    buffer_load_dwordx4 v[56:59], v11, s[12:15], s3 offen
    s_add_u32 s3, s3, 55296
    buffer_load_dwordx4 v[60:63], v11, s[12:15], s3 offen
    s_add_u32 s3, s3, 55296
    buffer_load_dwordx4 v[64:67], v11, s[12:15], s3 offen
    s_add_u32 s3, s3, 55296
    buffer_load_dwordx4 v[68:71], v11, s[12:15], s3 offen
    s_add_u32 s3, s3, 55296
    buffer_load_dwordx4 v[72:75], v11, s[12:15], s3 offen
    s_add_u32 s3, s3, 55296
    buffer_load_dwordx4 v[76:79], v11, s[12:15], s3 offen
    s_add_u32 s3, s3, 55296
    buffer_load_dwordx4 v[80:83], v11, s[12:15], s3 offen
    s_add_u32 s3, s3, 55296
    buffer_load_dwordx4 v[84:87], v11, s[12:15], s3 offen
    s_add_u32 s3, s3, 55296
    s_waitcnt vmcnt(12)
    s_mul_i32 s3, s45, 768
    s_add_u32 s3, s3, 16384
    v_lshl_add_u32 v22, v2, 4, s3
    ds_write_b128 v22, v[120:123] offset:0
    ds_write_b128 v22, v[124:127] offset:256
    ds_write_b128 v22, v[128:131] offset:512
    s_waitcnt lgkmcnt(0)
    s_barrier
    s_barrier
    s_sub_u32 s3, s40, 4
    s_lshl_b32 s3, s3, 10
    s_add_u32 s3, s3, 0
    v_lshl_add_u32 v3, v0, 4, s3
    v_add_u32 v4, 40960, v3
    s_waitcnt vmcnt(0)
    ds_write_b128 v3, v[40:43] offset:0
    ds_write_b128 v3, v[44:47] offset:4096
    ds_write_b128 v3, v[48:51] offset:8192
    ds_write_b128 v3, v[52:55] offset:12288
    ds_write_b128 v3, v[56:59] offset:16384
    ds_write_b128 v3, v[60:63] offset:20480
    ds_write_b128 v3, v[64:67] offset:24576
    ds_write_b128 v3, v[68:71] offset:28672
    ds_write_b128 v3, v[72:75] offset:32768
    ds_write_b128 v3, v[76:79] offset:36864
    ds_write_b128 v4, v[80:83] offset:0
    ds_write_b128 v4, v[84:87] offset:4096
    s_waitcnt lgkmcnt(0)
    s_barrier
    s_barrier
    s_barrier
    s_getpc_b64 s[52:53]
L_pc_34:
    s_mul_i32 s3, s56, 768
    s_sub_u32 s3, s3, L_pc_34-sequential_preLN__sliding_local_dilated__mixer_s_mlp__prompt_kernel
    s_add_u32 s52, s52, s3
    s_addc_u32 s53, s53, 0
    s_ashr_i32 s3, s3, 31
    s_add_u32 s53, s53, s3
    s_load_dword s95, s[52:53], 0
    s_load_dword s95, s[52:53], 64
    s_load_dword s95, s[52:53], 128
    s_load_dword s95, s[52:53], 192
    s_load_dword s95, s[52:53], 256
    s_load_dword s95, s[52:53], 320
    s_load_dword s95, s[52:53], 384
    s_load_dword s95, s[52:53], 448
    s_load_dword s95, s[52:53], 512
    s_load_dword s95, s[52:53], 576
    s_load_dword s95, s[52:53], 640
    s_load_dword s95, s[52:53], 704
    s_mul_i32 s41, s47, 10
    s_lshl_b32 s57, s47, 3
    s_lshl_b32 s3, s45, 2
    s_add_u32 s57, s57, s3
    s_mul_i32 s3, s57, 2560
    s_add_u32 s3, s3, 2315264
    v_lshlrev_b32 v20, 8, v1
    v_lshl_add_u32 v20, v2, 4, v20
    v_add_u32 v20, s3, v20
    v_mov_b32 v21, 1073741824
    v_cmp_gt_u32 vcc, 32, v0
    s_nop 1
    v_cndmask_b32 v21, v21, v20, vcc
    s_mov_b32 s62, 400000
    v_lshlrev_b32 v3, 3, v0
    s_lshl_b32 s3, s41, 1
    s_lshl_b32 s52, 20, 1
    s_bfm_b64 exec, s52, s3
L_po_35:
    buffer_load_dwordx2 v[126:127], v3, s[4:7], 0 offen offset:2048 sc1
    s_waitcnt vmcnt(0)
    v_and_b32 v126, v126, v127
    v_cmp_eq_u32 vcc, 0, v126
    s_cbranch_vccz L_pp_36
    s_sub_u32 s62, s62, 1
    s_cbranch_scc0 L_po_35
    s_endpgm
L_pp_36:
    s_mov_b64 exec, -1
    s_cmp_eq_u32 s50, 0
    s_cbranch_scc1 L_pq_37
    buffer_inv sc1
    s_waitcnt vmcnt(0)
L_pq_37:
    s_mov_b32 s52, 0
    buffer_load_dwordx4 v[40:43], v20, s[4:7], s52 offen sc1
    buffer_load_dwordx4 v[44:47], v20, s[4:7], s52 offen offset:1024 sc1
    buffer_load_dwordx4 v[48:51], v21, s[4:7], s52 offen offset:2048 sc1
    s_mov_b32 s52, 2560
    buffer_load_dwordx4 v[52:55], v20, s[4:7], s52 offen sc1
    buffer_load_dwordx4 v[56:59], v20, s[4:7], s52 offen offset:1024 sc1
    buffer_load_dwordx4 v[60:63], v21, s[4:7], s52 offen offset:2048 sc1
    s_mov_b32 s52, 5120
    buffer_load_dwordx4 v[64:67], v20, s[4:7], s52 offen sc1
    buffer_load_dwordx4 v[68:71], v20, s[4:7], s52 offen offset:1024 sc1
    buffer_load_dwordx4 v[72:75], v21, s[4:7], s52 offen offset:2048 sc1
    s_mov_b32 s52, 7680
    buffer_load_dwordx4 v[76:79], v20, s[4:7], s52 offen sc1
    buffer_load_dwordx4 v[80:83], v20, s[4:7], s52 offen offset:1024 sc1
    buffer_load_dwordx4 v[84:87], v21, s[4:7], s52 offen offset:2048 sc1
    s_waitcnt vmcnt(0)
    v_pk_add_f32 v[40:41], v[40:41], v[42:43]
    v_pk_add_f32 v[44:45], v[44:45], v[46:47]
    v_pk_add_f32 v[48:49], v[48:49], v[50:51]
    v_pk_add_f32 v[52:53], v[52:53], v[54:55]
    v_pk_add_f32 v[56:57], v[56:57], v[58:59]
    v_pk_add_f32 v[60:61], v[60:61], v[62:63]
    v_pk_add_f32 v[64:65], v[64:65], v[66:67]
    v_pk_add_f32 v[68:69], v[68:69], v[70:71]
    v_pk_add_f32 v[72:73], v[72:73], v[74:75]
    v_pk_add_f32 v[76:77], v[76:77], v[78:79]
    v_pk_add_f32 v[80:81], v[80:81], v[82:83]
    v_pk_add_f32 v[84:85], v[84:85], v[86:87]
    v_pk_add_f32 v[40:41], v[40:41], v[44:45]
    v_pk_add_f32 v[52:53], v[52:53], v[56:57]
    v_pk_add_f32 v[64:65], v[64:65], v[68:69]
    v_pk_add_f32 v[76:77], v[76:77], v[80:81]
    v_pk_add_f32 v[40:41], v[40:41], v[48:49]
    v_pk_add_f32 v[52:53], v[52:53], v[60:61]
    v_pk_add_f32 v[64:65], v[64:65], v[72:73]
    v_pk_add_f32 v[76:77], v[76:77], v[84:85]
    v_mov_b32 v42, v40
    v_mov_b32 v43, v41
    v_mov_b32 v54, v52
    v_mov_b32 v55, v53
    v_mov_b32 v66, v64
    v_mov_b32 v67, v65
    v_mov_b32 v78, v76
    v_mov_b32 v79, v77
    v_permlane32_swap_b32 v40, v42
    v_permlane32_swap_b32 v41, v43
    v_permlane32_swap_b32 v52, v54
    v_permlane32_swap_b32 v53, v55
    v_permlane32_swap_b32 v64, v66
    v_permlane32_swap_b32 v65, v67
    v_permlane32_swap_b32 v76, v78
    v_permlane32_swap_b32 v77, v79
    v_pk_add_f32 v[40:41], v[40:41], v[42:43]
    v_pk_add_f32 v[52:53], v[52:53], v[54:55]
    v_pk_add_f32 v[64:65], v[64:65], v[66:67]
    v_pk_add_f32 v[76:77], v[76:77], v[78:79]
    v_mov_b32 v42, v40
    v_mov_b32 v43, v41
    v_mov_b32 v54, v52
    v_mov_b32 v55, v53
    v_mov_b32 v66, v64
    v_mov_b32 v67, v65
    v_mov_b32 v78, v76
    v_mov_b32 v79, v77
    v_permlane16_swap_b32 v40, v42
    v_permlane16_swap_b32 v41, v43
    v_permlane16_swap_b32 v52, v54
    v_permlane16_swap_b32 v53, v55
    v_permlane16_swap_b32 v64, v66
    v_permlane16_swap_b32 v65, v67
    v_permlane16_swap_b32 v76, v78
    v_permlane16_swap_b32 v77, v79
    v_pk_add_f32 v[40:41], v[40:41], v[42:43]
    v_pk_add_f32 v[52:53], v[52:53], v[54:55]
    v_pk_add_f32 v[64:65], v[64:65], v[66:67]
    v_pk_add_f32 v[76:77], v[76:77], v[78:79]
    v_mul_f32 v140, 0x3acccccd, v40
    v_mul_f32 v141, 0x3acccccd, v41
    v_mul_f32 v142, 0x3acccccd, v52
    v_mul_f32 v143, 0x3acccccd, v53
    v_mul_f32 v144, 0x3acccccd, v64
    v_mul_f32 v145, 0x3acccccd, v65
    v_mul_f32 v146, 0x3acccccd, v76
    v_mul_f32 v147, 0x3acccccd, v77
    v_fma_f32 v141, -v140, v140, v141
    v_fma_f32 v143, -v142, v142, v143
    v_fma_f32 v145, -v144, v144, v145
    v_fma_f32 v147, -v146, v146, v147
    v_max_f32 v141, 0, v141
    v_max_f32 v143, 0, v143
    v_max_f32 v145, 0, v145
    v_max_f32 v147, 0, v147
    v_add_f32 v24, 0x3727c5ac, v141
    v_add_f32 v25, 0x3727c5ac, v143
    v_add_f32 v26, 0x3727c5ac, v145
    v_add_f32 v27, 0x3727c5ac, v147
    v_rsq_f32 v24, v24
    v_rsq_f32 v25, v25
    v_rsq_f32 v26, v26
    v_rsq_f32 v27, v27
    v_mul_f32 v120, v24, v24
    v_rcp_f32 v122, v24
    v_mul_f32 v121, 0xc0135761, v24
    v_mul_f32 v120, v120, v24
    v_mul_f32 v120, 0xbdd2d3e8, v120
    v_mov_b32 v123, v140
    v_mul_f32 v124, v25, v25
    v_rcp_f32 v126, v25
    v_mul_f32 v125, 0xc0135761, v25
    v_mul_f32 v124, v124, v25
    v_mul_f32 v124, 0xbdd2d3e8, v124
    v_mov_b32 v127, v142
    v_mul_f32 v128, v26, v26
    v_rcp_f32 v130, v26
    v_mul_f32 v129, 0xc0135761, v26
    v_mul_f32 v128, v128, v26
    v_mul_f32 v128, 0xbdd2d3e8, v128
    v_mov_b32 v131, v144
    v_mul_f32 v132, v27, v27
    v_rcp_f32 v134, v27
    v_mul_f32 v133, 0xc0135761, v27
    v_mul_f32 v132, v132, v27
    v_mul_f32 v132, 0xbdd2d3e8, v132
    v_mov_b32 v135, v146
    s_barrier
    s_barrier
    s_mul_i32 s3, s45, 1024
    s_add_u32 s3, s3, 140288
    v_lshl_add_u32 v22, v2, 4, s3
    ds_write_b128 v22, v[120:123] offset:0
    ds_write_b128 v22, v[124:127] offset:256
    ds_write_b128 v22, v[128:131] offset:512
    ds_write_b128 v22, v[132:135] offset:768
    s_waitcnt lgkmcnt(0)
    s_barrier
    s_barrier
    s_branch L_hA7
L_hA28a:
    s_barrier
    s_mul_i32 s3, s45, 768
    s_add_u32 s3, s3, 16384
    v_lshl_add_u32 v22, v2, 4, s3
    ds_write_b128 v22, v[120:123] offset:0
    ds_write_b128 v22, v[124:127] offset:256
    ds_write_b128 v22, v[128:131] offset:512
    s_waitcnt lgkmcnt(0)
    s_waitcnt vmcnt(0)
    s_barrier
    s_barrier
    s_barrier
    s_barrier
    s_barrier
L_hA28:
    s_barrier
    s_barrier
L_hA7:
    s_lshl_b32 s3, s45, 10
    s_add_u32 s3, s3, 0
    v_lshl_add_u32 v3, v0, 4, s3
    s_waitcnt vmcnt(0)
    s_barrier
    s_barrier
    s_barrier
    s_branch L_hfin
L_hidle:
    s_waitcnt lgkmcnt(0)
    s_lshl_b32 s3, s38, 22
    s_add_u32 s4, s36, s3
    s_addc_u32 s5, s37, 0
    s_mov_b32 s6, 4194304
    s_mov_b32 s7, 0x20000
    s_cmp_ge_u32 s40, 6
    s_cbranch_scc1 L_hidle2
    s_lshl_b32 s56, s39, 1
    s_add_u32 s56, s56, s45
    s_getpc_b64 s[52:53]
L_pc_38:
    s_mul_i32 s3, s56, 768
    s_sub_u32 s3, s3, L_pc_38-sequential_preLN__sliding_local_dilated__mixer_s_mlp__prompt_kernel
    s_add_u32 s52, s52, s3
    s_addc_u32 s53, s53, 0
    s_ashr_i32 s3, s3, 31
    s_add_u32 s53, s53, s3
    s_load_dword s95, s[52:53], 0
    s_load_dword s95, s[52:53], 64
    s_load_dword s95, s[52:53], 128
    s_load_dword s95, s[52:53], 192
    s_load_dword s95, s[52:53], 256
    s_load_dword s95, s[52:53], 320
    s_load_dword s95, s[52:53], 384
    s_load_dword s95, s[52:53], 448
    s_load_dword s95, s[52:53], 512
    s_load_dword s95, s[52:53], 576
    s_load_dword s95, s[52:53], 640
    s_load_dword s95, s[52:53], 704
L_hidle2:
    s_barrier
L_agent:
    s_and_b32 s58, s39, 1
    s_lshl_b32 s58, s58, 3
    s_add_u32 s58, s58, s40
    s_lshl_b32 s3, s58, 6
    v_add_u32 v20, s3, v0
    s_mov_b32 s3, 16384
    s_mov_b32 s49, 3
L_vt_39:
    v_min_u32 v21, 2879, v20
    v_lshlrev_b32 v21, 7, v21
    s_waitcnt vmcnt(2)
    buffer_load_dword v22, v21, s[4:7], s3 offen sc1
    v_add_u32 v20, 1024, v20
    s_sub_u32 s49, s49, 1
    s_cmp_lg_u32 s49, 0
    s_cbranch_scc1 L_vt_39
    s_mov_b32 s12, s26
    s_mov_b32 s13, s27
    s_mov_b32 s14, 819200
    s_mov_b32 s15, 0x20000
    s_lshl_b32 s3, s58, 6
    v_add_u32 v20, s3, v0
    s_mov_b32 s3, 0
    s_mov_b32 s49, 7
    s_mul_i32 s52, s38, 7
    s_lshr_b32 s52, s52, 3
    s_mul_i32 s53, s52, 1024
    v_add_u32 v20, s53, v20
L_vt_40:
    s_cmp_lg_u32 s52, 7
    s_cbranch_scc1 L_vw_41
    v_subrev_u32 v20, 7168, v20
L_vw_41:
    s_add_u32 s52, s52, 1
    v_min_u32 v21, 6399, v20
    v_lshlrev_b32 v21, 7, v21
    s_waitcnt vmcnt(2)
    buffer_load_dword v22, v21, s[12:15], s3 offen sc1
    v_add_u32 v20, 1024, v20
    s_sub_u32 s49, s49, 1
    s_cmp_lg_u32 s49, 0
    s_cbranch_scc1 L_vt_40
    s_mov_b32 s12, s28
    s_mov_b32 s13, s29
    s_mov_b32 s14, 2211840
    s_mov_b32 s15, 0x20000
    s_lshl_b32 s3, s58, 6
    v_add_u32 v20, s3, v0
    s_mov_b32 s3, 0
    s_mov_b32 s49, 9
    s_mul_i32 s52, s38, 9
    s_lshr_b32 s52, s52, 3
    s_mul_i32 s53, s52, 1024
    v_add_u32 v20, s53, v20
L_vt_42:
    s_cmp_lg_u32 s52, 9
    s_cbranch_scc1 L_vw_43
    v_subrev_u32 v20, 9216, v20
L_vw_43:
    s_add_u32 s52, s52, 1
    v_min_u32 v21, 8639, v20
    v_lshlrev_b32 v21, 7, v21
    s_waitcnt vmcnt(2)
    buffer_load_dword v22, v21, s[12:15], s3 offen sc1
    v_add_u32 v20, 1024, v20
    s_sub_u32 s49, s49, 1
    s_cmp_lg_u32 s49, 0
    s_cbranch_scc1 L_vt_42
    s_mov_b32 s12, s28
    s_mov_b32 s13, s29
    s_mov_b32 s14, 2211840
    s_mov_b32 s15, 0x20000
    s_lshl_b32 s3, s58, 6
    v_add_u32 v20, s3, v0
    s_mov_b32 s3, 1105920
    s_mov_b32 s49, 9
    s_mul_i32 s52, s38, 9
    s_lshr_b32 s52, s52, 3
    s_mul_i32 s53, s52, 1024
    v_add_u32 v20, s53, v20
L_vt_44:
    s_cmp_lg_u32 s52, 9
    s_cbranch_scc1 L_vw_45
    v_subrev_u32 v20, 9216, v20
L_vw_45:
    s_add_u32 s52, s52, 1
    v_min_u32 v21, 8639, v20
    v_lshlrev_b32 v21, 7, v21
    s_waitcnt vmcnt(2)
    buffer_load_dword v22, v21, s[12:15], s3 offen sc1
    v_add_u32 v20, 1024, v20
    s_sub_u32 s49, s49, 1
    s_cmp_lg_u32 s49, 0
    s_cbranch_scc1 L_vt_44
    s_mov_b32 s12, s30
    s_mov_b32 s13, s31
    s_mov_b32 s14, 2211840
    s_mov_b32 s15, 0x20000
    s_lshl_b32 s3, s58, 6
    v_add_u32 v20, s3, v0
    s_mov_b32 s3, 1638400
    s_mov_b32 s49, 5
    s_mul_i32 s52, s38, 5
    s_lshr_b32 s52, s52, 3
    s_mul_i32 s53, s52, 1024
    v_add_u32 v20, s53, v20
L_vt_46:
    s_cmp_lg_u32 s52, 5
    s_cbranch_scc1 L_vw_47
    v_subrev_u32 v20, 5120, v20
L_vw_47:
    s_add_u32 s52, s52, 1
    v_min_u32 v21, 4479, v20
    v_lshlrev_b32 v21, 7, v21
    s_waitcnt vmcnt(2)
    buffer_load_dword v22, v21, s[12:15], s3 offen sc1
    v_add_u32 v20, 1024, v20
    s_sub_u32 s49, s49, 1
    s_cmp_lg_u32 s49, 0
    s_cbranch_scc1 L_vt_46
L_hfin:
L_end:
    s_endpgm
L_compute:
    s_lshl_b32 s3, s39, 4
    s_lshl_b32 s49, s40, 2
    s_add_u32 s3, s3, s49
    v_mov_b32 v135, s3
    v_add_u32 v3, s3, v1
    v_lshlrev_b32 v134, 3, v3
    v_add_u32 v134, 3072, v134
    s_lshl_b32 s3, s38, 8
    s_sub_u32 s3, s3, 24
    v_add_u32 v3, s3, v3
    v_max_i32 v3, 0, v3
    v_min_i32 v3, 2047, v3
    v_mul_u32_u24 v3, 1280, v3
    v_lshl_add_u32 v3, v2, 4, v3
    s_waitcnt lgkmcnt(0)
    s_mov_b32 s8, s16
    s_mov_b32 s9, s17
    s_mov_b32 s10, 2621440
    s_mov_b32 s11, 0x20000
    s_cmp_ge_u32 s39, 18
    s_cbranch_scc1 L_p0a
    buffer_load_dwordx4 v[8:11], v3, s[8:11], 0 offen offset:0
    buffer_load_dwordx4 v[12:15], v3, s[8:11], 0 offen offset:256
    buffer_load_dwordx4 v[16:19], v3, s[8:11], 0 offen offset:512
    buffer_load_dwordx4 v[20:23], v3, s[8:11], 0 offen offset:768
    buffer_load_dwordx4 v[24:27], v3, s[8:11], 0 offen offset:1024
L_p0a:
    s_lshl_b32 s3, s38, 22
    s_add_u32 s4, s36, s3
    s_addc_u32 s5, s37, 0
    s_mov_b32 s6, 4194304
    s_mov_b32 s7, 0x20000
    s_cmp_ge_u32 s39, 14
    s_cselect_b32 s47, 1, 0
    s_mul_i32 s3, s47, 14
    s_sub_u32 s48, s39, s3
    s_lshr_b32 s45, s40, 1
    s_and_b32 s46, s40, 1
    s_lshl_b32 s3, s38, 5
    v_mov_b32 v128, s3
    v_mov_b32 v28, 0
    v_mov_b32 v29, 0
    v_mov_b32 v30, 0
    v_mov_b32 v31, 0
    v_mov_b32 v32, 0
    s_cmp_ge_u32 s39, 30
    s_cbranch_scc1 L_p1idle
    v_lshrrev_b32 v40, 1, v2
    v_xor_b32 v40, v40, v1
    v_lshlrev_b32 v40, 4, v40
    v_lshl_add_u32 v3, v2, 7, v40
    v_xor_b32 v4, 64, v3
    v_lshrrev_b32 v40, 3, v2
    v_and_b32 v41, 1, v1
    v_lshl_or_b32 v41, v41, 1, v40
    v_xor_b32 v41, s40, v41
    v_lshlrev_b32 v41, 5, v41
    v_lshrrev_b32 v40, 2, v2
    v_lshl_add_u32 v40, v1, 3, v40
    v_lshl_add_u32 v41, v40, 7, v41
    v_and_b32 v40, 3, v2
    v_lshl_add_u32 v41, v40, 3, v41
    v_add_u32 v5, 14336, v41
    v_mov_b32 v7, 0x3f803f80
    v_cmp_eq_u32 s[54:55], 0, v2
    v_lshlrev_b32 v110, 3, v2
    v_add_u32 v110, 65536, v110
    v_lshlrev_b32 v108, 4, v0
    s_lshl_b32 s3, s40, 2
    v_add_u32 v6, s3, v1
    v_mul_u32_u24 v6, 896, v6
    v_lshl_add_u32 v6, v2, 3, v6
    s_lshl_b32 s62, s40, 2
    s_lshr_b32 s62, 0x21303210, s62
    s_and_b32 s62, s62, 3
    s_lshr_b32 s63, s40, 2
    s_cmp_ge_u32 s44, 5
    s_cselect_b32 s3, 5, 0
    s_sub_u32 s3, s44, s3
    s_sub_u32 s52, 5, s3
    s_mul_i32 s3, s62, 5
    s_add_u32 s3, s3, s52
    s_sub_u32 s53, s3, 5
    s_min_u32 s3, s3, 16
    s_cmp_eq_u32 s62, 0
    s_cselect_b32 s53, 0, s53
    s_sub_u32 s41, s3, s53
    v_add_u32 v40, s53, v1
    v_mul_u32_u24 v100, 896, v40
    v_mov_b32 v42, 45056
    v_cmp_gt_u32 vcc, s41, v1
    v_add_u32 v102, 14336, v100
    s_nop 0
    v_cndmask_b32 v100, v42, v100, vcc
    v_cndmask_b32 v102, v42, v102, vcc
    v_lshl_add_u32 v100, v2, 3, v100
    v_lshl_add_u32 v102, v2, 3, v102
    v_mov_b32 v43, 1073741824
    s_lshl_b32 s3, s44, 4
    v_add_u32 v40, s3, v40
    s_mul_i32 s61, s63, 3
    s_add_u32 s61, s61, s42
    s_lshl_b32 s61, s61, 8
    s_add_u32 s61, s61, 16384
    v_lshrrev_b32 v44, 3, v40
    v_lshlrev_b32 v44, 2, v44
    v_and_or_b32 v44, v40, 3, v44
    v_mul_u32_u24 v44, 4608, v44
    v_and_b32 v45, 4, v40
    v_lshl_add_u32 v44, v45, 1, v44
    v_lshl_add_u32 v44, v2, 4, v44
    v_add_u32 v44, s61, v44
    v_cndmask_b32 v156, v43, v44, vcc
    s_cmp_eq_u32 s41, 5
    s_cselect_b32 s3, 16, 0
    v_cmp_gt_u32 vcc, s3, v0
    v_add_u32 v40, 4, v40
    v_lshrrev_b32 v44, 3, v40
    v_lshlrev_b32 v44, 2, v44
    v_and_or_b32 v44, v40, 3, v44
    v_mul_u32_u24 v44, 4608, v44
    v_and_b32 v45, 4, v40
    v_lshl_add_u32 v44, v45, 1, v44
    v_lshl_add_u32 v44, v2, 4, v44
    v_add_u32 v44, s61, v44
    v_cndmask_b32 v157, v43, v44, vcc
    s_add_u32 s3, s53, 4
    s_mul_i32 s3, s3, 896
    v_mov_b32 v44, s3
    v_add_u32 v45, 14336, v44
    v_cndmask_b32 v44, v42, v44, vcc
    v_cndmask_b32 v45, v42, v45, vcc
    v_lshl_add_u32 v101, v2, 3, v44
    v_lshl_add_u32 v103, v2, 3, v45
    v_and_b32 v44, 3, v2
    v_add_u32 v44, s53, v44
    v_mul_u32_u24 v44, 896, v44
    v_lshrrev_b32 v45, 2, v0
    v_lshl_add_u32 v44, v45, 3, v44
    v_add_u32 v104, 28672, v44
    v_and_b32 v40, 1, v2
    v_cmp_eq_u32 s[16:17], 1, v40
    v_lshl_add_u32 v44, v1, 2, v40
    v_add_u32 v45, 2, v2
    v_cmp_ge_u32 s[18:19], v44, v45
    v_cmp_ge_u32 s[22:23], v44, v2
    v_mov_b32 v40, 0xffff
    v_mov_b32 v44, 0xffff0000
    v_cndmask_b32 v40, v40, v44, s[16:17]
    v_cndmask_b32 v152, 0, v40, s[18:19]
    v_cndmask_b32 v153, 0, v40, s[22:23]
    v_cndmask_b32 v154, v40, 0, s[18:19]
    v_cndmask_b32 v155, v40, 0, s[22:23]
    s_cmp_eq_u32 s62, 0
    s_cselect_b32 s3, 0, 1
    s_cselect_b32 s61, -1, 1
    s_lshl_b32 s58, s39, 1
    s_add_u32 s58, s58, s3
    s_add_u32 s59, s58, s61
    s_mul_i32 s58, s58, 3072
    s_add_u32 s58, s58, 2080768
    s_mul_i32 s59, s59, 3072
    s_add_u32 s59, s59, 2080768
    s_mul_i32 s3, s63, 1536
    s_add_u32 s58, s58, s3
    s_add_u32 s59, s59, s3
    v_mul_u32_u24 v105, 12, v0
    s_mul_i32 s3, s63, 384
    v_add_u32 v100, s3, v100
    v_add_u32 v101, s3, v101
    v_add_u32 v102, s3, v102
    v_add_u32 v103, s3, v103
    v_add_u32 v104, s3, v104
    s_mul_i32 s57, s43, 5
    s_mul_i32 s3, s45, 3
    s_add_u32 s56, s42, s3
    s_add_u32 s57, s57, s3
    v_and_b32 v151, 1, v1
    v_lshlrev_b32 v151, 5, v151
    v_lshrrev_b32 v40, 1, v1
    v_lshl_add_u32 v151, v40, 4, v151
    s_lshl_b32 s3, s44, 7
    s_lshl_b32 s61, s46, 6
    s_add_u32 s3, s3, s61
    v_add_u32 v151, s3, v151
    s_lshl_b32 s3, s56, 4
    s_lshl_b32 s61, s38, 8
    s_add_u32 s3, s3, s61
    s_sub_u32 s3, s3, 8
    v_add_u32 v40, s3, v2
    s_movk_i32 s3, 2047
    v_mov_b32 v42, 1280
    v_med3_i32 v41, 0, v40, s3
    v_mad_u32_u24 v148, v41, v42, v151
    v_add_u32 v40, 16, v40
    v_med3_i32 v41, 0, v40, s3
    v_mad_u32_u24 v149, v41, v42, v151
    v_add_u32 v40, 16, v40
    v_med3_i32 v41, 0, v40, s3
    v_mad_u32_u24 v150, v41, v42, v151
    v_add_u32 v40, 16, v40
    v_mov_b32 v151, v151
    v_mov_b32 v136, 0x3f803f80
    v_mov_b32 v137, 0x3f803f80
    v_mov_b32 v138, 0x3f803f80
    v_mov_b32 v139, 0x3f803f80
    v_mov_b32 v33, 0
    v_mov_b32 v34, 0
    v_mov_b32 v35, 0
    v_mov_b32 v36, 0
    v_mov_b32 v37, 0
    v_mov_b32 v38, 0
    v_mov_b32 v39, 0
    v_mov_b32 v40, 0
    v_mov_b32 v41, 0
    v_mov_b32 v42, 0
    v_mov_b32 v43, 0
    v_mov_b32 v44, 0
    v_mov_b32 v45, 0
    v_mov_b32 v46, 0
    v_mov_b32 v47, 0
    v_mov_b32 v48, 0
    v_mov_b32 v49, 0
    v_mov_b32 v50, 0
    v_mov_b32 v51, 0
    v_mov_b32 v52, 0
    v_mov_b32 v53, 0
    v_mov_b32 v54, 0
    v_mov_b32 v55, 0
    v_mov_b32 v56, 0
    v_mov_b32 v57, 0
    v_mov_b32 v58, 0
    v_mov_b32 v59, 0
    v_mov_b32 v60, 0
    v_mov_b32 v61, 0
    v_mov_b32 v62, 0
    v_mov_b32 v63, 0
    v_mov_b32 v64, 0
    v_mov_b32 v65, 0
    v_mov_b32 v66, 0
    v_mov_b32 v67, 0
    v_mov_b32 v68, 0
    v_mov_b32 v69, 0
    v_mov_b32 v70, 0
    v_mov_b32 v71, 0
    v_mov_b32 v72, 0
    v_mov_b32 v73, 0
    v_mov_b32 v74, 0
    v_mov_b32 v75, 0
    v_mov_b32 v76, 0
    v_mov_b32 v77, 0
    v_mov_b32 v78, 0
    v_mov_b32 v79, 0
    v_mov_b32 v80, 0
    v_mov_b32 v81, 0
    v_mov_b32 v82, 0
    v_mov_b32 v83, 0
    v_mov_b32 v84, 0
    v_mov_b32 v85, 0
    v_mov_b32 v86, 0
    v_mov_b32 v87, 0
    v_mov_b32 v88, 0
    v_mov_b32 v89, 0
    v_mov_b32 v90, 0
    v_mov_b32 v91, 0
    s_cmp_ge_u32 s39, 18
    s_cbranch_scc1 L_p0done
    s_waitcnt vmcnt(0)
    v_dot2_f32_bf16 v28, v8, v7, v28
    v_dot2_f32_bf16 v29, v8, v8, v29
    v_dot2_f32_bf16 v31, v9, v7, v31
    v_dot2_f32_bf16 v32, v9, v9, v32
    v_dot2_f32_bf16 v28, v10, v7, v28
    v_dot2_f32_bf16 v29, v10, v10, v29
    v_dot2_f32_bf16 v31, v11, v7, v31
    v_dot2_f32_bf16 v32, v11, v11, v32
    v_dot2_f32_bf16 v28, v12, v7, v28
    v_dot2_f32_bf16 v29, v12, v12, v29
    v_dot2_f32_bf16 v31, v13, v7, v31
    v_dot2_f32_bf16 v32, v13, v13, v32
    v_dot2_f32_bf16 v28, v14, v7, v28
    v_dot2_f32_bf16 v29, v14, v14, v29
    v_dot2_f32_bf16 v31, v15, v7, v31
    v_dot2_f32_bf16 v32, v15, v15, v32
    v_dot2_f32_bf16 v28, v16, v7, v28
    v_dot2_f32_bf16 v29, v16, v16, v29
    v_dot2_f32_bf16 v31, v17, v7, v31
    v_dot2_f32_bf16 v32, v17, v17, v32
    v_dot2_f32_bf16 v28, v18, v7, v28
    v_dot2_f32_bf16 v29, v18, v18, v29
    v_dot2_f32_bf16 v31, v19, v7, v31
    v_dot2_f32_bf16 v32, v19, v19, v32
    v_dot2_f32_bf16 v28, v20, v7, v28
    v_dot2_f32_bf16 v29, v20, v20, v29
    v_dot2_f32_bf16 v31, v21, v7, v31
    v_dot2_f32_bf16 v32, v21, v21, v32
    v_dot2_f32_bf16 v28, v22, v7, v28
    v_dot2_f32_bf16 v29, v22, v22, v29
    v_dot2_f32_bf16 v31, v23, v7, v31
    v_dot2_f32_bf16 v32, v23, v23, v32
    v_dot2_f32_bf16 v28, v24, v7, v28
    v_dot2_f32_bf16 v29, v24, v24, v29
    v_dot2_f32_bf16 v31, v25, v7, v31
    v_dot2_f32_bf16 v32, v25, v25, v32
    v_dot2_f32_bf16 v28, v26, v7, v28
    v_dot2_f32_bf16 v29, v26, v26, v29
    v_dot2_f32_bf16 v31, v27, v7, v31
    v_dot2_f32_bf16 v32, v27, v27, v32
    s_nop 1
    v_add_f32 v28, v28, v31
    v_add_f32 v29, v29, v32
    s_nop 0
    v_add_f32_dpp v28, v28, v28 row_ror:8 row_mask:0xf bank_mask:0xf
    v_add_f32_dpp v29, v29, v29 row_ror:8 row_mask:0xf bank_mask:0xf
    s_nop 0
    v_add_f32_dpp v28, v28, v28 row_ror:4 row_mask:0xf bank_mask:0xf
    v_add_f32_dpp v29, v29, v29 row_ror:4 row_mask:0xf bank_mask:0xf
    s_nop 0
    v_add_f32_dpp v28, v28, v28 row_ror:2 row_mask:0xf bank_mask:0xf
    v_add_f32_dpp v29, v29, v29 row_ror:2 row_mask:0xf bank_mask:0xf
    s_nop 0
    v_add_f32_dpp v28, v28, v28 row_ror:1 row_mask:0xf bank_mask:0xf
    v_add_f32_dpp v29, v29, v29 row_ror:1 row_mask:0xf bank_mask:0xf
    v_mul_f32 v132, 0x3acccccd, v28
    v_mul_f32 v29, 0x3acccccd, v29
    v_fma_f32 v29, -v132, v132, v29
    v_max_f32 v29, 0, v29
    v_add_f32 v29, 0x3727c5ac, v29
    v_rsq_f32 v29, v29
    s_nop 0
    v_or_b32 v133, 1, v29
L_p0done:
    v_mov_b32 v8, 0
    v_mov_b32 v9, 0
    v_mov_b32 v10, 0
    v_mov_b32 v11, 0
    v_mov_b32 v12, 0
    v_mov_b32 v13, 0
    v_mov_b32 v14, 0
    v_mov_b32 v15, 0
    v_mov_b32 v16, 0
    v_mov_b32 v17, 0
    v_mov_b32 v18, 0
    v_mov_b32 v19, 0
    v_mov_b32 v20, 0
    v_mov_b32 v21, 0
    v_mov_b32 v22, 0
    v_mov_b32 v23, 0
    v_mov_b32 v24, 0
    v_mov_b32 v25, 0
    v_mov_b32 v26, 0
    v_mov_b32 v27, 0
    v_mov_b32 v28, 0
    v_mov_b32 v29, 0
    v_mov_b32 v30, 0
    v_mov_b32 v31, 0
    v_mov_b32 v32, 0
    s_mov_b32 s49, 0
    s_cmp_lt_u32 s39, 18
    s_cselect_b32 s60, 2, -1
    s_movk_i32 s61, 0x124
    s_waitcnt lgkmcnt(0)
    s_barrier
    ds_read_b64_tr_b16 a[48:49], v5 offset:0
    ds_read_b64_tr_b16 a[50:51], v5 offset:512
    ds_read_b64_tr_b16 a[52:53], v5 offset:8192
    ds_read_b64_tr_b16 a[54:55], v5 offset:8704
    ds_read_b64_tr_b16 a[56:57], v5 offset:16384
    ds_read_b64_tr_b16 a[58:59], v5 offset:16896
    ds_read_b128 a[0:3], v3 offset:2048
    ds_read_b128 a[4:7], v3 offset:4096
    ds_read_b128 a[8:11], v3 offset:6144
    ds_read_b128 a[12:15], v3 offset:8192
    ds_read_b128 a[16:19], v3 offset:10240
    ds_read_b128 a[20:23], v3 offset:12288
    ds_read_b128 v[92:95], v3 offset:0
L_p1loop:
    s_cmp_lg_u32 s60, s49
    s_cbranch_scc1 L_p1back
    buffer_store_dwordx2 v[132:133], v134, s[4:7], 0 offen sc1
L_p1back:
    s_bitcmp1_b32 s61, s49
    s_mov_b32 s63, 38912
    s_cmov_b32 s63, 4294889472
    s_waitcnt lgkmcnt(0)
    v_mfma_f32_16x16x32_bf16 v[20:23], a[48:51], a[0:3], v[20:23]
    ds_read_b64_tr_b16 a[60:61], v5 offset:4096
    v_mfma_f32_16x16x32_bf16 v[24:27], a[52:55], a[0:3], v[24:27]
    ds_read_b64_tr_b16 a[62:63], v5 offset:4608
    v_mfma_f32_16x16x32_bf16 v[28:31], a[56:59], a[0:3], v[28:31]
    ds_read_b64_tr_b16 a[64:65], v5 offset:12288
    v_mfma_f32_16x16x32_bf16 v[32:35], a[48:51], a[4:7], v[32:35]
    ds_read_b64_tr_b16 a[66:67], v5 offset:12800
    v_mfma_f32_16x16x32_bf16 v[36:39], a[52:55], a[4:7], v[36:39]
    ds_read_b64_tr_b16 a[68:69], v5 offset:20480
    v_mfma_f32_16x16x32_bf16 v[40:43], a[56:59], a[4:7], v[40:43]
    ds_read_b64_tr_b16 a[70:71], v5 offset:20992
    v_mfma_f32_16x16x32_bf16 v[44:47], a[48:51], a[8:11], v[44:47]
    ds_read_b128 a[24:27], v4 offset:2048
    v_mfma_f32_16x16x32_bf16 v[48:51], a[52:55], a[8:11], v[48:51]
    ds_read_b128 a[28:31], v4 offset:4096
    v_mfma_f32_16x16x32_bf16 v[52:55], a[56:59], a[8:11], v[52:55]
    ds_read_b128 a[32:35], v4 offset:6144
    v_mfma_f32_16x16x32_bf16 v[56:59], a[48:51], a[12:15], v[56:59]
    ds_read_b128 a[36:39], v4 offset:8192
    v_mfma_f32_16x16x32_bf16 v[60:63], a[52:55], a[12:15], v[60:63]
    v_cndmask_b32 v92, v92, v7, s[54:55]
    v_mfma_f32_16x16x32_bf16 v[64:67], a[56:59], a[12:15], v[64:67]
    v_cndmask_b32 v93, v93, v7, s[54:55]
    v_mfma_f32_16x16x32_bf16 v[68:71], a[48:51], a[16:19], v[68:71]
    v_cndmask_b32 v94, v94, v7, s[54:55]
    v_mfma_f32_16x16x32_bf16 v[72:75], a[52:55], a[16:19], v[72:75]
    v_cndmask_b32 v95, v95, v7, s[54:55]
    v_mfma_f32_16x16x32_bf16 v[76:79], a[56:59], a[16:19], v[76:79]
    ds_read_b128 a[40:43], v4 offset:10240
    v_mfma_f32_16x16x32_bf16 v[80:83], a[48:51], a[20:23], v[80:83]
    ds_read_b128 a[44:47], v4 offset:12288
    v_mfma_f32_16x16x32_bf16 v[84:87], a[52:55], a[20:23], v[84:87]
    ds_read_b128 v[96:99], v4 offset:0
    v_mfma_f32_16x16x32_bf16 v[88:91], a[56:59], a[20:23], v[88:91]
    v_add_u32 v3, s63, v3
    v_mfma_f32_16x16x32_bf16 v[8:11], a[48:51], v[136:139], v[8:11]
    v_add_u32 v4, s63, v4
    v_mfma_f32_16x16x32_bf16 v[12:15], a[52:55], v[92:95], v[12:15]
    v_add_u32 v5, s63, v5
    v_mfma_f32_16x16x32_bf16 v[16:19], a[56:59], v[92:95], v[16:19]
    s_waitcnt lgkmcnt(0)
    s_barrier
    v_mfma_f32_16x16x32_bf16 v[20:23], a[60:63], a[24:27], v[20:23]
    ds_read_b64_tr_b16 a[48:49], v5 offset:0
    v_mfma_f32_16x16x32_bf16 v[24:27], a[64:67], a[24:27], v[24:27]
    ds_read_b64_tr_b16 a[50:51], v5 offset:512
    v_mfma_f32_16x16x32_bf16 v[28:31], a[68:71], a[24:27], v[28:31]
    ds_read_b64_tr_b16 a[52:53], v5 offset:8192
    v_mfma_f32_16x16x32_bf16 v[32:35], a[60:63], a[28:31], v[32:35]
    ds_read_b64_tr_b16 a[54:55], v5 offset:8704
    v_mfma_f32_16x16x32_bf16 v[36:39], a[64:67], a[28:31], v[36:39]
    ds_read_b64_tr_b16 a[56:57], v5 offset:16384
    v_mfma_f32_16x16x32_bf16 v[40:43], a[68:71], a[28:31], v[40:43]
    ds_read_b64_tr_b16 a[58:59], v5 offset:16896
    v_mfma_f32_16x16x32_bf16 v[44:47], a[60:63], a[32:35], v[44:47]
    ds_read_b128 a[0:3], v3 offset:2048
    v_mfma_f32_16x16x32_bf16 v[48:51], a[64:67], a[32:35], v[48:51]
    ds_read_b128 a[4:7], v3 offset:4096
    v_mfma_f32_16x16x32_bf16 v[52:55], a[68:71], a[32:35], v[52:55]
    ds_read_b128 a[8:11], v3 offset:6144
    v_mfma_f32_16x16x32_bf16 v[56:59], a[60:63], a[36:39], v[56:59]
    ds_read_b128 a[12:15], v3 offset:8192
    v_mfma_f32_16x16x32_bf16 v[60:63], a[64:67], a[36:39], v[60:63]
    v_cndmask_b32 v96, v96, v7, s[54:55]
    v_mfma_f32_16x16x32_bf16 v[64:67], a[68:71], a[36:39], v[64:67]
    v_cndmask_b32 v97, v97, v7, s[54:55]
    v_mfma_f32_16x16x32_bf16 v[68:71], a[60:63], a[40:43], v[68:71]
    v_cndmask_b32 v98, v98, v7, s[54:55]
    v_mfma_f32_16x16x32_bf16 v[72:75], a[64:67], a[40:43], v[72:75]
    v_cndmask_b32 v99, v99, v7, s[54:55]
    v_mfma_f32_16x16x32_bf16 v[76:79], a[68:71], a[40:43], v[76:79]
    ds_read_b128 a[16:19], v3 offset:10240
    v_mfma_f32_16x16x32_bf16 v[80:83], a[60:63], a[44:47], v[80:83]
    ds_read_b128 a[20:23], v3 offset:12288
    v_mfma_f32_16x16x32_bf16 v[84:87], a[64:67], a[44:47], v[84:87]
    ds_read_b128 v[92:95], v3 offset:0
    v_mfma_f32_16x16x32_bf16 v[88:91], a[68:71], a[44:47], v[88:91]
    v_mfma_f32_16x16x32_bf16 v[8:11], a[60:63], v[136:139], v[8:11]
    v_mfma_f32_16x16x32_bf16 v[12:15], a[64:67], v[96:99], v[12:15]
    v_mfma_f32_16x16x32_bf16 v[16:19], a[68:71], v[96:99], v[16:19]
    s_add_u32 s49, s49, 1
    s_cmp_lt_u32 s49, 10
    s_cbranch_scc1 L_p1loop
    ds_read_b64 v[112:113], v110 offset:0
    ds_read_b64 v[114:115], v110 offset:128
    ds_read_b64 v[116:117], v110 offset:256
    ds_read_b64 v[118:119], v110 offset:384
    ds_read_b64 v[120:121], v110 offset:512
    ds_read_b64 v[122:123], v110 offset:640
    ds_read_b64 v[124:125], v110 offset:768
    v_mov_b32 v126, 66560
    ds_read_b32 v126, v126
    s_waitcnt lgkmcnt(8)
    v_mov_b32_dpp v92, v8 row_newbcast:0 row_mask:0xf bank_mask:0xf
    v_mov_b32_dpp v93, v9 row_newbcast:0 row_mask:0xf bank_mask:0xf
    v_mov_b32_dpp v94, v10 row_newbcast:0 row_mask:0xf bank_mask:0xf
    v_mov_b32_dpp v95, v11 row_newbcast:0 row_mask:0xf bank_mask:0xf
    v_mov_b32_dpp v96, v12 row_newbcast:0 row_mask:0xf bank_mask:0xf
    v_mov_b32_dpp v97, v13 row_newbcast:0 row_mask:0xf bank_mask:0xf
    v_mov_b32_dpp v98, v14 row_newbcast:0 row_mask:0xf bank_mask:0xf
    v_mov_b32_dpp v99, v15 row_newbcast:0 row_mask:0xf bank_mask:0xf
    v_mov_b32_dpp v128, v16 row_newbcast:0 row_mask:0xf bank_mask:0xf
    v_mov_b32_dpp v129, v17 row_newbcast:0 row_mask:0xf bank_mask:0xf
    v_mov_b32_dpp v130, v18 row_newbcast:0 row_mask:0xf bank_mask:0xf
    v_mov_b32_dpp v131, v19 row_newbcast:0 row_mask:0xf bank_mask:0xf
    s_waitcnt lgkmcnt(0)
    v_readfirstlane_b32 s50, v126
    v_pk_fma_f32 v[12:13], v[96:97], v[112:113], v[12:13] op_sel:[0,0,0] op_sel_hi:[1,0,1] neg_lo:[0,1,0] neg_hi:[0,1,0]
    v_pk_fma_f32 v[14:15], v[98:99], v[112:113], v[14:15] op_sel:[0,0,0] op_sel_hi:[1,0,1] neg_lo:[0,1,0] neg_hi:[0,1,0]
    v_pk_fma_f32 v[16:17], v[128:129], v[112:113], v[16:17] op_sel:[0,0,0] op_sel_hi:[1,0,1] neg_lo:[0,1,0] neg_hi:[0,1,0]
    v_pk_fma_f32 v[18:19], v[130:131], v[112:113], v[18:19] op_sel:[0,0,0] op_sel_hi:[1,0,1] neg_lo:[0,1,0] neg_hi:[0,1,0]
    v_pk_mul_f32 v[12:13], v[12:13], v[112:113] op_sel:[0,1] op_sel_hi:[1,1]
    v_pk_mul_f32 v[14:15], v[14:15], v[112:113] op_sel:[0,1] op_sel_hi:[1,1]
    v_pk_mul_f32 v[16:17], v[16:17], v[112:113] op_sel:[0,1] op_sel_hi:[1,1]
    v_pk_mul_f32 v[18:19], v[18:19], v[112:113] op_sel:[0,1] op_sel_hi:[1,1]
    v_cvt_pk_bf16_f32 v12, v12, v13
    v_cvt_pk_bf16_f32 v13, v14, v15
    ds_write_b64 v6, v[12:13] offset:14336
    v_cvt_pk_bf16_f32 v16, v16, v17
    v_cvt_pk_bf16_f32 v17, v18, v19
    ds_write_b64 v6, v[16:17] offset:28672
    v_mov_b32 v8, 0
    v_mov_b32 v9, 0
    v_mov_b32 v10, 0
    v_mov_b32 v11, 0
    ds_write_b128 v108, v[8:11] offset:45056
    v_pk_fma_f32 v[20:21], v[92:93], v[114:115], v[20:21] op_sel:[0,0,0] op_sel_hi:[1,0,1] neg_lo:[0,1,0] neg_hi:[0,1,0]
    v_pk_fma_f32 v[22:23], v[94:95], v[114:115], v[22:23] op_sel:[0,0,0] op_sel_hi:[1,0,1] neg_lo:[0,1,0] neg_hi:[0,1,0]
    v_pk_fma_f32 v[24:25], v[96:97], v[114:115], v[24:25] op_sel:[0,0,0] op_sel_hi:[1,0,1] neg_lo:[0,1,0] neg_hi:[0,1,0]
    v_pk_fma_f32 v[26:27], v[98:99], v[114:115], v[26:27] op_sel:[0,0,0] op_sel_hi:[1,0,1] neg_lo:[0,1,0] neg_hi:[0,1,0]
    v_pk_fma_f32 v[28:29], v[128:129], v[114:115], v[28:29] op_sel:[0,0,0] op_sel_hi:[1,0,1] neg_lo:[0,1,0] neg_hi:[0,1,0]
    v_pk_fma_f32 v[30:31], v[130:131], v[114:115], v[30:31] op_sel:[0,0,0] op_sel_hi:[1,0,1] neg_lo:[0,1,0] neg_hi:[0,1,0]
    v_pk_mul_f32 v[20:21], v[20:21], v[114:115] op_sel:[0,1] op_sel_hi:[1,1]
    v_pk_mul_f32 v[22:23], v[22:23], v[114:115] op_sel:[0,1] op_sel_hi:[1,1]
    v_pk_mul_f32 v[24:25], v[24:25], v[114:115] op_sel:[0,1] op_sel_hi:[1,1]
    v_pk_mul_f32 v[26:27], v[26:27], v[114:115] op_sel:[0,1] op_sel_hi:[1,1]
    v_pk_mul_f32 v[28:29], v[28:29], v[114:115] op_sel:[0,1] op_sel_hi:[1,1]
    v_pk_mul_f32 v[30:31], v[30:31], v[114:115] op_sel:[0,1] op_sel_hi:[1,1]
    v_cvt_pk_bf16_f32 v20, v20, v21
    v_cvt_pk_bf16_f32 v21, v22, v23
    ds_write_b64 v6, v[20:21] offset:128
    v_cvt_pk_bf16_f32 v24, v24, v25
    v_cvt_pk_bf16_f32 v25, v26, v27
    ds_write_b64 v6, v[24:25] offset:14464
    v_cvt_pk_bf16_f32 v28, v28, v29
    v_cvt_pk_bf16_f32 v29, v30, v31
    ds_write_b64 v6, v[28:29] offset:28800
    v_pk_fma_f32 v[32:33], v[92:93], v[116:117], v[32:33] op_sel:[0,0,0] op_sel_hi:[1,0,1] neg_lo:[0,1,0] neg_hi:[0,1,0]
    v_pk_fma_f32 v[34:35], v[94:95], v[116:117], v[34:35] op_sel:[0,0,0] op_sel_hi:[1,0,1] neg_lo:[0,1,0] neg_hi:[0,1,0]
    v_pk_fma_f32 v[36:37], v[96:97], v[116:117], v[36:37] op_sel:[0,0,0] op_sel_hi:[1,0,1] neg_lo:[0,1,0] neg_hi:[0,1,0]
    v_pk_fma_f32 v[38:39], v[98:99], v[116:117], v[38:39] op_sel:[0,0,0] op_sel_hi:[1,0,1] neg_lo:[0,1,0] neg_hi:[0,1,0]
    v_pk_fma_f32 v[40:41], v[128:129], v[116:117], v[40:41] op_sel:[0,0,0] op_sel_hi:[1,0,1] neg_lo:[0,1,0] neg_hi:[0,1,0]
    v_pk_fma_f32 v[42:43], v[130:131], v[116:117], v[42:43] op_sel:[0,0,0] op_sel_hi:[1,0,1] neg_lo:[0,1,0] neg_hi:[0,1,0]
    v_pk_mul_f32 v[32:33], v[32:33], v[116:117] op_sel:[0,1] op_sel_hi:[1,1]
    v_pk_mul_f32 v[34:35], v[34:35], v[116:117] op_sel:[0,1] op_sel_hi:[1,1]
    v_pk_mul_f32 v[36:37], v[36:37], v[116:117] op_sel:[0,1] op_sel_hi:[1,1]
    v_pk_mul_f32 v[38:39], v[38:39], v[116:117] op_sel:[0,1] op_sel_hi:[1,1]
    v_pk_mul_f32 v[40:41], v[40:41], v[116:117] op_sel:[0,1] op_sel_hi:[1,1]
    v_pk_mul_f32 v[42:43], v[42:43], v[116:117] op_sel:[0,1] op_sel_hi:[1,1]
    v_cvt_pk_bf16_f32 v32, v32, v33
    v_cvt_pk_bf16_f32 v33, v34, v35
    ds_write_b64 v6, v[32:33] offset:256
    v_cvt_pk_bf16_f32 v36, v36, v37
    v_cvt_pk_bf16_f32 v37, v38, v39
    ds_write_b64 v6, v[36:37] offset:14592
    v_cvt_pk_bf16_f32 v40, v40, v41
    v_cvt_pk_bf16_f32 v41, v42, v43
    ds_write_b64 v6, v[40:41] offset:28928
    v_pk_fma_f32 v[44:45], v[92:93], v[118:119], v[44:45] op_sel:[0,0,0] op_sel_hi:[1,0,1] neg_lo:[0,1,0] neg_hi:[0,1,0]
    v_pk_fma_f32 v[46:47], v[94:95], v[118:119], v[46:47] op_sel:[0,0,0] op_sel_hi:[1,0,1] neg_lo:[0,1,0] neg_hi:[0,1,0]
    v_pk_fma_f32 v[48:49], v[96:97], v[118:119], v[48:49] op_sel:[0,0,0] op_sel_hi:[1,0,1] neg_lo:[0,1,0] neg_hi:[0,1,0]
    v_pk_fma_f32 v[50:51], v[98:99], v[118:119], v[50:51] op_sel:[0,0,0] op_sel_hi:[1,0,1] neg_lo:[0,1,0] neg_hi:[0,1,0]
    v_pk_fma_f32 v[52:53], v[128:129], v[118:119], v[52:53] op_sel:[0,0,0] op_sel_hi:[1,0,1] neg_lo:[0,1,0] neg_hi:[0,1,0]
    v_pk_fma_f32 v[54:55], v[130:131], v[118:119], v[54:55] op_sel:[0,0,0] op_sel_hi:[1,0,1] neg_lo:[0,1,0] neg_hi:[0,1,0]
    v_pk_mul_f32 v[44:45], v[44:45], v[118:119] op_sel:[0,1] op_sel_hi:[1,1]
    v_pk_mul_f32 v[46:47], v[46:47], v[118:119] op_sel:[0,1] op_sel_hi:[1,1]
    v_pk_mul_f32 v[48:49], v[48:49], v[118:119] op_sel:[0,1] op_sel_hi:[1,1]
    v_pk_mul_f32 v[50:51], v[50:51], v[118:119] op_sel:[0,1] op_sel_hi:[1,1]
    v_pk_mul_f32 v[52:53], v[52:53], v[118:119] op_sel:[0,1] op_sel_hi:[1,1]
    v_pk_mul_f32 v[54:55], v[54:55], v[118:119] op_sel:[0,1] op_sel_hi:[1,1]
    v_cvt_pk_bf16_f32 v44, v44, v45
    v_cvt_pk_bf16_f32 v45, v46, v47
    ds_write_b64 v6, v[44:45] offset:384
    v_cvt_pk_bf16_f32 v48, v48, v49
    v_cvt_pk_bf16_f32 v49, v50, v51
    ds_write_b64 v6, v[48:49] offset:14720
    v_cvt_pk_bf16_f32 v52, v52, v53
    v_cvt_pk_bf16_f32 v53, v54, v55
    ds_write_b64 v6, v[52:53] offset:29056
    v_pk_fma_f32 v[56:57], v[92:93], v[120:121], v[56:57] op_sel:[0,0,0] op_sel_hi:[1,0,1] neg_lo:[0,1,0] neg_hi:[0,1,0]
    v_pk_fma_f32 v[58:59], v[94:95], v[120:121], v[58:59] op_sel:[0,0,0] op_sel_hi:[1,0,1] neg_lo:[0,1,0] neg_hi:[0,1,0]
    v_pk_fma_f32 v[60:61], v[96:97], v[120:121], v[60:61] op_sel:[0,0,0] op_sel_hi:[1,0,1] neg_lo:[0,1,0] neg_hi:[0,1,0]
    v_pk_fma_f32 v[62:63], v[98:99], v[120:121], v[62:63] op_sel:[0,0,0] op_sel_hi:[1,0,1] neg_lo:[0,1,0] neg_hi:[0,1,0]
    v_pk_fma_f32 v[64:65], v[128:129], v[120:121], v[64:65] op_sel:[0,0,0] op_sel_hi:[1,0,1] neg_lo:[0,1,0] neg_hi:[0,1,0]
    v_pk_fma_f32 v[66:67], v[130:131], v[120:121], v[66:67] op_sel:[0,0,0] op_sel_hi:[1,0,1] neg_lo:[0,1,0] neg_hi:[0,1,0]
    v_pk_mul_f32 v[56:57], v[56:57], v[120:121] op_sel:[0,1] op_sel_hi:[1,1]
    v_pk_mul_f32 v[58:59], v[58:59], v[120:121] op_sel:[0,1] op_sel_hi:[1,1]
    v_pk_mul_f32 v[60:61], v[60:61], v[120:121] op_sel:[0,1] op_sel_hi:[1,1]
    v_pk_mul_f32 v[62:63], v[62:63], v[120:121] op_sel:[0,1] op_sel_hi:[1,1]
    v_pk_mul_f32 v[64:65], v[64:65], v[120:121] op_sel:[0,1] op_sel_hi:[1,1]
    v_pk_mul_f32 v[66:67], v[66:67], v[120:121] op_sel:[0,1] op_sel_hi:[1,1]
    v_cvt_pk_bf16_f32 v56, v56, v57
    v_cvt_pk_bf16_f32 v57, v58, v59
    ds_write_b64 v6, v[56:57] offset:512
    v_cvt_pk_bf16_f32 v60, v60, v61
    v_cvt_pk_bf16_f32 v61, v62, v63
    ds_write_b64 v6, v[60:61] offset:14848
    v_cvt_pk_bf16_f32 v64, v64, v65
    v_cvt_pk_bf16_f32 v65, v66, v67
    ds_write_b64 v6, v[64:65] offset:29184
    v_pk_fma_f32 v[68:69], v[92:93], v[122:123], v[68:69] op_sel:[0,0,0] op_sel_hi:[1,0,1] neg_lo:[0,1,0] neg_hi:[0,1,0]
    v_pk_fma_f32 v[70:71], v[94:95], v[122:123], v[70:71] op_sel:[0,0,0] op_sel_hi:[1,0,1] neg_lo:[0,1,0] neg_hi:[0,1,0]
    v_pk_fma_f32 v[72:73], v[96:97], v[122:123], v[72:73] op_sel:[0,0,0] op_sel_hi:[1,0,1] neg_lo:[0,1,0] neg_hi:[0,1,0]
    v_pk_fma_f32 v[74:75], v[98:99], v[122:123], v[74:75] op_sel:[0,0,0] op_sel_hi:[1,0,1] neg_lo:[0,1,0] neg_hi:[0,1,0]
    v_pk_fma_f32 v[76:77], v[128:129], v[122:123], v[76:77] op_sel:[0,0,0] op_sel_hi:[1,0,1] neg_lo:[0,1,0] neg_hi:[0,1,0]
    v_pk_fma_f32 v[78:79], v[130:131], v[122:123], v[78:79] op_sel:[0,0,0] op_sel_hi:[1,0,1] neg_lo:[0,1,0] neg_hi:[0,1,0]
    v_pk_mul_f32 v[68:69], v[68:69], v[122:123] op_sel:[0,1] op_sel_hi:[1,1]
    v_pk_mul_f32 v[70:71], v[70:71], v[122:123] op_sel:[0,1] op_sel_hi:[1,1]
    v_pk_mul_f32 v[72:73], v[72:73], v[122:123] op_sel:[0,1] op_sel_hi:[1,1]
    v_pk_mul_f32 v[74:75], v[74:75], v[122:123] op_sel:[0,1] op_sel_hi:[1,1]
    v_pk_mul_f32 v[76:77], v[76:77], v[122:123] op_sel:[0,1] op_sel_hi:[1,1]
    v_pk_mul_f32 v[78:79], v[78:79], v[122:123] op_sel:[0,1] op_sel_hi:[1,1]
    v_cvt_pk_bf16_f32 v68, v68, v69
    v_cvt_pk_bf16_f32 v69, v70, v71
    ds_write_b64 v6, v[68:69] offset:640
    v_cvt_pk_bf16_f32 v72, v72, v73
    v_cvt_pk_bf16_f32 v73, v74, v75
    ds_write_b64 v6, v[72:73] offset:14976
    v_cvt_pk_bf16_f32 v76, v76, v77
    v_cvt_pk_bf16_f32 v77, v78, v79
    ds_write_b64 v6, v[76:77] offset:29312
    v_pk_fma_f32 v[80:81], v[92:93], v[124:125], v[80:81] op_sel:[0,0,0] op_sel_hi:[1,0,1] neg_lo:[0,1,0] neg_hi:[0,1,0]
    v_pk_fma_f32 v[82:83], v[94:95], v[124:125], v[82:83] op_sel:[0,0,0] op_sel_hi:[1,0,1] neg_lo:[0,1,0] neg_hi:[0,1,0]
    v_pk_fma_f32 v[84:85], v[96:97], v[124:125], v[84:85] op_sel:[0,0,0] op_sel_hi:[1,0,1] neg_lo:[0,1,0] neg_hi:[0,1,0]
    v_pk_fma_f32 v[86:87], v[98:99], v[124:125], v[86:87] op_sel:[0,0,0] op_sel_hi:[1,0,1] neg_lo:[0,1,0] neg_hi:[0,1,0]
    v_pk_fma_f32 v[88:89], v[128:129], v[124:125], v[88:89] op_sel:[0,0,0] op_sel_hi:[1,0,1] neg_lo:[0,1,0] neg_hi:[0,1,0]
    v_pk_fma_f32 v[90:91], v[130:131], v[124:125], v[90:91] op_sel:[0,0,0] op_sel_hi:[1,0,1] neg_lo:[0,1,0] neg_hi:[0,1,0]
    v_pk_mul_f32 v[80:81], v[80:81], v[124:125] op_sel:[0,1] op_sel_hi:[1,1]
    v_pk_mul_f32 v[82:83], v[82:83], v[124:125] op_sel:[0,1] op_sel_hi:[1,1]
    v_pk_mul_f32 v[84:85], v[84:85], v[124:125] op_sel:[0,1] op_sel_hi:[1,1]
    v_pk_mul_f32 v[86:87], v[86:87], v[124:125] op_sel:[0,1] op_sel_hi:[1,1]
    v_pk_mul_f32 v[88:89], v[88:89], v[124:125] op_sel:[0,1] op_sel_hi:[1,1]
    v_pk_mul_f32 v[90:91], v[90:91], v[124:125] op_sel:[0,1] op_sel_hi:[1,1]
    v_cvt_pk_bf16_f32 v80, v80, v81
    v_cvt_pk_bf16_f32 v81, v82, v83
    ds_write_b64 v6, v[80:81] offset:768
    v_cvt_pk_bf16_f32 v84, v84, v85
    v_cvt_pk_bf16_f32 v85, v86, v87
    ds_write_b64 v6, v[84:85] offset:15104
    v_cvt_pk_bf16_f32 v88, v88, v89
    v_cvt_pk_bf16_f32 v89, v90, v91
    ds_write_b64 v6, v[88:89] offset:29440
    s_mov_b32 s94, 0
L_att:
    s_waitcnt lgkmcnt(0)
    s_barrier
    ds_read_b64 a[24:25], v102 offset:0
    ds_read_b64 a[26:27], v103 offset:0
    ds_read_b64 a[28:29], v102 offset:128
    ds_read_b64 a[30:31], v103 offset:128
    ds_read_b64 a[0:1], v100 offset:128
    ds_read_b64 a[2:3], v101 offset:128
    ds_read_b64 a[32:33], v102 offset:256
    ds_read_b64 a[34:35], v103 offset:256
    ds_read_b64 a[4:5], v100 offset:256
    ds_read_b64 a[6:7], v101 offset:256
    ds_read_b64 a[36:37], v102 offset:384
    ds_read_b64 a[38:39], v103 offset:384
    ds_read_b64 a[8:9], v100 offset:384
    ds_read_b64 a[10:11], v101 offset:384
    s_waitcnt lgkmcnt(8)
    v_mfma_f32_16x16x32_bf16 v[16:19], a[24:27], a[0:3], 0
    v_mfma_f32_16x16x32_bf16 v[20:23], a[28:31], a[0:3], 0
    s_waitcnt lgkmcnt(4)
    v_mfma_f32_16x16x32_bf16 v[24:27], a[28:31], a[4:7], 0
    v_mfma_f32_16x16x32_bf16 v[28:31], a[32:35], a[4:7], 0
    s_waitcnt lgkmcnt(0)
    v_mfma_f32_16x16x32_bf16 v[32:35], a[32:35], a[8:11], 0
    v_mfma_f32_16x16x32_bf16 v[36:39], a[36:39], a[8:11], 0
    ds_read_b64_tr_b16 a[52:53], v104 offset:0
    ds_read_b64_tr_b16 a[66:67], v104 offset:3584
    ds_read_b64_tr_b16 a[54:55], v104 offset:128
    ds_read_b64_tr_b16 a[68:69], v104 offset:3712
    ds_read_b64_tr_b16 a[56:57], v104 offset:256
    ds_read_b64_tr_b16 a[70:71], v104 offset:3840
    ds_read_b64_tr_b16 a[58:59], v104 offset:384
    ds_read_b64_tr_b16 a[72:73], v104 offset:3968
    v_mov_b32 v4, 0x3f803f80
    v_mov_b32 v5, 0x3f803f80
    v_mov_b32 v6, 0x3f803f80
    v_mov_b32 v7, 0x3f803f80
    s_mov_b32 s60, 0x3ea52b5c
    v_cndmask_b32 v16, v16, v17, s[16:17]
    v_cndmask_b32 v18, v18, v19, s[16:17]
    v_cndmask_b32 v20, v20, v21, s[16:17]
    v_cndmask_b32 v22, v22, v23, s[16:17]
    v_cndmask_b32 v24, v24, v25, s[16:17]
    v_cndmask_b32 v26, v26, v27, s[16:17]
    v_cndmask_b32 v28, v28, v29, s[16:17]
    v_cndmask_b32 v30, v30, v31, s[16:17]
    v_cndmask_b32 v32, v32, v33, s[16:17]
    v_cndmask_b32 v34, v34, v35, s[16:17]
    v_cndmask_b32 v36, v36, v37, s[16:17]
    v_cndmask_b32 v38, v38, v39, s[16:17]
    v_cndmask_b32 v64, v20, v16, s[18:19]
    v_cndmask_b32 v65, v22, v18, s[22:23]
    v_cndmask_b32 v66, v28, v24, s[18:19]
    v_cndmask_b32 v67, v30, v26, s[22:23]
    v_cndmask_b32 v68, v36, v32, s[18:19]
    v_cndmask_b32 v69, v38, v34, s[22:23]
    s_cmp_eq_u32 s41, 5
    s_cbranch_scc1 L_p2whole
    v_mov_b32 v72, v67
    v_mov_b32 v73, v68
    v_mov_b32 v74, v69
    s_cmp_eq_u32 s50, 0
    s_cbranch_scc0 L_p2far
    buffer_store_dwordx3 v[64:66], v105, s[4:7], s58 offen
    buffer_store_dwordx3 v[72:74], v105, s[4:7], s58 offen offset:768
    s_branch L_p2st
L_p2far:
    buffer_store_dwordx3 v[64:66], v105, s[4:7], s58 offen sc1
    buffer_store_dwordx3 v[72:74], v105, s[4:7], s58 offen offset:768 sc1
L_p2st:
    s_mov_b32 s62, 400000
L_p2x:
    buffer_load_dwordx3 v[76:78], v105, s[4:7], s59 offen sc1
    buffer_load_dwordx3 v[80:82], v105, s[4:7], s59 offen offset:768 sc1
    s_waitcnt vmcnt(0)
    v_max3_u32 v12, v76, v77, v78
    v_max3_u32 v13, v80, v81, v82
    v_max_u32 v12, v12, v13
    v_cmp_eq_u32 vcc, -1, v12
    s_cbranch_vccz L_p2y
    s_sub_u32 s62, s62, 1
    s_cbranch_scc0 L_p2x
L_p2y:
    v_add_f32 v64, v64, v76
    v_add_f32 v65, v65, v77
    v_add_f32 v66, v66, v78
    v_add_f32 v67, v67, v80
    v_add_f32 v68, v68, v81
    v_add_f32 v69, v69, v82
L_p2whole:
    s_cmp_lg_u32 s94, 0
    s_cbranch_scc1 L_p2nomask
    s_or_b32 s3, s38, s43
    s_cmp_lg_u32 s3, 0
    s_cbranch_scc1 L_p2nomask
    v_mov_b32 v12, 0xf149f2ca
    s_mov_b32 s58, -1
    s_mov_b32 s59, s19
    v_cndmask_b32 v64, v64, v12, s[58:59]
    s_mov_b32 s59, s23
    v_cndmask_b32 v65, v65, v12, s[58:59]
    s_mov_b32 s58, s18
    s_mov_b32 s59, 0
    v_cndmask_b32 v66, v66, v12, s[58:59]
    s_mov_b32 s58, s22
    v_cndmask_b32 v67, v67, v12, s[58:59]
L_p2nomask:
    v_max_f32 v16, v64, v65
    v_max_f32 v24, v66, v67
    v_max_f32 v32, v68, v69
    v_mov_b32 v17, v16
    v_mov_b32 v25, v24
    v_mov_b32 v33, v32
    v_permlane32_swap_b32 v16, v17
    v_permlane32_swap_b32 v24, v25
    v_permlane32_swap_b32 v32, v33
    v_max_f32 v16, v16, v17
    v_max_f32 v24, v24, v25
    v_max_f32 v32, v32, v33
    v_mov_b32 v17, v16
    v_mov_b32 v25, v24
    v_mov_b32 v33, v32
    v_permlane16_swap_b32 v16, v17
    v_permlane16_swap_b32 v24, v25
    v_permlane16_swap_b32 v32, v33
    v_max_f32 v16, v16, v17
    v_max_f32 v24, v24, v25
    v_max_f32 v32, v32, v33
    v_pk_add_f32 v[64:65], v[64:65], v[16:17] op_sel_hi:[1,0] neg_lo:[0,1] neg_hi:[0,1]
    v_pk_add_f32 v[66:67], v[66:67], v[24:25] op_sel_hi:[1,0] neg_lo:[0,1] neg_hi:[0,1]
    v_pk_add_f32 v[68:69], v[68:69], v[32:33] op_sel_hi:[1,0] neg_lo:[0,1] neg_hi:[0,1]
    v_pk_mul_f32 v[64:65], v[64:65], s[60:61] op_sel_hi:[1,0]
    v_pk_mul_f32 v[66:67], v[66:67], s[60:61] op_sel_hi:[1,0]
    v_pk_mul_f32 v[68:69], v[68:69], s[60:61] op_sel_hi:[1,0]
    v_exp_f32 v64, v64
    v_exp_f32 v65, v65
    v_exp_f32 v66, v66
    v_exp_f32 v67, v67
    v_exp_f32 v68, v68
    v_exp_f32 v69, v69
    v_cvt_pk_bf16_f32 v64, v64, v64
    v_cvt_pk_bf16_f32 v65, v65, v65
    v_cvt_pk_bf16_f32 v66, v66, v66
    v_cvt_pk_bf16_f32 v67, v67, v67
    v_cvt_pk_bf16_f32 v68, v68, v68
    v_cvt_pk_bf16_f32 v69, v69, v69
    v_and_b32 v16, v152, v64
    v_and_b32 v17, v153, v65
    v_and_b32 v18, v154, v64
    v_and_b32 v19, v155, v65
    v_and_b32 v24, v152, v66
    v_and_b32 v25, v153, v67
    v_and_b32 v26, v154, v66
    v_and_b32 v27, v155, v67
    v_and_b32 v32, v152, v68
    v_and_b32 v33, v153, v69
    v_and_b32 v34, v154, v68
    v_and_b32 v35, v155, v69
    s_waitcnt lgkmcnt(0)
    s_lshl_b32 s3, s94, 2
    s_or_b32 s3, s3, s43
    v_mfma_f32_16x16x32_bf16 v[20:23], v[4:7], v[16:19], 0
    v_mfma_f32_16x16x32_bf16 v[64:67], a[52:55], v[16:19], 0
    v_mfma_f32_16x16x32_bf16 v[68:71], a[66:69], v[16:19], 0
    v_mfma_f32_16x16x32_bf16 v[28:31], v[4:7], v[24:27], 0
    v_mfma_f32_16x16x32_bf16 v[72:75], a[54:57], v[24:27], 0
    v_mfma_f32_16x16x32_bf16 v[76:79], a[68:71], v[24:27], 0
    v_mfma_f32_16x16x32_bf16 v[36:39], v[4:7], v[32:35], 0
    v_mfma_f32_16x16x32_bf16 v[80:83], a[56:59], v[32:35], 0
    v_mfma_f32_16x16x32_bf16 v[84:87], a[70:73], v[32:35], 0
    v_rcp_f32 v20, v20
    s_nop 1
    v_rcp_f32 v28, v28
    s_nop 1
    v_rcp_f32 v36, v36
    v_pk_mul_f32 v[64:65], v[64:65], v[20:21] op_sel_hi:[1,0]
    v_pk_mul_f32 v[66:67], v[66:67], v[20:21] op_sel_hi:[1,0]
    v_pk_mul_f32 v[68:69], v[68:69], v[20:21] op_sel_hi:[1,0]
    v_pk_mul_f32 v[70:71], v[70:71], v[20:21] op_sel_hi:[1,0]
    v_cvt_pk_bf16_f32 v64, v64, v65
    v_cvt_pk_bf16_f32 v65, v66, v67
    v_cvt_pk_bf16_f32 v66, v68, v69
    v_cvt_pk_bf16_f32 v67, v70, v71
    s_cmp_eq_u32 s3, 2
    s_cbranch_scc1 L_p2dup
    buffer_store_dwordx2 v[64:65], v156, s[4:7], 0 offen offset:0
    buffer_store_dwordx2 v[66:67], v157, s[4:7], 0 offen offset:0
L_p2dup:
    v_pk_mul_f32 v[72:73], v[72:73], v[28:29] op_sel_hi:[1,0]
    v_pk_mul_f32 v[74:75], v[74:75], v[28:29] op_sel_hi:[1,0]
    v_pk_mul_f32 v[76:77], v[76:77], v[28:29] op_sel_hi:[1,0]
    v_pk_mul_f32 v[78:79], v[78:79], v[28:29] op_sel_hi:[1,0]
    v_cvt_pk_bf16_f32 v72, v72, v73
    v_cvt_pk_bf16_f32 v73, v74, v75
    v_cvt_pk_bf16_f32 v74, v76, v77
    v_cvt_pk_bf16_f32 v75, v78, v79
    buffer_store_dwordx2 v[72:73], v156, s[4:7], 0 offen offset:256
    buffer_store_dwordx2 v[74:75], v157, s[4:7], 0 offen offset:256
    v_pk_mul_f32 v[80:81], v[80:81], v[36:37] op_sel_hi:[1,0]
    v_pk_mul_f32 v[82:83], v[82:83], v[36:37] op_sel_hi:[1,0]
    v_pk_mul_f32 v[84:85], v[84:85], v[36:37] op_sel_hi:[1,0]
    v_pk_mul_f32 v[86:87], v[86:87], v[36:37] op_sel_hi:[1,0]
    v_cvt_pk_bf16_f32 v80, v80, v81
    v_cvt_pk_bf16_f32 v81, v82, v83
    v_cvt_pk_bf16_f32 v82, v84, v85
    v_cvt_pk_bf16_f32 v83, v86, v87
    buffer_store_dwordx2 v[80:81], v156, s[4:7], 0 offen offset:512
    buffer_store_dwordx2 v[82:83], v157, s[4:7], 0 offen offset:512
    s_cmp_eq_u32 s94, 0
    s_cbranch_scc1 L_attc
    s_cmp_eq_u32 s94, 2
    s_cbranch_scc1 L_hBret
    s_waitcnt vmcnt(0)
    s_barrier
    s_branch L_hAret
L_attc:
    buffer_load_dwordx4 v[136:139], v148, s[8:11], 0 offen
    buffer_load_dwordx4 v[140:143], v149, s[8:11], 0 offen
    buffer_load_dwordx4 v[144:147], v150, s[8:11], 0 offen
    v_mov_b32 v133, v151
    s_waitcnt vmcnt(3)
    s_barrier
    v_mov_b32 v3, 1
    s_mov_b64 exec, 1
    s_cmp_eq_u32 s50, 0
    s_cbranch_scc0 L_pf_48
    s_waitcnt vmcnt(3)
    buffer_store_dword v3, v135, s[4:7], 0 offen offset:512
    s_branch L_pg_49
L_pf_48:
    s_waitcnt vmcnt(0)
    buffer_wbl2 sc1
    s_waitcnt vmcnt(0)
    buffer_store_dword v3, v135, s[4:7], 0 offen offset:512 sc1
L_pg_49:
    s_mov_b64 exec, -1
    s_branch L_p3
L_p1idle:
    s_cmp_lg_u32 s40, 0
    s_cbranch_scc1 L_idle2
    s_cmp_lg_u32 s39, 30
    s_cbranch_scc1 L_nolead
    v_lshlrev_b32 v4, 4, v0
    buffer_store_dwordx4 v[28:31], v4, s[4:7], 0 offen offset:0 sc1
    buffer_store_dwordx4 v[28:31], v4, s[4:7], 0 offen offset:1024 sc1
    buffer_store_dwordx4 v[28:31], v4, s[4:7], 0 offen offset:2048 sc1
    buffer_store_dwordx4 v[28:31], v4, s[4:7], 0 offen offset:3072 sc1
    v_add_u32 v4, 4096, v4
    buffer_store_dwordx4 v[28:31], v4, s[4:7], 0 offen sc1
    buffer_store_dwordx4 v[28:31], v4, s[4:7], 0 offen offset:1024 sc1
    v_mov_b32 v4, 1
    s_waitcnt vmcnt(0)
    s_mov_b64 exec, 1
    global_store_dword v128, v4, s[34:35] sc1
    s_mov_b64 exec, -1
L_nolead:
L_idle2:
    s_barrier
    s_branch L_agent
L_p3:
    v_lshrrev_b32 v93, 2, v2
    v_lshl_add_u32 v93, v1, 2, v93
    v_lshrrev_b32 v94, 1, v93
    v_and_b32 v94, 3, v94
    s_lshl_b32 s3, s46, 1
    v_xor_b32 v94, s3, v94
    v_lshlrev_b32 v94, 5, v94
    v_lshl_add_u32 v94, v93, 7, v94
    v_and_b32 v93, 3, v2
    v_lshl_add_u32 v134, v93, 3, v94
    v_mul_u32_u24 v132, 4608, v1
    v_lshl_add_u32 v132, v2, 4, v132
    s_lshl_b32 s3, s44, 1
    s_add_u32 s3, s3, s46
    s_mul_i32 s47, s3, 18432
    s_mov_b32 s41, s3
    v_and_b32 v93, 1, v2
    v_cmp_eq_u32 s[26:27], 1, v93
    v_and_b32 v93, 2, v2
    v_cmp_eq_u32 s[28:29], 2, v93
    s_cmp_eq_u32 s56, 11
    s_cselect_b32 s54, 1, 0
    s_cmp_eq_u32 s57, 5
    s_cselect_b32 s55, 1, 0
    s_cmp_eq_u32 s57, 10
    s_cselect_b32 s55, 1, s55
    s_mul_i32 s3, s46, 40960
    s_add_u32 s3, s3, 81920
    v_add_u32 v88, s3, v134
    v_xor_b32 v89, 32, v88
    v_xor_b32 v90, 64, v88
    v_xor_b32 v91, 96, v88
    s_lshl_b32 s3, s56, 8
    s_add_u32 s3, s3, 16384
    v_add_u32 v92, s3, v132
    s_cmp_eq_u32 s54, 0
    s_cselect_b32 s3, 0, 1073741824
    v_add_u32 v131, s3, v92
    s_lshl_b32 s3, s56, 8
    s_add_u32 s3, s3, s47
    s_add_u32 s3, s3, 385024
    v_add_u32 v96, s3, v132
    s_mul_i32 s3, s56, 2560
    s_lshl_b32 s52, s44, 8
    s_add_u32 s3, s3, s52
    s_lshl_b32 s52, s46, 3
    s_add_u32 s3, s3, s52
    s_add_u32 s3, s3, 2269184
    v_lshl_add_u32 v97, v2, 4, s3
    v_lshrrev_b32 v98, 2, v2
    v_cmp_eq_u32 vcc, v98, v1
    v_mov_b32 v98, 1073741824
    s_nop 0
    v_cndmask_b32 v97, v98, v97, vcc
    v_mov_b32 v4, 0x3f803f80
    v_mov_b32 v5, 0x3f803f80
    v_mov_b32 v6, 0x3f803f80
    v_mov_b32 v7, 0x3f803f80
    s_lshl_b32 s3, s45, 13
    s_add_u32 s3, s3, 81920
    s_mul_i32 s52, s46, 40960
    s_add_u32 s53, s52, s3
    v_lshl_add_u32 v93, v0, 4, s53
    s_sub_u32 s52, 40960, s52
    s_add_u32 s53, s52, s3
    v_lshl_add_u32 v94, v0, 4, s53
    s_mul_i32 s61, s46, 184320
    s_waitcnt vmcnt(1)
    v_permlane16_swap_b32 v136, v138
    v_permlane16_swap_b32 v137, v139
    v_permlane16_swap_b32 v140, v142
    v_permlane16_swap_b32 v141, v143
    v_permlane16_swap_b32 v144, v146
    v_permlane16_swap_b32 v145, v147
    v_and_b32 v9, 0xffff0000, v136
    v_lshlrev_b32 v8, 16, v136
    v_and_b32 v11, 0xffff0000, v137
    v_lshlrev_b32 v10, 16, v137
    v_and_b32 v13, 0xffff0000, v138
    v_lshlrev_b32 v12, 16, v138
    v_and_b32 v15, 0xffff0000, v139
    v_lshlrev_b32 v14, 16, v139
    v_and_b32 v25, 0xffff0000, v140
    v_lshlrev_b32 v24, 16, v140
    v_and_b32 v27, 0xffff0000, v141
    v_lshlrev_b32 v26, 16, v141
    v_and_b32 v29, 0xffff0000, v142
    v_lshlrev_b32 v28, 16, v142
    v_and_b32 v31, 0xffff0000, v143
    v_lshlrev_b32 v30, 16, v143
    v_and_b32 v41, 0xffff0000, v144
    v_lshlrev_b32 v40, 16, v144
    v_and_b32 v43, 0xffff0000, v145
    v_lshlrev_b32 v42, 16, v145
    v_and_b32 v45, 0xffff0000, v146
    v_lshlrev_b32 v44, 16, v146
    v_and_b32 v47, 0xffff0000, v147
    v_lshlrev_b32 v46, 16, v147
    s_cmp_eq_u32 s43, 0
    s_cselect_b32 s31, 0, 10
    s_cmp_eq_u32 s43, 2
    s_cselect_b32 s21, 10, 0
    s_cselect_b32 s30, 20, 10
    s_mul_i32 s30, s43, 10
    s_mov_b32 s62, 400000
    v_lshlrev_b32 v3, 3, v0
    s_lshl_b32 s3, s30, 1
    s_lshl_b32 s52, 10, 1
    s_bfm_b64 exec, s52, s3
L_po_50:
    buffer_load_dwordx2 v[126:127], v3, s[4:7], 0 offen offset:512 sc1
    s_waitcnt vmcnt(0)
    v_and_b32 v126, v126, v127
    v_cmp_eq_u32 vcc, 0, v126
    s_cbranch_vccz L_pp_51
    s_sub_u32 s62, s62, 1
    s_cbranch_scc0 L_po_50
    s_endpgm
L_pp_51:
    s_mov_b64 exec, -1
    s_cmp_eq_u32 s50, 0
    s_cbranch_scc1 L_pq_52
    buffer_inv sc1
    s_waitcnt vmcnt(0)
L_pq_52:
    s_add_u32 s3, s61, 0
    buffer_load_dwordx4 a[0:3], v131, s[4:7], s3 offen offset:0 sc1
    buffer_load_dwordx4 a[4:7], v92, s[4:7], s3 offen offset:256 sc1
    buffer_load_dwordx4 a[8:11], v92, s[4:7], s3 offen offset:512 sc1
    s_add_u32 s3, s61, 18432
    buffer_load_dwordx4 a[12:15], v131, s[4:7], s3 offen offset:0 sc1
    buffer_load_dwordx4 a[16:19], v92, s[4:7], s3 offen offset:256 sc1
    buffer_load_dwordx4 a[20:23], v92, s[4:7], s3 offen offset:512 sc1
    s_add_u32 s3, s61, 36864
    buffer_load_dwordx4 a[24:27], v131, s[4:7], s3 offen offset:0 sc1
    buffer_load_dwordx4 a[28:31], v92, s[4:7], s3 offen offset:256 sc1
    buffer_load_dwordx4 a[32:35], v92, s[4:7], s3 offen offset:512 sc1
    s_add_u32 s3, s61, 55296
    buffer_load_dwordx4 a[36:39], v131, s[4:7], s3 offen offset:0 sc1
    buffer_load_dwordx4 a[40:43], v92, s[4:7], s3 offen offset:256 sc1
    buffer_load_dwordx4 a[44:47], v92, s[4:7], s3 offen offset:512 sc1
    ds_read_b64_tr_b16 v[56:57], v88 offset:0
    ds_read_b64_tr_b16 v[58:59], v88 offset:2048
    ds_read_b64_tr_b16 v[60:61], v89 offset:0
    ds_read_b64_tr_b16 v[62:63], v89 offset:2048
    ds_read_b64_tr_b16 v[64:65], v90 offset:0
    ds_read_b64_tr_b16 v[66:67], v90 offset:2048
    ds_read_b64_tr_b16 v[68:69], v91 offset:0
    ds_read_b64_tr_b16 v[70:71], v91 offset:2048
    s_waitcnt vmcnt(9) lgkmcnt(0)
    v_mfma_f32_16x16x32_bf16 v[8:11], v[56:59], a[0:3], v[8:11]
    s_add_u32 s3, s61, 73728
    buffer_load_dwordx4 a[48:51], v131, s[4:7], s3 offen offset:0 sc1
    v_mfma_f32_16x16x32_bf16 v[24:27], v[56:59], a[4:7], v[24:27]
    ds_read_b64_tr_b16 v[72:73], v88 offset:4096
    v_mfma_f32_16x16x32_bf16 v[40:43], v[56:59], a[8:11], v[40:43]
    ds_read_b64_tr_b16 v[74:75], v88 offset:6144
    v_mfma_f32_16x16x32_bf16 v[12:15], v[60:63], a[0:3], v[12:15]
    ds_read_b64_tr_b16 v[76:77], v89 offset:4096
    v_mfma_f32_16x16x32_bf16 v[28:31], v[60:63], a[4:7], v[28:31]
    buffer_load_dwordx4 a[52:55], v92, s[4:7], s3 offen offset:256 sc1
    v_mfma_f32_16x16x32_bf16 v[44:47], v[60:63], a[8:11], v[44:47]
    ds_read_b64_tr_b16 v[78:79], v89 offset:6144
    v_mfma_f32_16x16x32_bf16 v[16:19], v[64:67], a[0:3], 0
    ds_read_b64_tr_b16 v[80:81], v90 offset:4096
    v_mfma_f32_16x16x32_bf16 v[32:35], v[64:67], a[4:7], 0
    ds_read_b64_tr_b16 v[82:83], v90 offset:6144
    v_mfma_f32_16x16x32_bf16 v[48:51], v[64:67], a[8:11], 0
    buffer_load_dwordx4 a[56:59], v92, s[4:7], s3 offen offset:512 sc1
    v_mfma_f32_16x16x32_bf16 v[20:23], v[68:71], a[0:3], 0
    ds_read_b64_tr_b16 v[84:85], v91 offset:4096
    v_mfma_f32_16x16x32_bf16 v[36:39], v[68:71], a[4:7], 0
    ds_read_b64_tr_b16 v[86:87], v91 offset:6144
    v_mfma_f32_16x16x32_bf16 v[52:55], v[68:71], a[8:11], 0
    s_waitcnt vmcnt(9) lgkmcnt(0)
    v_mfma_f32_16x16x32_bf16 v[8:11], v[72:75], a[12:15], v[8:11]
    s_add_u32 s3, s61, 92160
    buffer_load_dwordx4 a[0:3], v131, s[4:7], s3 offen offset:0 sc1
    v_mfma_f32_16x16x32_bf16 v[24:27], v[72:75], a[16:19], v[24:27]
    ds_read_b64_tr_b16 v[56:57], v88 offset:8192
    v_mfma_f32_16x16x32_bf16 v[40:43], v[72:75], a[20:23], v[40:43]
    ds_read_b64_tr_b16 v[58:59], v88 offset:10240
    v_mfma_f32_16x16x32_bf16 v[12:15], v[76:79], a[12:15], v[12:15]
    ds_read_b64_tr_b16 v[60:61], v89 offset:8192
    v_mfma_f32_16x16x32_bf16 v[28:31], v[76:79], a[16:19], v[28:31]
    buffer_load_dwordx4 a[4:7], v92, s[4:7], s3 offen offset:256 sc1
    v_mfma_f32_16x16x32_bf16 v[44:47], v[76:79], a[20:23], v[44:47]
    ds_read_b64_tr_b16 v[62:63], v89 offset:10240
    v_mfma_f32_16x16x32_bf16 v[16:19], v[80:83], a[12:15], v[16:19]
    ds_read_b64_tr_b16 v[64:65], v90 offset:8192
    v_mfma_f32_16x16x32_bf16 v[32:35], v[80:83], a[16:19], v[32:35]
    ds_read_b64_tr_b16 v[66:67], v90 offset:10240
    v_mfma_f32_16x16x32_bf16 v[48:51], v[80:83], a[20:23], v[48:51]
    buffer_load_dwordx4 a[8:11], v92, s[4:7], s3 offen offset:512 sc1
    v_mfma_f32_16x16x32_bf16 v[20:23], v[84:87], a[12:15], v[20:23]
    ds_read_b64_tr_b16 v[68:69], v91 offset:8192
    v_mfma_f32_16x16x32_bf16 v[36:39], v[84:87], a[16:19], v[36:39]
    ds_read_b64_tr_b16 v[70:71], v91 offset:10240
    v_mfma_f32_16x16x32_bf16 v[52:55], v[84:87], a[20:23], v[52:55]
    s_waitcnt vmcnt(9) lgkmcnt(0)
    v_mfma_f32_16x16x32_bf16 v[8:11], v[56:59], a[24:27], v[8:11]
    s_add_u32 s3, s61, 110592
    buffer_load_dwordx4 a[12:15], v131, s[4:7], s3 offen offset:0 sc1
    v_mfma_f32_16x16x32_bf16 v[24:27], v[56:59], a[28:31], v[24:27]
    ds_read_b64_tr_b16 v[72:73], v88 offset:12288
    v_mfma_f32_16x16x32_bf16 v[40:43], v[56:59], a[32:35], v[40:43]
    ds_read_b64_tr_b16 v[74:75], v88 offset:14336
    v_mfma_f32_16x16x32_bf16 v[12:15], v[60:63], a[24:27], v[12:15]
    buffer_load_dwordx4 a[16:19], v92, s[4:7], s3 offen offset:256 sc1
    v_mfma_f32_16x16x32_bf16 v[28:31], v[60:63], a[28:31], v[28:31]
    ds_read_b64_tr_b16 v[76:77], v89 offset:12288
    v_mfma_f32_16x16x32_bf16 v[44:47], v[60:63], a[32:35], v[44:47]
    ds_read_b64_tr_b16 v[78:79], v89 offset:14336
    v_mfma_f32_16x16x32_bf16 v[16:19], v[64:67], a[24:27], v[16:19]
    buffer_load_dwordx4 a[20:23], v92, s[4:7], s3 offen offset:512 sc1
    v_mfma_f32_16x16x32_bf16 v[32:35], v[64:67], a[28:31], v[32:35]
    ds_read_b64_tr_b16 v[80:81], v90 offset:12288
    v_mfma_f32_16x16x32_bf16 v[48:51], v[64:67], a[32:35], v[48:51]
    ds_read_b64_tr_b16 v[82:83], v90 offset:14336
    v_mfma_f32_16x16x32_bf16 v[20:23], v[68:71], a[24:27], v[20:23]
    buffer_load_dword v95, v3, s[4:7], 0 offen offset:1024 sc1
    v_mfma_f32_16x16x32_bf16 v[36:39], v[68:71], a[28:31], v[36:39]
    ds_read_b64_tr_b16 v[84:85], v91 offset:12288
    v_mfma_f32_16x16x32_bf16 v[52:55], v[68:71], a[32:35], v[52:55]
    ds_read_b64_tr_b16 v[86:87], v91 offset:14336
    s_waitcnt vmcnt(10) lgkmcnt(0)
    v_mfma_f32_16x16x32_bf16 v[8:11], v[72:75], a[36:39], v[8:11]
    s_add_u32 s3, s61, 129024
    buffer_load_dwordx4 a[24:27], v131, s[4:7], s3 offen offset:0 sc1
    v_mfma_f32_16x16x32_bf16 v[24:27], v[72:75], a[40:43], v[24:27]
    ds_read_b64_tr_b16 v[56:57], v88 offset:16384
    v_mfma_f32_16x16x32_bf16 v[40:43], v[72:75], a[44:47], v[40:43]
    ds_read_b64_tr_b16 v[58:59], v88 offset:18432
    v_mfma_f32_16x16x32_bf16 v[12:15], v[76:79], a[36:39], v[12:15]
    ds_read_b64_tr_b16 v[60:61], v89 offset:16384
    v_mfma_f32_16x16x32_bf16 v[28:31], v[76:79], a[40:43], v[28:31]
    buffer_load_dwordx4 a[28:31], v92, s[4:7], s3 offen offset:256 sc1
    v_mfma_f32_16x16x32_bf16 v[44:47], v[76:79], a[44:47], v[44:47]
    ds_read_b64_tr_b16 v[62:63], v89 offset:18432
    v_mfma_f32_16x16x32_bf16 v[16:19], v[80:83], a[36:39], v[16:19]
    ds_read_b64_tr_b16 v[64:65], v90 offset:16384
    v_mfma_f32_16x16x32_bf16 v[32:35], v[80:83], a[40:43], v[32:35]
    ds_read_b64_tr_b16 v[66:67], v90 offset:18432
    v_mfma_f32_16x16x32_bf16 v[48:51], v[80:83], a[44:47], v[48:51]
    buffer_load_dwordx4 a[32:35], v92, s[4:7], s3 offen offset:512 sc1
    v_mfma_f32_16x16x32_bf16 v[20:23], v[84:87], a[36:39], v[20:23]
    ds_read_b64_tr_b16 v[68:69], v91 offset:16384
    v_mfma_f32_16x16x32_bf16 v[36:39], v[84:87], a[40:43], v[36:39]
    ds_read_b64_tr_b16 v[70:71], v91 offset:18432
    v_mfma_f32_16x16x32_bf16 v[52:55], v[84:87], a[44:47], v[52:55]
    s_waitcnt vmcnt(10) lgkmcnt(0)
    v_mfma_f32_16x16x32_bf16 v[8:11], v[56:59], a[48:51], v[8:11]
    s_add_u32 s3, s61, 147456
    buffer_load_dwordx4 a[36:39], v131, s[4:7], s3 offen offset:0 sc1
    v_mfma_f32_16x16x32_bf16 v[24:27], v[56:59], a[52:55], v[24:27]
    ds_read_b64_tr_b16 v[72:73], v88 offset:20480
    v_mfma_f32_16x16x32_bf16 v[40:43], v[56:59], a[56:59], v[40:43]
    ds_read_b64_tr_b16 v[74:75], v88 offset:22528
    v_mfma_f32_16x16x32_bf16 v[12:15], v[60:63], a[48:51], v[12:15]
    ds_read_b64_tr_b16 v[76:77], v89 offset:20480
    v_mfma_f32_16x16x32_bf16 v[28:31], v[60:63], a[52:55], v[28:31]
    buffer_load_dwordx4 a[40:43], v92, s[4:7], s3 offen offset:256 sc1
    v_mfma_f32_16x16x32_bf16 v[44:47], v[60:63], a[56:59], v[44:47]
    ds_read_b64_tr_b16 v[78:79], v89 offset:22528
    v_mfma_f32_16x16x32_bf16 v[16:19], v[64:67], a[48:51], v[16:19]
    ds_read_b64_tr_b16 v[80:81], v90 offset:20480
    v_mfma_f32_16x16x32_bf16 v[32:35], v[64:67], a[52:55], v[32:35]
    ds_read_b64_tr_b16 v[82:83], v90 offset:22528
    v_mfma_f32_16x16x32_bf16 v[48:51], v[64:67], a[56:59], v[48:51]
    buffer_load_dwordx4 a[44:47], v92, s[4:7], s3 offen offset:512 sc1
    v_mfma_f32_16x16x32_bf16 v[20:23], v[68:71], a[48:51], v[20:23]
    ds_read_b64_tr_b16 v[84:85], v91 offset:20480
    v_mfma_f32_16x16x32_bf16 v[36:39], v[68:71], a[52:55], v[36:39]
    ds_read_b64_tr_b16 v[86:87], v91 offset:22528
    v_mfma_f32_16x16x32_bf16 v[52:55], v[68:71], a[56:59], v[52:55]
    s_waitcnt vmcnt(10) lgkmcnt(0)
    v_mfma_f32_16x16x32_bf16 v[8:11], v[72:75], a[0:3], v[8:11]
    s_add_u32 s3, s61, 165888
    buffer_load_dwordx4 a[48:51], v131, s[4:7], s3 offen offset:0 sc1
    v_mfma_f32_16x16x32_bf16 v[24:27], v[72:75], a[4:7], v[24:27]
    ds_read_b64_tr_b16 v[56:57], v88 offset:24576
    v_mfma_f32_16x16x32_bf16 v[40:43], v[72:75], a[8:11], v[40:43]
    ds_read_b64_tr_b16 v[58:59], v88 offset:26624
    v_mfma_f32_16x16x32_bf16 v[12:15], v[76:79], a[0:3], v[12:15]
    ds_read_b64_tr_b16 v[60:61], v89 offset:24576
    v_mfma_f32_16x16x32_bf16 v[28:31], v[76:79], a[4:7], v[28:31]
    buffer_load_dwordx4 a[52:55], v92, s[4:7], s3 offen offset:256 sc1
    v_mfma_f32_16x16x32_bf16 v[44:47], v[76:79], a[8:11], v[44:47]
    ds_read_b64_tr_b16 v[62:63], v89 offset:26624
    v_mfma_f32_16x16x32_bf16 v[16:19], v[80:83], a[0:3], v[16:19]
    ds_read_b64_tr_b16 v[64:65], v90 offset:24576
    v_mfma_f32_16x16x32_bf16 v[32:35], v[80:83], a[4:7], v[32:35]
    ds_read_b64_tr_b16 v[66:67], v90 offset:26624
    v_mfma_f32_16x16x32_bf16 v[48:51], v[80:83], a[8:11], v[48:51]
    buffer_load_dwordx4 a[56:59], v92, s[4:7], s3 offen offset:512 sc1
    v_mfma_f32_16x16x32_bf16 v[20:23], v[84:87], a[0:3], v[20:23]
    ds_read_b64_tr_b16 v[68:69], v91 offset:24576
    v_mfma_f32_16x16x32_bf16 v[36:39], v[84:87], a[4:7], v[36:39]
    ds_read_b64_tr_b16 v[70:71], v91 offset:26624
    v_mfma_f32_16x16x32_bf16 v[52:55], v[84:87], a[8:11], v[52:55]
    s_waitcnt vmcnt(10) lgkmcnt(0)
    s_barrier
    v_mfma_f32_16x16x32_bf16 v[8:11], v[56:59], a[12:15], v[8:11]
    ds_read_b64_tr_b16 v[72:73], v88 offset:28672
    v_mfma_f32_16x16x32_bf16 v[24:27], v[56:59], a[16:19], v[24:27]
    ds_read_b64_tr_b16 v[74:75], v88 offset:30720
    v_mfma_f32_16x16x32_bf16 v[40:43], v[56:59], a[20:23], v[40:43]
    ds_read_b64_tr_b16 v[76:77], v89 offset:28672
    v_mfma_f32_16x16x32_bf16 v[12:15], v[60:63], a[12:15], v[12:15]
    ds_read_b64_tr_b16 v[78:79], v89 offset:30720
    v_mfma_f32_16x16x32_bf16 v[28:31], v[60:63], a[16:19], v[28:31]
    ds_read_b64_tr_b16 v[80:81], v90 offset:28672
    v_mfma_f32_16x16x32_bf16 v[44:47], v[60:63], a[20:23], v[44:47]
    ds_read_b64_tr_b16 v[82:83], v90 offset:30720
    v_mfma_f32_16x16x32_bf16 v[16:19], v[64:67], a[12:15], v[16:19]
    ds_read_b64_tr_b16 v[84:85], v91 offset:28672
    v_mfma_f32_16x16x32_bf16 v[32:35], v[64:67], a[16:19], v[32:35]
    ds_read_b64_tr_b16 v[86:87], v91 offset:30720
    v_mfma_f32_16x16x32_bf16 v[48:51], v[64:67], a[20:23], v[48:51]
    v_mfma_f32_16x16x32_bf16 v[20:23], v[68:71], a[12:15], v[20:23]
    v_mfma_f32_16x16x32_bf16 v[36:39], v[68:71], a[16:19], v[36:39]
    v_mfma_f32_16x16x32_bf16 v[52:55], v[68:71], a[20:23], v[52:55]
    s_waitcnt vmcnt(6) lgkmcnt(0)
    v_mfma_f32_16x16x32_bf16 v[16:19], v[80:83], a[24:27], v[16:19]
    ds_read_b64_tr_b16 v[64:65], v90 offset:32768
    ds_read_b64_tr_b16 v[66:67], v90 offset:34816
    v_mfma_f32_16x16x32_bf16 v[32:35], v[80:83], a[28:31], v[32:35]
    ds_read_b64_tr_b16 v[68:69], v91 offset:32768
    ds_read_b64_tr_b16 v[70:71], v91 offset:34816
    v_mfma_f32_16x16x32_bf16 v[48:51], v[80:83], a[32:35], v[48:51]
    v_mfma_f32_16x16x32_bf16 v[20:23], v[84:87], a[24:27], v[20:23]
    v_mfma_f32_16x16x32_bf16 v[36:39], v[84:87], a[28:31], v[36:39]
    v_mfma_f32_16x16x32_bf16 v[52:55], v[84:87], a[32:35], v[52:55]
    s_waitcnt vmcnt(3) lgkmcnt(0)
    v_mfma_f32_16x16x32_bf16 v[16:19], v[64:67], a[36:39], v[16:19]
    ds_read_b64_tr_b16 v[80:81], v90 offset:36864
    ds_read_b64_tr_b16 v[82:83], v90 offset:38912
    v_mfma_f32_16x16x32_bf16 v[32:35], v[64:67], a[40:43], v[32:35]
    ds_read_b64_tr_b16 v[84:85], v91 offset:36864
    ds_read_b64_tr_b16 v[86:87], v91 offset:38912
    v_mfma_f32_16x16x32_bf16 v[48:51], v[64:67], a[44:47], v[48:51]
    v_mfma_f32_16x16x32_bf16 v[20:23], v[68:71], a[36:39], v[20:23]
    v_mfma_f32_16x16x32_bf16 v[36:39], v[68:71], a[40:43], v[36:39]
    v_mfma_f32_16x16x32_bf16 v[52:55], v[68:71], a[44:47], v[52:55]
    s_waitcnt vmcnt(0) lgkmcnt(0)
    v_mfma_f32_16x16x32_bf16 v[16:19], v[80:83], a[48:51], v[16:19]
    ds_read_b64_tr_b16 v[56:57], v88 offset:32768
    ds_read_b64_tr_b16 v[58:59], v88 offset:34816
    v_mfma_f32_16x16x32_bf16 v[32:35], v[80:83], a[52:55], v[32:35]
    ds_read_b64_tr_b16 v[60:61], v89 offset:32768
    ds_read_b64_tr_b16 v[62:63], v89 offset:34816
    v_mfma_f32_16x16x32_bf16 v[48:51], v[80:83], a[56:59], v[48:51]
    ds_read_b64_tr_b16 v[64:65], v88 offset:36864
    ds_read_b64_tr_b16 v[66:67], v88 offset:38912
    v_mfma_f32_16x16x32_bf16 v[20:23], v[84:87], a[48:51], v[20:23]
    ds_read_b64_tr_b16 v[68:69], v89 offset:36864
    ds_read_b64_tr_b16 v[70:71], v89 offset:38912
    v_mfma_f32_16x16x32_bf16 v[36:39], v[84:87], a[52:55], v[36:39]
    v_mfma_f32_16x16x32_bf16 v[52:55], v[84:87], a[56:59], v[52:55]
    v_mfma_f32_16x16x32_bf16 v[8:11], v[72:75], a[24:27], v[8:11]
    v_mfma_f32_16x16x32_bf16 v[24:27], v[72:75], a[28:31], v[24:27]
    ds_write_b128 v93, v[16:19] offset:0
    v_mfma_f32_16x16x32_bf16 v[40:43], v[72:75], a[32:35], v[40:43]
    v_mfma_f32_16x16x32_bf16 v[12:15], v[76:79], a[24:27], v[12:15]
    ds_write_b128 v93, v[32:35] offset:2048
    v_mfma_f32_16x16x32_bf16 v[28:31], v[76:79], a[28:31], v[28:31]
    v_mfma_f32_16x16x32_bf16 v[44:47], v[76:79], a[32:35], v[44:47]
    ds_write_b128 v93, v[48:51] offset:4096
    s_waitcnt lgkmcnt(3)
    v_mfma_f32_16x16x32_bf16 v[8:11], v[56:59], a[36:39], v[8:11]
    v_mfma_f32_16x16x32_bf16 v[24:27], v[56:59], a[40:43], v[24:27]
    ds_write_b128 v93, v[20:23] offset:1024
    v_mfma_f32_16x16x32_bf16 v[40:43], v[56:59], a[44:47], v[40:43]
    v_mfma_f32_16x16x32_bf16 v[12:15], v[60:63], a[36:39], v[12:15]
    ds_write_b128 v93, v[36:39] offset:3072
    v_mfma_f32_16x16x32_bf16 v[28:31], v[60:63], a[40:43], v[28:31]
    v_mfma_f32_16x16x32_bf16 v[44:47], v[60:63], a[44:47], v[44:47]
    ds_write_b128 v93, v[52:55] offset:5120
    v_mfma_f32_16x16x32_bf16 v[8:11], v[64:67], a[48:51], v[8:11]
    v_mfma_f32_16x16x32_bf16 v[24:27], v[64:67], a[52:55], v[24:27]
    v_mfma_f32_16x16x32_bf16 v[40:43], v[64:67], a[56:59], v[40:43]
    v_mfma_f32_16x16x32_bf16 v[12:15], v[68:71], a[48:51], v[12:15]
    v_mfma_f32_16x16x32_bf16 v[28:31], v[68:71], a[52:55], v[28:31]
    v_mfma_f32_16x16x32_bf16 v[44:47], v[68:71], a[56:59], v[44:47]
    s_waitcnt lgkmcnt(0)
    s_barrier
    ds_read_b128 v[16:19], v94 offset:0
    ds_read_b128 v[20:23], v94 offset:1024
    ds_read_b128 v[32:35], v94 offset:2048
    ds_read_b128 v[36:39], v94 offset:3072
    ds_read_b128 v[48:51], v94 offset:4096
    ds_read_b128 v[52:55], v94 offset:5120
    s_waitcnt lgkmcnt(4)
    v_pk_add_f32 v[8:9], v[8:9], v[16:17]
    v_pk_add_f32 v[10:11], v[10:11], v[18:19]
    v_pk_add_f32 v[12:13], v[12:13], v[20:21]
    v_pk_add_f32 v[14:15], v[14:15], v[22:23]
    s_waitcnt lgkmcnt(2)
    v_pk_add_f32 v[24:25], v[24:25], v[32:33]
    v_pk_add_f32 v[26:27], v[26:27], v[34:35]
    v_pk_add_f32 v[28:29], v[28:29], v[36:37]
    v_pk_add_f32 v[30:31], v[30:31], v[38:39]
    s_waitcnt lgkmcnt(0)
    s_barrier
    v_pk_add_f32 v[40:41], v[40:41], v[48:49]
    v_pk_add_f32 v[42:43], v[42:43], v[50:51]
    v_pk_add_f32 v[44:45], v[44:45], v[52:53]
    v_pk_add_f32 v[46:47], v[46:47], v[54:55]
    v_cvt_pk_bf16_f32 v100, v8, v9
    v_cvt_pk_bf16_f32 v101, v10, v11
    v_cvt_pk_bf16_f32 v102, v12, v13
    v_cvt_pk_bf16_f32 v103, v14, v15
    s_cmp_lg_u32 s54, 0
    s_cbranch_scc1 L_du_53
    buffer_store_dwordx4 v[100:103], v96, s[4:7], 0 offen offset:0 sc1
L_du_53:
    v_mfma_f32_16x16x32_bf16 v[60:63], v[100:103], v[100:103], 0
    v_mfma_f32_16x16x32_bf16 v[56:59], v[4:7], v[100:103], 0
    v_cvt_pk_bf16_f32 v104, v24, v25
    v_cvt_pk_bf16_f32 v105, v26, v27
    v_cvt_pk_bf16_f32 v106, v28, v29
    v_cvt_pk_bf16_f32 v107, v30, v31
    buffer_store_dwordx4 v[104:107], v96, s[4:7], 0 offen offset:256 sc1
    s_nop 0
    v_mfma_f32_16x16x32_bf16 v[68:71], v[104:107], v[104:107], 0
    v_mfma_f32_16x16x32_bf16 v[64:67], v[4:7], v[104:107], 0
    v_cvt_pk_bf16_f32 v108, v40, v41
    v_cvt_pk_bf16_f32 v109, v42, v43
    v_cvt_pk_bf16_f32 v110, v44, v45
    v_cvt_pk_bf16_f32 v111, v46, v47
    buffer_store_dwordx4 v[108:111], v96, s[4:7], 0 offen offset:512 sc1
    s_nop 0
    v_mfma_f32_16x16x32_bf16 v[76:79], v[108:111], v[108:111], 0
    v_mfma_f32_16x16x32_bf16 v[72:75], v[4:7], v[108:111], 0
    v_cndmask_b32 v60, v60, v61, s[26:27]
    v_cndmask_b32 v62, v62, v63, s[26:27]
    v_cndmask_b32 v68, v68, v69, s[26:27]
    v_cndmask_b32 v70, v70, v71, s[26:27]
    s_nop 2
    v_cndmask_b32 v76, v76, v77, s[26:27]
    v_cndmask_b32 v78, v78, v79, s[26:27]
    s_movk_i32 s3, 5120
    v_cndmask_b32 v57, v60, v62, s[28:29]
    s_cmp_lg_u32 s54, 0
    s_cbranch_scc1 L_du_54
    buffer_store_dwordx2 v[56:57], v97, s[4:7], 0 offen offset:0
L_du_54:
    v_cndmask_b32 v65, v68, v70, s[28:29]
    buffer_store_dwordx2 v[64:65], v97, s[4:7], 0 offen offset:2560
    v_cndmask_b32 v73, v76, v78, s[28:29]
    buffer_store_dwordx2 v[72:73], v97, s[4:7], s3 offen offset:0
    v_add_u32 v40, 0, v134
    v_xor_b32 v41, 32, v40
    v_add_u32 v42, 40960, v40
    v_add_u32 v43, 40960, v41
    ds_read_b64_tr_b16 v[8:9], v40 offset:0
    ds_read_b64_tr_b16 v[10:11], v40 offset:2048
    ds_read_b64_tr_b16 v[12:13], v41 offset:0
    ds_read_b64_tr_b16 v[14:15], v41 offset:2048
    ds_read_b64_tr_b16 v[16:17], v40 offset:4096
    ds_read_b64_tr_b16 v[18:19], v40 offset:6144
    ds_read_b64_tr_b16 v[20:21], v41 offset:4096
    ds_read_b64_tr_b16 v[22:23], v41 offset:6144
    ds_read_b64_tr_b16 v[24:25], v40 offset:8192
    ds_read_b64_tr_b16 v[26:27], v40 offset:10240
    ds_read_b64_tr_b16 v[28:29], v41 offset:8192
    ds_read_b64_tr_b16 v[30:31], v41 offset:10240
    ds_read_b64_tr_b16 v[32:33], v40 offset:12288
    ds_read_b64_tr_b16 v[34:35], v40 offset:14336
    ds_read_b64_tr_b16 v[36:37], v41 offset:12288
    ds_read_b64_tr_b16 v[38:39], v41 offset:14336
    s_waitcnt lgkmcnt(12)
    v_mfma_f32_16x16x32_bf16 v[96:99], v[8:11], v[4:7], 0
    v_mfma_f32_16x16x32_bf16 v[100:103], v[12:15], v[4:7], 0
    ds_read_b64_tr_b16 v[8:9], v40 offset:16384
    ds_read_b64_tr_b16 v[10:11], v40 offset:18432
    ds_read_b64_tr_b16 v[12:13], v41 offset:16384
    ds_read_b64_tr_b16 v[14:15], v41 offset:18432
    s_waitcnt lgkmcnt(12)
    v_mfma_f32_16x16x32_bf16 v[96:99], v[16:19], v[4:7], v[96:99]
    v_mfma_f32_16x16x32_bf16 v[100:103], v[20:23], v[4:7], v[100:103]
    ds_read_b64_tr_b16 v[16:17], v40 offset:20480
    ds_read_b64_tr_b16 v[18:19], v40 offset:22528
    ds_read_b64_tr_b16 v[20:21], v41 offset:20480
    ds_read_b64_tr_b16 v[22:23], v41 offset:22528
    s_waitcnt lgkmcnt(12)
    v_mfma_f32_16x16x32_bf16 v[96:99], v[24:27], v[4:7], v[96:99]
    v_mfma_f32_16x16x32_bf16 v[100:103], v[28:31], v[4:7], v[100:103]
    ds_read_b64_tr_b16 v[24:25], v40 offset:24576
    ds_read_b64_tr_b16 v[26:27], v40 offset:26624
    ds_read_b64_tr_b16 v[28:29], v41 offset:24576
    ds_read_b64_tr_b16 v[30:31], v41 offset:26624
    s_waitcnt lgkmcnt(12)
    v_mfma_f32_16x16x32_bf16 v[96:99], v[32:35], v[4:7], v[96:99]
    v_mfma_f32_16x16x32_bf16 v[100:103], v[36:39], v[4:7], v[100:103]
    v_mov_b32 v3, 1
    s_mov_b64 exec, 1
    s_cmp_eq_u32 s50, 0
    s_cbranch_scc0 L_pf_55
    s_waitcnt vmcnt(0)
    buffer_store_dword v3, v135, s[4:7], 0 offen offset:1024
    s_branch L_pg_56
L_pf_55:
    s_waitcnt vmcnt(0)
    buffer_wbl2 sc1
    s_waitcnt vmcnt(0)
    buffer_store_dword v3, v135, s[4:7], 0 offen offset:1024 sc1
L_pg_56:
    s_mov_b64 exec, -1
    ds_read_b64_tr_b16 v[32:33], v40 offset:28672
    ds_read_b64_tr_b16 v[34:35], v40 offset:30720
    ds_read_b64_tr_b16 v[36:37], v41 offset:28672
    ds_read_b64_tr_b16 v[38:39], v41 offset:30720
    s_waitcnt lgkmcnt(12)
    v_mfma_f32_16x16x32_bf16 v[96:99], v[8:11], v[4:7], v[96:99]
    v_mfma_f32_16x16x32_bf16 v[100:103], v[12:15], v[4:7], v[100:103]
    ds_read_b64_tr_b16 v[8:9], v40 offset:32768
    ds_read_b64_tr_b16 v[10:11], v40 offset:34816
    ds_read_b64_tr_b16 v[12:13], v41 offset:32768
    ds_read_b64_tr_b16 v[14:15], v41 offset:34816
    s_waitcnt lgkmcnt(12)
    v_mfma_f32_16x16x32_bf16 v[96:99], v[16:19], v[4:7], v[96:99]
    v_mfma_f32_16x16x32_bf16 v[100:103], v[20:23], v[4:7], v[100:103]
    ds_read_b64_tr_b16 v[16:17], v40 offset:36864
    ds_read_b64_tr_b16 v[18:19], v40 offset:38912
    ds_read_b64_tr_b16 v[20:21], v41 offset:36864
    ds_read_b64_tr_b16 v[22:23], v41 offset:38912
    s_waitcnt lgkmcnt(12)
    v_mfma_f32_16x16x32_bf16 v[96:99], v[24:27], v[4:7], v[96:99]
    v_mfma_f32_16x16x32_bf16 v[100:103], v[28:31], v[4:7], v[100:103]
    ds_read_b64_tr_b16 v[24:25], v42 offset:0
    ds_read_b64_tr_b16 v[26:27], v42 offset:2048
    ds_read_b64_tr_b16 v[28:29], v43 offset:0
    ds_read_b64_tr_b16 v[30:31], v43 offset:2048
    s_waitcnt lgkmcnt(12)
    v_mfma_f32_16x16x32_bf16 v[96:99], v[32:35], v[4:7], v[96:99]
    v_mfma_f32_16x16x32_bf16 v[100:103], v[36:39], v[4:7], v[100:103]
    ds_read_b64_tr_b16 v[32:33], v42 offset:4096
    ds_read_b64_tr_b16 v[34:35], v42 offset:6144
    ds_read_b64_tr_b16 v[36:37], v43 offset:4096
    ds_read_b64_tr_b16 v[38:39], v43 offset:6144
    s_waitcnt lgkmcnt(12)
    v_mfma_f32_16x16x32_bf16 v[96:99], v[8:11], v[4:7], v[96:99]
    v_mfma_f32_16x16x32_bf16 v[100:103], v[12:15], v[4:7], v[100:103]
    ds_read_b64_tr_b16 v[8:9], v42 offset:8192
    ds_read_b64_tr_b16 v[10:11], v42 offset:10240
    ds_read_b64_tr_b16 v[12:13], v43 offset:8192
    ds_read_b64_tr_b16 v[14:15], v43 offset:10240
    s_waitcnt lgkmcnt(12)
    v_mfma_f32_16x16x32_bf16 v[96:99], v[16:19], v[4:7], v[96:99]
    v_mfma_f32_16x16x32_bf16 v[100:103], v[20:23], v[4:7], v[100:103]
    ds_read_b64_tr_b16 v[16:17], v42 offset:12288
    ds_read_b64_tr_b16 v[18:19], v42 offset:14336
    ds_read_b64_tr_b16 v[20:21], v43 offset:12288
    ds_read_b64_tr_b16 v[22:23], v43 offset:14336
    s_waitcnt lgkmcnt(12)
    v_mfma_f32_16x16x32_bf16 v[96:99], v[24:27], v[4:7], v[96:99]
    v_mfma_f32_16x16x32_bf16 v[100:103], v[28:31], v[4:7], v[100:103]
    ds_read_b64_tr_b16 v[24:25], v42 offset:16384
    ds_read_b64_tr_b16 v[26:27], v42 offset:18432
    ds_read_b64_tr_b16 v[28:29], v43 offset:16384
    ds_read_b64_tr_b16 v[30:31], v43 offset:18432
    s_waitcnt lgkmcnt(12)
    v_mfma_f32_16x16x32_bf16 v[96:99], v[32:35], v[4:7], v[96:99]
    v_mfma_f32_16x16x32_bf16 v[100:103], v[36:39], v[4:7], v[100:103]
    ds_read_b64_tr_b16 v[32:33], v42 offset:20480
    ds_read_b64_tr_b16 v[34:35], v42 offset:22528
    ds_read_b64_tr_b16 v[36:37], v43 offset:20480
    ds_read_b64_tr_b16 v[38:39], v43 offset:22528
    s_waitcnt lgkmcnt(12)
    v_mfma_f32_16x16x32_bf16 v[96:99], v[8:11], v[4:7], v[96:99]
    v_mfma_f32_16x16x32_bf16 v[100:103], v[12:15], v[4:7], v[100:103]
    ds_read_b64_tr_b16 v[8:9], v42 offset:24576
    ds_read_b64_tr_b16 v[10:11], v42 offset:26624
    ds_read_b64_tr_b16 v[12:13], v43 offset:24576
    ds_read_b64_tr_b16 v[14:15], v43 offset:26624
    s_waitcnt lgkmcnt(12)
    v_mfma_f32_16x16x32_bf16 v[96:99], v[16:19], v[4:7], v[96:99]
    v_mfma_f32_16x16x32_bf16 v[100:103], v[20:23], v[4:7], v[100:103]
    ds_read_b64_tr_b16 v[16:17], v42 offset:28672
    ds_read_b64_tr_b16 v[18:19], v42 offset:30720
    ds_read_b64_tr_b16 v[20:21], v43 offset:28672
    ds_read_b64_tr_b16 v[22:23], v43 offset:30720
    s_waitcnt lgkmcnt(12)
    v_mfma_f32_16x16x32_bf16 v[96:99], v[24:27], v[4:7], v[96:99]
    v_mfma_f32_16x16x32_bf16 v[100:103], v[28:31], v[4:7], v[100:103]
    ds_read_b64_tr_b16 v[24:25], v42 offset:32768
    ds_read_b64_tr_b16 v[26:27], v42 offset:34816
    ds_read_b64_tr_b16 v[28:29], v43 offset:32768
    ds_read_b64_tr_b16 v[30:31], v43 offset:34816
    s_waitcnt lgkmcnt(12)
    v_mfma_f32_16x16x32_bf16 v[96:99], v[32:35], v[4:7], v[96:99]
    v_mfma_f32_16x16x32_bf16 v[100:103], v[36:39], v[4:7], v[100:103]
    ds_read_b64_tr_b16 v[32:33], v42 offset:36864
    ds_read_b64_tr_b16 v[34:35], v42 offset:38912
    ds_read_b64_tr_b16 v[36:37], v43 offset:36864
    ds_read_b64_tr_b16 v[38:39], v43 offset:38912
    s_waitcnt lgkmcnt(12)
    v_mfma_f32_16x16x32_bf16 v[96:99], v[8:11], v[4:7], v[96:99]
    v_mfma_f32_16x16x32_bf16 v[100:103], v[12:15], v[4:7], v[100:103]
    s_waitcnt lgkmcnt(8)
    v_mfma_f32_16x16x32_bf16 v[96:99], v[16:19], v[4:7], v[96:99]
    v_mfma_f32_16x16x32_bf16 v[100:103], v[20:23], v[4:7], v[100:103]
    s_waitcnt lgkmcnt(4)
    v_mfma_f32_16x16x32_bf16 v[96:99], v[24:27], v[4:7], v[96:99]
    v_mfma_f32_16x16x32_bf16 v[100:103], v[28:31], v[4:7], v[100:103]
    s_waitcnt lgkmcnt(0)
    v_mfma_f32_16x16x32_bf16 v[96:99], v[32:35], v[4:7], v[96:99]
    v_mfma_f32_16x16x32_bf16 v[100:103], v[36:39], v[4:7], v[100:103]
    s_mul_i32 s3, s46, 40960
    s_add_u32 s3, s3, 0
    v_add_u32 v88, s3, v134
    v_xor_b32 v89, 32, v88
    v_xor_b32 v90, 64, v88
    v_xor_b32 v91, 96, v88
    s_lshl_b32 s3, s56, 8
    s_add_u32 s3, s3, 385024
    v_add_u32 v92, s3, v132
    s_cmp_eq_u32 s54, 0
    s_cselect_b32 s3, 0, 1073741824
    v_add_u32 v131, s3, v92
    s_lshl_b32 s3, s45, 13
    s_add_u32 s3, s3, 0
    s_mul_i32 s52, s46, 40960
    s_add_u32 s53, s52, s3
    v_lshl_add_u32 v93, v0, 4, s53
    s_sub_u32 s52, 40960, s52
    s_add_u32 s53, s52, s3
    v_lshl_add_u32 v94, v0, 4, s53
    s_mul_i32 s3, s45, 768
    s_add_u32 s3, s3, 16384
    v_lshl_add_u32 v128, v2, 4, s3
    s_mul_i32 s53, s41, 52
    s_lshr_b32 s53, s53, 8
    s_lshl_b32 s53, s53, 3
    s_lshr_b32 s53, 0x060a0709, s53
    s_and_b32 s59, s53, 0xff
    s_lshl_b32 s3, s56, 8
    s_add_u32 s3, s3, s47
    s_add_u32 s3, s3, 16384
    v_add_u32 v124, s3, v132
    s_lshl_b32 s3, s59, 4
    v_add_u32 v124, s3, v124
    s_lshl_b32 s3, s56, 4
    s_lshl_b32 s52, s38, 8
    s_add_u32 s3, s3, s52
    s_sub_u32 s3, s3, 8
    v_add_u32 v125, s3, v2
    v_cmp_gt_u32 vcc, 2048, v125
    s_nop 0
    s_mov_b64 s[16:17], vcc
    v_add_u32 v125, 16, v125
    v_cmp_gt_u32 vcc, 2048, v125
    s_nop 0
    s_mov_b64 s[18:19], vcc
    v_add_u32 v125, 16, v125
    v_cmp_gt_u32 vcc, 2048, v125
    s_nop 0
    s_mov_b64 s[22:23], vcc
    v_add_u32 v125, 16, v125
    s_lshl_b32 s3, s56, 7
    s_add_u32 s3, s3, 2265088
    v_lshl_add_u32 v125, v2, 3, s3
    s_mov_b32 s62, 400000
    v_lshlrev_b32 v3, 3, v0
    s_lshl_b32 s3, s31, 1
    s_lshl_b32 s52, 20, 1
    s_bfm_b64 exec, s52, s3
L_po_57:
    buffer_load_dwordx2 v[126:127], v3, s[4:7], 0 offen offset:1024 sc1
    s_waitcnt vmcnt(0)
    v_and_b32 v126, v126, v127
    v_cmp_eq_u32 vcc, 0, v126
    s_cbranch_vccz L_pp_58
    s_sub_u32 s62, s62, 1
    s_cbranch_scc0 L_po_57
    s_endpgm
L_pp_58:
    s_mov_b64 exec, -1
    s_cmp_eq_u32 s50, 0
    s_cbranch_scc1 L_pq_59
    buffer_inv sc1
    s_waitcnt vmcnt(0)
L_pq_59:
    s_add_u32 s3, s61, 0
    buffer_load_dwordx4 a[0:3], v131, s[4:7], s3 offen offset:0 sc1
    buffer_load_dwordx4 a[4:7], v92, s[4:7], s3 offen offset:256 sc1
    buffer_load_dwordx4 a[8:11], v92, s[4:7], s3 offen offset:512 sc1
    s_add_u32 s3, s61, 18432
    buffer_load_dwordx4 a[12:15], v131, s[4:7], s3 offen offset:0 sc1
    buffer_load_dwordx4 a[16:19], v92, s[4:7], s3 offen offset:256 sc1
    buffer_load_dwordx4 a[20:23], v92, s[4:7], s3 offen offset:512 sc1
    s_add_u32 s3, s61, 36864
    buffer_load_dwordx4 a[24:27], v131, s[4:7], s3 offen offset:0 sc1
    buffer_load_dwordx4 a[28:31], v92, s[4:7], s3 offen offset:256 sc1
    buffer_load_dwordx4 a[32:35], v92, s[4:7], s3 offen offset:512 sc1
    s_add_u32 s3, s61, 55296
    buffer_load_dwordx4 a[36:39], v131, s[4:7], s3 offen offset:0 sc1
    buffer_load_dwordx4 a[40:43], v92, s[4:7], s3 offen offset:256 sc1
    buffer_load_dwordx4 a[44:47], v92, s[4:7], s3 offen offset:512 sc1
    ds_read_b64_tr_b16 v[56:57], v88 offset:0
    ds_read_b64_tr_b16 v[58:59], v88 offset:2048
    ds_read_b64_tr_b16 v[60:61], v89 offset:0
    ds_read_b64_tr_b16 v[62:63], v89 offset:2048
    ds_read_b64_tr_b16 v[64:65], v90 offset:0
    ds_read_b64_tr_b16 v[66:67], v90 offset:2048
    ds_read_b64_tr_b16 v[68:69], v91 offset:0
    ds_read_b64_tr_b16 v[70:71], v91 offset:2048
    s_waitcnt vmcnt(9) lgkmcnt(0)
    v_mfma_f32_16x16x32_bf16 v[8:11], v[56:59], a[0:3], 0
    s_add_u32 s3, s61, 73728
    buffer_load_dwordx4 a[48:51], v131, s[4:7], s3 offen offset:0 sc1
    v_mfma_f32_16x16x32_bf16 v[24:27], v[56:59], a[4:7], 0
    ds_read_b64_tr_b16 v[72:73], v88 offset:4096
    v_mfma_f32_16x16x32_bf16 v[40:43], v[56:59], a[8:11], 0
    ds_read_b64_tr_b16 v[74:75], v88 offset:6144
    v_mfma_f32_16x16x32_bf16 v[12:15], v[60:63], a[0:3], 0
    ds_read_b64_tr_b16 v[76:77], v89 offset:4096
    v_mfma_f32_16x16x32_bf16 v[28:31], v[60:63], a[4:7], 0
    buffer_load_dwordx4 a[52:55], v92, s[4:7], s3 offen offset:256 sc1
    v_mfma_f32_16x16x32_bf16 v[44:47], v[60:63], a[8:11], 0
    ds_read_b64_tr_b16 v[78:79], v89 offset:6144
    v_mfma_f32_16x16x32_bf16 v[16:19], v[64:67], a[0:3], 0
    ds_read_b64_tr_b16 v[80:81], v90 offset:4096
    v_mfma_f32_16x16x32_bf16 v[32:35], v[64:67], a[4:7], 0
    ds_read_b64_tr_b16 v[82:83], v90 offset:6144
    v_mfma_f32_16x16x32_bf16 v[48:51], v[64:67], a[8:11], 0
    buffer_load_dwordx4 a[56:59], v92, s[4:7], s3 offen offset:512 sc1
    v_mfma_f32_16x16x32_bf16 v[20:23], v[68:71], a[0:3], 0
    ds_read_b64_tr_b16 v[84:85], v91 offset:4096
    v_mfma_f32_16x16x32_bf16 v[36:39], v[68:71], a[4:7], 0
    ds_read_b64_tr_b16 v[86:87], v91 offset:6144
    v_mfma_f32_16x16x32_bf16 v[52:55], v[68:71], a[8:11], 0
    s_waitcnt vmcnt(9) lgkmcnt(0)
    v_mfma_f32_16x16x32_bf16 v[8:11], v[72:75], a[12:15], v[8:11]
    s_add_u32 s3, s61, 92160
    buffer_load_dwordx4 a[0:3], v131, s[4:7], s3 offen offset:0 sc1
    v_mfma_f32_16x16x32_bf16 v[24:27], v[72:75], a[16:19], v[24:27]
    ds_read_b64_tr_b16 v[56:57], v88 offset:8192
    v_mfma_f32_16x16x32_bf16 v[40:43], v[72:75], a[20:23], v[40:43]
    ds_read_b64_tr_b16 v[58:59], v88 offset:10240
    v_mfma_f32_16x16x32_bf16 v[12:15], v[76:79], a[12:15], v[12:15]
    ds_read_b64_tr_b16 v[60:61], v89 offset:8192
    v_mfma_f32_16x16x32_bf16 v[28:31], v[76:79], a[16:19], v[28:31]
    buffer_load_dwordx4 a[4:7], v92, s[4:7], s3 offen offset:256 sc1
    v_mfma_f32_16x16x32_bf16 v[44:47], v[76:79], a[20:23], v[44:47]
    ds_read_b64_tr_b16 v[62:63], v89 offset:10240
    v_mfma_f32_16x16x32_bf16 v[16:19], v[80:83], a[12:15], v[16:19]
    ds_read_b64_tr_b16 v[64:65], v90 offset:8192
    v_mfma_f32_16x16x32_bf16 v[32:35], v[80:83], a[16:19], v[32:35]
    ds_read_b64_tr_b16 v[66:67], v90 offset:10240
    v_mfma_f32_16x16x32_bf16 v[48:51], v[80:83], a[20:23], v[48:51]
    buffer_load_dwordx4 a[8:11], v92, s[4:7], s3 offen offset:512 sc1
    v_mfma_f32_16x16x32_bf16 v[20:23], v[84:87], a[12:15], v[20:23]
    ds_read_b64_tr_b16 v[68:69], v91 offset:8192
    v_mfma_f32_16x16x32_bf16 v[36:39], v[84:87], a[16:19], v[36:39]
    ds_read_b64_tr_b16 v[70:71], v91 offset:10240
    v_mfma_f32_16x16x32_bf16 v[52:55], v[84:87], a[20:23], v[52:55]
    s_waitcnt vmcnt(9) lgkmcnt(0)
    v_mfma_f32_16x16x32_bf16 v[8:11], v[56:59], a[24:27], v[8:11]
    s_add_u32 s3, s61, 110592
    buffer_load_dwordx4 a[12:15], v131, s[4:7], s3 offen offset:0 sc1
    v_mfma_f32_16x16x32_bf16 v[24:27], v[56:59], a[28:31], v[24:27]
    ds_read_b64_tr_b16 v[72:73], v88 offset:12288
    v_mfma_f32_16x16x32_bf16 v[40:43], v[56:59], a[32:35], v[40:43]
    ds_read_b64_tr_b16 v[74:75], v88 offset:14336
    v_mfma_f32_16x16x32_bf16 v[12:15], v[60:63], a[24:27], v[12:15]
    ds_read_b64_tr_b16 v[76:77], v89 offset:12288
    v_mfma_f32_16x16x32_bf16 v[28:31], v[60:63], a[28:31], v[28:31]
    buffer_load_dwordx4 a[16:19], v92, s[4:7], s3 offen offset:256 sc1
    v_mfma_f32_16x16x32_bf16 v[44:47], v[60:63], a[32:35], v[44:47]
    ds_read_b64_tr_b16 v[78:79], v89 offset:14336
    v_mfma_f32_16x16x32_bf16 v[16:19], v[64:67], a[24:27], v[16:19]
    ds_read_b64_tr_b16 v[80:81], v90 offset:12288
    v_mfma_f32_16x16x32_bf16 v[32:35], v[64:67], a[28:31], v[32:35]
    ds_read_b64_tr_b16 v[82:83], v90 offset:14336
    v_mfma_f32_16x16x32_bf16 v[48:51], v[64:67], a[32:35], v[48:51]
    buffer_load_dwordx4 a[20:23], v92, s[4:7], s3 offen offset:512 sc1
    v_mfma_f32_16x16x32_bf16 v[20:23], v[68:71], a[24:27], v[20:23]
    ds_read_b64_tr_b16 v[84:85], v91 offset:12288
    v_mfma_f32_16x16x32_bf16 v[36:39], v[68:71], a[28:31], v[36:39]
    ds_read_b64_tr_b16 v[86:87], v91 offset:14336
    v_mfma_f32_16x16x32_bf16 v[52:55], v[68:71], a[32:35], v[52:55]
    s_waitcnt vmcnt(9) lgkmcnt(0)
    v_mfma_f32_16x16x32_bf16 v[8:11], v[72:75], a[36:39], v[8:11]
    s_add_u32 s3, s61, 129024
    buffer_load_dwordx4 a[24:27], v131, s[4:7], s3 offen offset:0 sc1
    v_mfma_f32_16x16x32_bf16 v[24:27], v[72:75], a[40:43], v[24:27]
    ds_read_b64_tr_b16 v[56:57], v88 offset:16384
    v_mfma_f32_16x16x32_bf16 v[40:43], v[72:75], a[44:47], v[40:43]
    ds_read_b64_tr_b16 v[58:59], v88 offset:18432
    v_mfma_f32_16x16x32_bf16 v[12:15], v[76:79], a[36:39], v[12:15]
    ds_read_b64_tr_b16 v[60:61], v89 offset:16384
    v_mfma_f32_16x16x32_bf16 v[28:31], v[76:79], a[40:43], v[28:31]
    buffer_load_dwordx4 a[28:31], v92, s[4:7], s3 offen offset:256 sc1
    v_mfma_f32_16x16x32_bf16 v[44:47], v[76:79], a[44:47], v[44:47]
    ds_read_b64_tr_b16 v[62:63], v89 offset:18432
    v_mfma_f32_16x16x32_bf16 v[16:19], v[80:83], a[36:39], v[16:19]
    ds_read_b64_tr_b16 v[64:65], v90 offset:16384
    v_mfma_f32_16x16x32_bf16 v[32:35], v[80:83], a[40:43], v[32:35]
    ds_read_b64_tr_b16 v[66:67], v90 offset:18432
    v_mfma_f32_16x16x32_bf16 v[48:51], v[80:83], a[44:47], v[48:51]
    buffer_load_dwordx4 a[32:35], v92, s[4:7], s3 offen offset:512 sc1
    v_mfma_f32_16x16x32_bf16 v[20:23], v[84:87], a[36:39], v[20:23]
    ds_read_b64_tr_b16 v[68:69], v91 offset:16384
    v_mfma_f32_16x16x32_bf16 v[36:39], v[84:87], a[40:43], v[36:39]
    ds_read_b64_tr_b16 v[70:71], v91 offset:18432
    v_mfma_f32_16x16x32_bf16 v[52:55], v[84:87], a[44:47], v[52:55]
    s_waitcnt vmcnt(9) lgkmcnt(0)
    v_mfma_f32_16x16x32_bf16 v[8:11], v[56:59], a[48:51], v[8:11]
    s_add_u32 s3, s61, 147456
    buffer_load_dwordx4 a[36:39], v131, s[4:7], s3 offen offset:0 sc1
    v_mfma_f32_16x16x32_bf16 v[24:27], v[56:59], a[52:55], v[24:27]
    ds_read_b64_tr_b16 v[72:73], v88 offset:20480
    v_mfma_f32_16x16x32_bf16 v[40:43], v[56:59], a[56:59], v[40:43]
    ds_read_b64_tr_b16 v[74:75], v88 offset:22528
    v_mfma_f32_16x16x32_bf16 v[12:15], v[60:63], a[48:51], v[12:15]
    buffer_load_dwordx4 a[40:43], v92, s[4:7], s3 offen offset:256 sc1
    v_mfma_f32_16x16x32_bf16 v[28:31], v[60:63], a[52:55], v[28:31]
    ds_read_b64_tr_b16 v[76:77], v89 offset:20480
    v_mfma_f32_16x16x32_bf16 v[44:47], v[60:63], a[56:59], v[44:47]
    ds_read_b64_tr_b16 v[78:79], v89 offset:22528
    v_mfma_f32_16x16x32_bf16 v[16:19], v[64:67], a[48:51], v[16:19]
    buffer_load_dwordx4 a[44:47], v92, s[4:7], s3 offen offset:512 sc1
    v_mfma_f32_16x16x32_bf16 v[32:35], v[64:67], a[52:55], v[32:35]
    ds_read_b64_tr_b16 v[80:81], v90 offset:20480
    v_mfma_f32_16x16x32_bf16 v[48:51], v[64:67], a[56:59], v[48:51]
    ds_read_b64_tr_b16 v[82:83], v90 offset:22528
    v_mfma_f32_16x16x32_bf16 v[20:23], v[68:71], a[48:51], v[20:23]
    buffer_load_dword v95, v3, s[4:7], 0 offen offset:1536 sc1
    v_mfma_f32_16x16x32_bf16 v[36:39], v[68:71], a[52:55], v[36:39]
    ds_read_b64_tr_b16 v[84:85], v91 offset:20480
    v_mfma_f32_16x16x32_bf16 v[52:55], v[68:71], a[56:59], v[52:55]
    ds_read_b64_tr_b16 v[86:87], v91 offset:22528
    s_waitcnt vmcnt(10) lgkmcnt(0)
    v_mfma_f32_16x16x32_bf16 v[8:11], v[72:75], a[0:3], v[8:11]
    s_add_u32 s3, s61, 165888
    buffer_load_dwordx4 a[48:51], v131, s[4:7], s3 offen offset:0 sc1
    v_mfma_f32_16x16x32_bf16 v[24:27], v[72:75], a[4:7], v[24:27]
    ds_read_b64_tr_b16 v[56:57], v88 offset:24576
    v_mfma_f32_16x16x32_bf16 v[40:43], v[72:75], a[8:11], v[40:43]
    ds_read_b64_tr_b16 v[58:59], v88 offset:26624
    v_mfma_f32_16x16x32_bf16 v[12:15], v[76:79], a[0:3], v[12:15]
    ds_read_b64_tr_b16 v[60:61], v89 offset:24576
    v_mfma_f32_16x16x32_bf16 v[28:31], v[76:79], a[4:7], v[28:31]
    buffer_load_dwordx4 a[52:55], v92, s[4:7], s3 offen offset:256 sc1
    v_mfma_f32_16x16x32_bf16 v[44:47], v[76:79], a[8:11], v[44:47]
    ds_read_b64_tr_b16 v[62:63], v89 offset:26624
    v_mfma_f32_16x16x32_bf16 v[16:19], v[80:83], a[0:3], v[16:19]
    ds_read_b64_tr_b16 v[64:65], v90 offset:24576
    v_mfma_f32_16x16x32_bf16 v[32:35], v[80:83], a[4:7], v[32:35]
    ds_read_b64_tr_b16 v[66:67], v90 offset:26624
    v_mfma_f32_16x16x32_bf16 v[48:51], v[80:83], a[8:11], v[48:51]
    buffer_load_dwordx4 a[56:59], v92, s[4:7], s3 offen offset:512 sc1
    v_mfma_f32_16x16x32_bf16 v[20:23], v[84:87], a[0:3], v[20:23]
    ds_read_b64_tr_b16 v[68:69], v91 offset:24576
    v_mfma_f32_16x16x32_bf16 v[36:39], v[84:87], a[4:7], v[36:39]
    ds_read_b64_tr_b16 v[70:71], v91 offset:26624
    v_mfma_f32_16x16x32_bf16 v[52:55], v[84:87], a[8:11], v[52:55]
    s_waitcnt vmcnt(10) lgkmcnt(0)
    s_barrier
    v_mfma_f32_16x16x32_bf16 v[8:11], v[56:59], a[12:15], v[8:11]
    ds_read_b64_tr_b16 v[72:73], v88 offset:28672
    v_mfma_f32_16x16x32_bf16 v[24:27], v[56:59], a[16:19], v[24:27]
    ds_read_b64_tr_b16 v[74:75], v88 offset:30720
    v_mfma_f32_16x16x32_bf16 v[40:43], v[56:59], a[20:23], v[40:43]
    ds_read_b64_tr_b16 v[76:77], v89 offset:28672
    v_mfma_f32_16x16x32_bf16 v[12:15], v[60:63], a[12:15], v[12:15]
    ds_read_b64_tr_b16 v[78:79], v89 offset:30720
    v_mfma_f32_16x16x32_bf16 v[28:31], v[60:63], a[16:19], v[28:31]
    ds_read_b64_tr_b16 v[80:81], v90 offset:28672
    v_mfma_f32_16x16x32_bf16 v[44:47], v[60:63], a[20:23], v[44:47]
    ds_read_b64_tr_b16 v[82:83], v90 offset:30720
    v_mfma_f32_16x16x32_bf16 v[16:19], v[64:67], a[12:15], v[16:19]
    ds_read_b64_tr_b16 v[84:85], v91 offset:28672
    v_mfma_f32_16x16x32_bf16 v[32:35], v[64:67], a[16:19], v[32:35]
    ds_read_b64_tr_b16 v[86:87], v91 offset:30720
    v_mfma_f32_16x16x32_bf16 v[48:51], v[64:67], a[20:23], v[48:51]
    v_mfma_f32_16x16x32_bf16 v[20:23], v[68:71], a[12:15], v[20:23]
    v_mfma_f32_16x16x32_bf16 v[36:39], v[68:71], a[16:19], v[36:39]
    v_mfma_f32_16x16x32_bf16 v[52:55], v[68:71], a[20:23], v[52:55]
    s_waitcnt vmcnt(7) lgkmcnt(0)
    v_mfma_f32_16x16x32_bf16 v[16:19], v[80:83], a[24:27], v[16:19]
    ds_read_b64_tr_b16 v[64:65], v90 offset:32768
    ds_read_b64_tr_b16 v[66:67], v90 offset:34816
    v_mfma_f32_16x16x32_bf16 v[32:35], v[80:83], a[28:31], v[32:35]
    ds_read_b64_tr_b16 v[68:69], v91 offset:32768
    ds_read_b64_tr_b16 v[70:71], v91 offset:34816
    v_mfma_f32_16x16x32_bf16 v[48:51], v[80:83], a[32:35], v[48:51]
    v_mfma_f32_16x16x32_bf16 v[20:23], v[84:87], a[24:27], v[20:23]
    v_mfma_f32_16x16x32_bf16 v[36:39], v[84:87], a[28:31], v[36:39]
    v_mfma_f32_16x16x32_bf16 v[52:55], v[84:87], a[32:35], v[52:55]
    s_waitcnt vmcnt(4) lgkmcnt(0)
    v_mfma_f32_16x16x32_bf16 v[16:19], v[64:67], a[36:39], v[16:19]
    ds_read_b64_tr_b16 v[80:81], v90 offset:36864
    ds_read_b64_tr_b16 v[82:83], v90 offset:38912
    v_mfma_f32_16x16x32_bf16 v[32:35], v[64:67], a[40:43], v[32:35]
    ds_read_b64_tr_b16 v[84:85], v91 offset:36864
    ds_read_b64_tr_b16 v[86:87], v91 offset:38912
    v_mfma_f32_16x16x32_bf16 v[48:51], v[64:67], a[44:47], v[48:51]
    v_mfma_f32_16x16x32_bf16 v[20:23], v[68:71], a[36:39], v[20:23]
    v_mfma_f32_16x16x32_bf16 v[36:39], v[68:71], a[40:43], v[36:39]
    v_mfma_f32_16x16x32_bf16 v[52:55], v[68:71], a[44:47], v[52:55]
    s_waitcnt vmcnt(0) lgkmcnt(0)
    v_mfma_f32_16x16x32_bf16 v[16:19], v[80:83], a[48:51], v[16:19]
    ds_read_b64_tr_b16 v[56:57], v88 offset:32768
    ds_read_b64_tr_b16 v[58:59], v88 offset:34816
    v_mfma_f32_16x16x32_bf16 v[32:35], v[80:83], a[52:55], v[32:35]
    ds_read_b64_tr_b16 v[60:61], v89 offset:32768
    ds_read_b64_tr_b16 v[62:63], v89 offset:34816
    v_mfma_f32_16x16x32_bf16 v[48:51], v[80:83], a[56:59], v[48:51]
    ds_read_b64_tr_b16 v[64:65], v88 offset:36864
    ds_read_b64_tr_b16 v[66:67], v88 offset:38912
    v_mfma_f32_16x16x32_bf16 v[20:23], v[84:87], a[48:51], v[20:23]
    ds_read_b64_tr_b16 v[68:69], v89 offset:36864
    ds_read_b64_tr_b16 v[70:71], v89 offset:38912
    v_mfma_f32_16x16x32_bf16 v[36:39], v[84:87], a[52:55], v[36:39]
    v_mfma_f32_16x16x32_bf16 v[52:55], v[84:87], a[56:59], v[52:55]
    v_mfma_f32_16x16x32_bf16 v[8:11], v[72:75], a[24:27], v[8:11]
    v_mfma_f32_16x16x32_bf16 v[24:27], v[72:75], a[28:31], v[24:27]
    ds_write_b128 v93, v[16:19] offset:0
    v_mfma_f32_16x16x32_bf16 v[40:43], v[72:75], a[32:35], v[40:43]
    v_mfma_f32_16x16x32_bf16 v[12:15], v[76:79], a[24:27], v[12:15]
    ds_write_b128 v93, v[32:35] offset:2048
    v_mfma_f32_16x16x32_bf16 v[28:31], v[76:79], a[28:31], v[28:31]
    v_mfma_f32_16x16x32_bf16 v[44:47], v[76:79], a[32:35], v[44:47]
    ds_write_b128 v93, v[48:51] offset:4096
    s_waitcnt lgkmcnt(3)
    v_mfma_f32_16x16x32_bf16 v[8:11], v[56:59], a[36:39], v[8:11]
    v_mfma_f32_16x16x32_bf16 v[24:27], v[56:59], a[40:43], v[24:27]
    ds_write_b128 v93, v[20:23] offset:1024
    v_mfma_f32_16x16x32_bf16 v[40:43], v[56:59], a[44:47], v[40:43]
    v_mfma_f32_16x16x32_bf16 v[12:15], v[60:63], a[36:39], v[12:15]
    ds_write_b128 v93, v[36:39] offset:3072
    v_mfma_f32_16x16x32_bf16 v[28:31], v[60:63], a[40:43], v[28:31]
    v_mfma_f32_16x16x32_bf16 v[44:47], v[60:63], a[44:47], v[44:47]
    ds_write_b128 v93, v[52:55] offset:5120
    v_mfma_f32_16x16x32_bf16 v[8:11], v[64:67], a[48:51], v[8:11]
    v_mfma_f32_16x16x32_bf16 v[24:27], v[64:67], a[52:55], v[24:27]
    v_mfma_f32_16x16x32_bf16 v[40:43], v[64:67], a[56:59], v[40:43]
    v_mfma_f32_16x16x32_bf16 v[12:15], v[68:71], a[48:51], v[12:15]
    v_mfma_f32_16x16x32_bf16 v[28:31], v[68:71], a[52:55], v[28:31]
    v_mfma_f32_16x16x32_bf16 v[44:47], v[68:71], a[56:59], v[44:47]
    s_waitcnt lgkmcnt(0)
    s_barrier
    ds_read_b128 v[136:139], v128 offset:0
    ds_read_b128 v[140:143], v128 offset:256
    ds_read_b128 v[144:147], v128 offset:512
    ds_read_b128 v[16:19], v94 offset:0
    ds_read_b128 v[20:23], v94 offset:1024
    ds_read_b128 v[32:35], v94 offset:2048
    ds_read_b128 v[36:39], v94 offset:3072
    ds_read_b128 v[48:51], v94 offset:4096
    ds_read_b128 v[52:55], v94 offset:5120
    s_waitcnt lgkmcnt(4)
    v_pk_add_f32 v[8:9], v[8:9], v[16:17]
    v_pk_add_f32 v[10:11], v[10:11], v[18:19]
    v_pk_add_f32 v[12:13], v[12:13], v[20:21]
    v_pk_add_f32 v[14:15], v[14:15], v[22:23]
    s_waitcnt lgkmcnt(2)
    v_pk_add_f32 v[24:25], v[24:25], v[32:33]
    v_pk_add_f32 v[26:27], v[26:27], v[34:35]
    v_pk_add_f32 v[28:29], v[28:29], v[36:37]
    v_pk_add_f32 v[30:31], v[30:31], v[38:39]
    s_waitcnt lgkmcnt(0)
    s_barrier
    v_pk_add_f32 v[40:41], v[40:41], v[48:49]
    v_pk_add_f32 v[42:43], v[42:43], v[50:51]
    v_pk_add_f32 v[44:45], v[44:45], v[52:53]
    v_pk_add_f32 v[46:47], v[46:47], v[54:55]
    v_pk_fma_f32 v[8:9], v[96:97], v[138:139], v[8:9] op_sel:[0,1,0] op_sel_hi:[1,1,1] neg_lo:[0,1,0] neg_hi:[0,1,0]
    v_pk_fma_f32 v[10:11], v[98:99], v[138:139], v[10:11] op_sel:[0,1,0] op_sel_hi:[1,1,1] neg_lo:[0,1,0] neg_hi:[0,1,0]
    v_pk_fma_f32 v[12:13], v[100:101], v[138:139], v[12:13] op_sel:[0,1,0] op_sel_hi:[1,1,1] neg_lo:[0,1,0] neg_hi:[0,1,0]
    v_pk_fma_f32 v[14:15], v[102:103], v[138:139], v[14:15] op_sel:[0,1,0] op_sel_hi:[1,1,1] neg_lo:[0,1,0] neg_hi:[0,1,0]
    v_pk_mul_f32 v[58:59], v[8:9], v[8:9]
    v_pk_mul_f32 v[60:61], v[10:11], v[10:11]
    v_pk_mul_f32 v[62:63], v[12:13], v[12:13]
    v_pk_mul_f32 v[64:65], v[14:15], v[14:15]
    v_pk_fma_f32 v[58:59], v[58:59], v[136:137], v[136:137] op_sel:[0,0,1] op_sel_hi:[1,0,1]
    v_pk_fma_f32 v[60:61], v[60:61], v[136:137], v[136:137] op_sel:[0,0,1] op_sel_hi:[1,0,1]
    v_pk_fma_f32 v[62:63], v[62:63], v[136:137], v[136:137] op_sel:[0,0,1] op_sel_hi:[1,0,1]
    v_pk_fma_f32 v[64:65], v[64:65], v[136:137], v[136:137] op_sel:[0,0,1] op_sel_hi:[1,0,1]
    v_pk_mul_f32 v[58:59], v[58:59], v[8:9]
    v_pk_mul_f32 v[60:61], v[60:61], v[10:11]
    v_pk_mul_f32 v[62:63], v[62:63], v[12:13]
    v_pk_mul_f32 v[64:65], v[64:65], v[14:15]
    v_exp_f32 v58, v58
    v_exp_f32 v59, v59
    v_exp_f32 v60, v60
    v_exp_f32 v61, v61
    v_exp_f32 v62, v62
    v_exp_f32 v63, v63
    v_exp_f32 v64, v64
    v_exp_f32 v65, v65
    v_pk_fma_f32 v[58:59], v[58:59], v[138:139], v[138:139] op_sel:[0,0,0] op_sel_hi:[1,0,0]
    v_pk_fma_f32 v[60:61], v[60:61], v[138:139], v[138:139] op_sel:[0,0,0] op_sel_hi:[1,0,0]
    v_pk_fma_f32 v[62:63], v[62:63], v[138:139], v[138:139] op_sel:[0,0,0] op_sel_hi:[1,0,0]
    v_pk_fma_f32 v[64:65], v[64:65], v[138:139], v[138:139] op_sel:[0,0,0] op_sel_hi:[1,0,0]
    v_rcp_f32 v58, v58
    v_rcp_f32 v59, v59
    v_rcp_f32 v60, v60
    v_rcp_f32 v61, v61
    v_rcp_f32 v62, v62
    v_rcp_f32 v63, v63
    v_rcp_f32 v64, v64
    v_rcp_f32 v65, v65
    v_pk_mul_f32 v[8:9], v[8:9], v[58:59]
    v_pk_mul_f32 v[10:11], v[10:11], v[60:61]
    v_pk_mul_f32 v[12:13], v[12:13], v[62:63]
    v_pk_mul_f32 v[14:15], v[14:15], v[64:65]
    v_cvt_pk_bf16_f32 v16, v8, v9
    v_cvt_pk_bf16_f32 v17, v10, v11
    v_cvt_pk_bf16_f32 v18, v12, v13
    v_cvt_pk_bf16_f32 v19, v14, v15
    s_cmp_eq_u64 s[16:17], -1
    s_cbranch_scc1 L_zr_60
    v_cndmask_b32 v16, 0, v16, s[16:17]
    v_cndmask_b32 v17, 0, v17, s[16:17]
    v_cndmask_b32 v18, 0, v18, s[16:17]
    v_cndmask_b32 v19, 0, v19, s[16:17]
L_zr_60:
    s_cmp_lg_u32 s54, 0
    s_cbranch_scc1 L_du_61
    buffer_store_dwordx4 v[16:19], v124, s[4:7], 0 offen offset:0
L_du_61:
    v_pk_fma_f32 v[24:25], v[96:97], v[142:143], v[24:25] op_sel:[0,1,0] op_sel_hi:[1,1,1] neg_lo:[0,1,0] neg_hi:[0,1,0]
    v_pk_fma_f32 v[26:27], v[98:99], v[142:143], v[26:27] op_sel:[0,1,0] op_sel_hi:[1,1,1] neg_lo:[0,1,0] neg_hi:[0,1,0]
    v_pk_fma_f32 v[28:29], v[100:101], v[142:143], v[28:29] op_sel:[0,1,0] op_sel_hi:[1,1,1] neg_lo:[0,1,0] neg_hi:[0,1,0]
    v_pk_fma_f32 v[30:31], v[102:103], v[142:143], v[30:31] op_sel:[0,1,0] op_sel_hi:[1,1,1] neg_lo:[0,1,0] neg_hi:[0,1,0]
    v_pk_mul_f32 v[58:59], v[24:25], v[24:25]
    v_pk_mul_f32 v[60:61], v[26:27], v[26:27]
    v_pk_mul_f32 v[62:63], v[28:29], v[28:29]
    v_pk_mul_f32 v[64:65], v[30:31], v[30:31]
    v_pk_fma_f32 v[58:59], v[58:59], v[140:141], v[140:141] op_sel:[0,0,1] op_sel_hi:[1,0,1]
    v_pk_fma_f32 v[60:61], v[60:61], v[140:141], v[140:141] op_sel:[0,0,1] op_sel_hi:[1,0,1]
    v_pk_fma_f32 v[62:63], v[62:63], v[140:141], v[140:141] op_sel:[0,0,1] op_sel_hi:[1,0,1]
    v_pk_fma_f32 v[64:65], v[64:65], v[140:141], v[140:141] op_sel:[0,0,1] op_sel_hi:[1,0,1]
    v_pk_mul_f32 v[58:59], v[58:59], v[24:25]
    v_pk_mul_f32 v[60:61], v[60:61], v[26:27]
    v_pk_mul_f32 v[62:63], v[62:63], v[28:29]
    v_pk_mul_f32 v[64:65], v[64:65], v[30:31]
    v_exp_f32 v58, v58
    v_exp_f32 v59, v59
    v_exp_f32 v60, v60
    v_exp_f32 v61, v61
    v_exp_f32 v62, v62
    v_exp_f32 v63, v63
    v_exp_f32 v64, v64
    v_exp_f32 v65, v65
    v_pk_fma_f32 v[58:59], v[58:59], v[142:143], v[142:143] op_sel:[0,0,0] op_sel_hi:[1,0,0]
    v_pk_fma_f32 v[60:61], v[60:61], v[142:143], v[142:143] op_sel:[0,0,0] op_sel_hi:[1,0,0]
    v_pk_fma_f32 v[62:63], v[62:63], v[142:143], v[142:143] op_sel:[0,0,0] op_sel_hi:[1,0,0]
    v_pk_fma_f32 v[64:65], v[64:65], v[142:143], v[142:143] op_sel:[0,0,0] op_sel_hi:[1,0,0]
    v_rcp_f32 v58, v58
    v_rcp_f32 v59, v59
    v_rcp_f32 v60, v60
    v_rcp_f32 v61, v61
    v_rcp_f32 v62, v62
    v_rcp_f32 v63, v63
    v_rcp_f32 v64, v64
    v_rcp_f32 v65, v65
    v_pk_mul_f32 v[24:25], v[24:25], v[58:59]
    v_pk_mul_f32 v[26:27], v[26:27], v[60:61]
    v_pk_mul_f32 v[28:29], v[28:29], v[62:63]
    v_pk_mul_f32 v[30:31], v[30:31], v[64:65]
    v_cvt_pk_bf16_f32 v32, v24, v25
    v_cvt_pk_bf16_f32 v33, v26, v27
    v_cvt_pk_bf16_f32 v34, v28, v29
    v_cvt_pk_bf16_f32 v35, v30, v31
    s_cmp_eq_u64 s[18:19], -1
    s_cbranch_scc1 L_zr_62
    v_cndmask_b32 v32, 0, v32, s[18:19]
    v_cndmask_b32 v33, 0, v33, s[18:19]
    v_cndmask_b32 v34, 0, v34, s[18:19]
    v_cndmask_b32 v35, 0, v35, s[18:19]
L_zr_62:
    buffer_store_dwordx4 v[32:35], v124, s[4:7], 0 offen offset:256
    v_pk_fma_f32 v[40:41], v[96:97], v[146:147], v[40:41] op_sel:[0,1,0] op_sel_hi:[1,1,1] neg_lo:[0,1,0] neg_hi:[0,1,0]
    v_pk_fma_f32 v[42:43], v[98:99], v[146:147], v[42:43] op_sel:[0,1,0] op_sel_hi:[1,1,1] neg_lo:[0,1,0] neg_hi:[0,1,0]
    v_pk_fma_f32 v[44:45], v[100:101], v[146:147], v[44:45] op_sel:[0,1,0] op_sel_hi:[1,1,1] neg_lo:[0,1,0] neg_hi:[0,1,0]
    v_pk_fma_f32 v[46:47], v[102:103], v[146:147], v[46:47] op_sel:[0,1,0] op_sel_hi:[1,1,1] neg_lo:[0,1,0] neg_hi:[0,1,0]
    v_pk_mul_f32 v[58:59], v[40:41], v[40:41]
    v_pk_mul_f32 v[60:61], v[42:43], v[42:43]
    v_pk_mul_f32 v[62:63], v[44:45], v[44:45]
    v_pk_mul_f32 v[64:65], v[46:47], v[46:47]
    v_pk_fma_f32 v[58:59], v[58:59], v[144:145], v[144:145] op_sel:[0,0,1] op_sel_hi:[1,0,1]
    v_pk_fma_f32 v[60:61], v[60:61], v[144:145], v[144:145] op_sel:[0,0,1] op_sel_hi:[1,0,1]
    v_pk_fma_f32 v[62:63], v[62:63], v[144:145], v[144:145] op_sel:[0,0,1] op_sel_hi:[1,0,1]
    v_pk_fma_f32 v[64:65], v[64:65], v[144:145], v[144:145] op_sel:[0,0,1] op_sel_hi:[1,0,1]
    v_pk_mul_f32 v[58:59], v[58:59], v[40:41]
    v_pk_mul_f32 v[60:61], v[60:61], v[42:43]
    v_pk_mul_f32 v[62:63], v[62:63], v[44:45]
    v_pk_mul_f32 v[64:65], v[64:65], v[46:47]
    v_exp_f32 v58, v58
    v_exp_f32 v59, v59
    v_exp_f32 v60, v60
    v_exp_f32 v61, v61
    v_exp_f32 v62, v62
    v_exp_f32 v63, v63
    v_exp_f32 v64, v64
    v_exp_f32 v65, v65
    v_pk_fma_f32 v[58:59], v[58:59], v[146:147], v[146:147] op_sel:[0,0,0] op_sel_hi:[1,0,0]
    v_pk_fma_f32 v[60:61], v[60:61], v[146:147], v[146:147] op_sel:[0,0,0] op_sel_hi:[1,0,0]
    v_pk_fma_f32 v[62:63], v[62:63], v[146:147], v[146:147] op_sel:[0,0,0] op_sel_hi:[1,0,0]
    v_pk_fma_f32 v[64:65], v[64:65], v[146:147], v[146:147] op_sel:[0,0,0] op_sel_hi:[1,0,0]
    v_rcp_f32 v58, v58
    v_rcp_f32 v59, v59
    v_rcp_f32 v60, v60
    v_rcp_f32 v61, v61
    v_rcp_f32 v62, v62
    v_rcp_f32 v63, v63
    v_rcp_f32 v64, v64
    v_rcp_f32 v65, v65
    v_pk_mul_f32 v[40:41], v[40:41], v[58:59]
    v_pk_mul_f32 v[42:43], v[42:43], v[60:61]
    v_pk_mul_f32 v[44:45], v[44:45], v[62:63]
    v_pk_mul_f32 v[46:47], v[46:47], v[64:65]
    v_cvt_pk_bf16_f32 v48, v40, v41
    v_cvt_pk_bf16_f32 v49, v42, v43
    v_cvt_pk_bf16_f32 v50, v44, v45
    v_cvt_pk_bf16_f32 v51, v46, v47
    s_cmp_eq_u64 s[22:23], -1
    s_cbranch_scc1 L_zr_63
    v_cndmask_b32 v48, 0, v48, s[22:23]
    v_cndmask_b32 v49, 0, v49, s[22:23]
    v_cndmask_b32 v50, 0, v50, s[22:23]
    v_cndmask_b32 v51, 0, v51, s[22:23]
L_zr_63:
    buffer_store_dwordx4 v[48:51], v124, s[4:7], 0 offen offset:512
    v_mov_b32 v3, 1
    s_mov_b64 exec, 1
    s_cmp_eq_u32 s50, 0
    s_cbranch_scc0 L_pf_64
    s_waitcnt vmcnt(0)
    buffer_store_dword v3, v135, s[4:7], 0 offen offset:1536
    s_branch L_pg_65
L_pf_64:
    s_waitcnt vmcnt(0)
    buffer_wbl2 sc1
    s_waitcnt vmcnt(0)
    buffer_store_dword v3, v135, s[4:7], 0 offen offset:1536 sc1
L_pg_65:
    s_mov_b64 exec, -1
    s_mul_i32 s3, s46, 40960
    s_add_u32 s3, s3, 81920
    v_add_u32 v88, s3, v134
    v_xor_b32 v89, 32, v88
    v_xor_b32 v90, 64, v88
    v_xor_b32 v91, 96, v88
    s_lshl_b32 s3, s57, 8
    s_add_u32 s3, s3, 16640
    v_add_u32 v92, s3, v132
    s_cmp_eq_u32 s55, 0
    s_cselect_b32 s3, 0, 1073741824
    v_add_u32 v131, s3, v92
    s_lshl_b32 s3, s57, 8
    s_add_u32 s3, s3, s47
    s_add_u32 s3, s3, 385152
    v_add_u32 v118, s3, v132
    s_lshl_b32 s3, s57, 8
    s_add_u32 s3, s3, s47
    s_add_u32 s3, s3, 16640
    v_add_u32 v96, s3, v132
    s_mul_i32 s3, s57, 2560
    s_lshl_b32 s52, s44, 8
    s_add_u32 s3, s3, s52
    s_lshl_b32 s52, s46, 3
    s_add_u32 s3, s3, s52
    s_add_u32 s3, s3, 2315264
    v_lshl_add_u32 v97, v2, 4, s3
    v_lshrrev_b32 v98, 2, v2
    v_cmp_eq_u32 vcc, v98, v1
    v_mov_b32 v98, 1073741824
    s_nop 0
    v_cndmask_b32 v97, v98, v97, vcc
    v_mov_b32 v4, 0x3f803f80
    v_mov_b32 v5, 0x3f803f80
    v_mov_b32 v6, 0x3f803f80
    v_mov_b32 v7, 0x3f803f80
    s_lshl_b32 s3, s45, 13
    s_add_u32 s3, s3, 81920
    s_mul_i32 s52, s46, 40960
    s_add_u32 s53, s52, s3
    v_lshl_add_u32 v93, v0, 4, s53
    s_sub_u32 s52, 40960, s52
    s_add_u32 s53, s52, s3
    v_lshl_add_u32 v94, v0, 4, s53
    s_lshl_b32 s3, s57, 7
    s_add_u32 s3, s3, 2265152
    v_lshl_add_u32 v119, v2, 3, s3
    s_mov_b32 s62, 400000
    v_lshlrev_b32 v3, 3, v0
    s_lshl_b32 s3, s21, 1
    s_lshl_b32 s52, 20, 1
    s_bfm_b64 exec, s52, s3
L_po_66:
    buffer_load_dwordx2 v[126:127], v3, s[4:7], 0 offen offset:1536 sc1
    s_waitcnt vmcnt(0)
    v_and_b32 v126, v126, v127
    v_cmp_eq_u32 vcc, 0, v126
    s_cbranch_vccz L_pp_67
    s_sub_u32 s62, s62, 1
    s_cbranch_scc0 L_po_66
    s_endpgm
L_pp_67:
    s_mov_b64 exec, -1
    s_cmp_eq_u32 s50, 0
    s_cbranch_scc1 L_pq_68
    buffer_inv sc1
    s_waitcnt vmcnt(0)
L_pq_68:
    s_add_u32 s3, s61, 0
    buffer_load_dwordx4 a[0:3], v131, s[4:7], s3 offen offset:0 sc1
    buffer_load_dwordx4 a[4:7], v92, s[4:7], s3 offen offset:256 sc1
    buffer_load_dwordx4 a[8:11], v92, s[4:7], s3 offen offset:512 sc1
    s_add_u32 s3, s61, 18432
    buffer_load_dwordx4 a[12:15], v131, s[4:7], s3 offen offset:0 sc1
    buffer_load_dwordx4 a[16:19], v92, s[4:7], s3 offen offset:256 sc1
    buffer_load_dwordx4 a[20:23], v92, s[4:7], s3 offen offset:512 sc1
    s_add_u32 s3, s61, 36864
    buffer_load_dwordx4 a[24:27], v131, s[4:7], s3 offen offset:0 sc1
    buffer_load_dwordx4 a[28:31], v92, s[4:7], s3 offen offset:256 sc1
    buffer_load_dwordx4 a[32:35], v92, s[4:7], s3 offen offset:512 sc1
    s_add_u32 s3, s61, 55296
    buffer_load_dwordx4 a[36:39], v131, s[4:7], s3 offen offset:0 sc1
    buffer_load_dwordx4 a[40:43], v92, s[4:7], s3 offen offset:256 sc1
    buffer_load_dwordx4 a[44:47], v92, s[4:7], s3 offen offset:512 sc1
    ds_read_b64_tr_b16 v[56:57], v88 offset:0
    ds_read_b64_tr_b16 v[58:59], v88 offset:2048
    ds_read_b64_tr_b16 v[60:61], v89 offset:0
    ds_read_b64_tr_b16 v[62:63], v89 offset:2048
    ds_read_b64_tr_b16 v[64:65], v90 offset:0
    ds_read_b64_tr_b16 v[66:67], v90 offset:2048
    ds_read_b64_tr_b16 v[68:69], v91 offset:0
    ds_read_b64_tr_b16 v[70:71], v91 offset:2048
    s_waitcnt vmcnt(9) lgkmcnt(0)
    v_mfma_f32_16x16x32_bf16 v[8:11], v[56:59], a[0:3], 0
    s_add_u32 s3, s61, 73728
    buffer_load_dwordx4 a[48:51], v131, s[4:7], s3 offen offset:0 sc1
    v_mfma_f32_16x16x32_bf16 v[24:27], v[56:59], a[4:7], 0
    ds_read_b64_tr_b16 v[72:73], v88 offset:4096
    v_mfma_f32_16x16x32_bf16 v[40:43], v[56:59], a[8:11], 0
    buffer_load_dwordx4 a[52:55], v92, s[4:7], s3 offen offset:256 sc1
    v_mfma_f32_16x16x32_bf16 v[12:15], v[60:63], a[0:3], 0
    ds_read_b64_tr_b16 v[74:75], v88 offset:6144
    v_mfma_f32_16x16x32_bf16 v[28:31], v[60:63], a[4:7], 0
    buffer_load_dwordx4 a[56:59], v92, s[4:7], s3 offen offset:512 sc1
    v_mfma_f32_16x16x32_bf16 v[44:47], v[60:63], a[8:11], 0
    ds_read_b64_tr_b16 v[76:77], v89 offset:4096
    v_mfma_f32_16x16x32_bf16 v[16:19], v[64:67], a[0:3], 0
    buffer_load_dwordx4 v[100:103], v118, s[4:7], 0 offen offset:0 sc1
    v_mfma_f32_16x16x32_bf16 v[32:35], v[64:67], a[4:7], 0
    ds_read_b64_tr_b16 v[78:79], v89 offset:6144
    v_mfma_f32_16x16x32_bf16 v[48:51], v[64:67], a[8:11], 0
    buffer_load_dwordx4 v[104:107], v118, s[4:7], 0 offen offset:256 sc1
    ds_read_b64_tr_b16 v[80:81], v90 offset:4096
    v_mfma_f32_16x16x32_bf16 v[20:23], v[68:71], a[0:3], 0
    ds_read_b64_tr_b16 v[82:83], v90 offset:6144
    v_mfma_f32_16x16x32_bf16 v[36:39], v[68:71], a[4:7], 0
    buffer_load_dwordx4 v[108:111], v118, s[4:7], 0 offen offset:512 sc1
    ds_read_b64_tr_b16 v[84:85], v91 offset:4096
    v_mfma_f32_16x16x32_bf16 v[52:55], v[68:71], a[8:11], 0
    ds_read_b64_tr_b16 v[86:87], v91 offset:6144
    s_waitcnt vmcnt(12) lgkmcnt(0)
    v_mfma_f32_16x16x32_bf16 v[8:11], v[72:75], a[12:15], v[8:11]
    s_add_u32 s3, s61, 92160
    buffer_load_dwordx4 a[0:3], v131, s[4:7], s3 offen offset:0 sc1
    v_mfma_f32_16x16x32_bf16 v[24:27], v[72:75], a[16:19], v[24:27]
    ds_read_b64_tr_b16 v[56:57], v88 offset:8192
    v_mfma_f32_16x16x32_bf16 v[40:43], v[72:75], a[20:23], v[40:43]
    buffer_load_dwordx4 a[4:7], v92, s[4:7], s3 offen offset:256 sc1
    v_mfma_f32_16x16x32_bf16 v[12:15], v[76:79], a[12:15], v[12:15]
    ds_read_b64_tr_b16 v[58:59], v88 offset:10240
    v_mfma_f32_16x16x32_bf16 v[28:31], v[76:79], a[16:19], v[28:31]
    buffer_load_dwordx4 a[8:11], v92, s[4:7], s3 offen offset:512 sc1
    v_mfma_f32_16x16x32_bf16 v[44:47], v[76:79], a[20:23], v[44:47]
    ds_read_b64_tr_b16 v[60:61], v89 offset:8192
    v_mfma_f32_16x16x32_bf16 v[16:19], v[80:83], a[12:15], v[16:19]
    buffer_load_dwordx2 v[112:113], v119, s[4:7], 0 offen offset:0 sc1
    v_mfma_f32_16x16x32_bf16 v[32:35], v[80:83], a[16:19], v[32:35]
    ds_read_b64_tr_b16 v[62:63], v89 offset:10240
    v_mfma_f32_16x16x32_bf16 v[48:51], v[80:83], a[20:23], v[48:51]
    buffer_load_dwordx2 v[114:115], v119, s[4:7], 0 offen offset:128 sc1
    ds_read_b64_tr_b16 v[64:65], v90 offset:8192
    v_mfma_f32_16x16x32_bf16 v[20:23], v[84:87], a[12:15], v[20:23]
    ds_read_b64_tr_b16 v[66:67], v90 offset:10240
    v_mfma_f32_16x16x32_bf16 v[36:39], v[84:87], a[16:19], v[36:39]
    buffer_load_dwordx2 v[116:117], v119, s[4:7], 0 offen offset:256 sc1
    ds_read_b64_tr_b16 v[68:69], v91 offset:8192
    v_mfma_f32_16x16x32_bf16 v[52:55], v[84:87], a[20:23], v[52:55]
    ds_read_b64_tr_b16 v[70:71], v91 offset:10240
    s_waitcnt vmcnt(15) lgkmcnt(0)
    v_mfma_f32_16x16x32_bf16 v[8:11], v[56:59], a[24:27], v[8:11]
    s_add_u32 s3, s61, 110592
    buffer_load_dwordx4 a[12:15], v131, s[4:7], s3 offen offset:0 sc1
    v_mfma_f32_16x16x32_bf16 v[24:27], v[56:59], a[28:31], v[24:27]
    ds_read_b64_tr_b16 v[72:73], v88 offset:12288
    v_mfma_f32_16x16x32_bf16 v[40:43], v[56:59], a[32:35], v[40:43]
    ds_read_b64_tr_b16 v[74:75], v88 offset:14336
    v_mfma_f32_16x16x32_bf16 v[12:15], v[60:63], a[24:27], v[12:15]
    ds_read_b64_tr_b16 v[76:77], v89 offset:12288
    v_mfma_f32_16x16x32_bf16 v[28:31], v[60:63], a[28:31], v[28:31]
    buffer_load_dwordx4 a[16:19], v92, s[4:7], s3 offen offset:256 sc1
    v_mfma_f32_16x16x32_bf16 v[44:47], v[60:63], a[32:35], v[44:47]
    ds_read_b64_tr_b16 v[78:79], v89 offset:14336
    v_mfma_f32_16x16x32_bf16 v[16:19], v[64:67], a[24:27], v[16:19]
    ds_read_b64_tr_b16 v[80:81], v90 offset:12288
    v_mfma_f32_16x16x32_bf16 v[32:35], v[64:67], a[28:31], v[32:35]
    ds_read_b64_tr_b16 v[82:83], v90 offset:14336
    v_mfma_f32_16x16x32_bf16 v[48:51], v[64:67], a[32:35], v[48:51]
    buffer_load_dwordx4 a[20:23], v92, s[4:7], s3 offen offset:512 sc1
    v_mfma_f32_16x16x32_bf16 v[20:23], v[68:71], a[24:27], v[20:23]
    ds_read_b64_tr_b16 v[84:85], v91 offset:12288
    v_mfma_f32_16x16x32_bf16 v[36:39], v[68:71], a[28:31], v[36:39]
    ds_read_b64_tr_b16 v[86:87], v91 offset:14336
    v_mfma_f32_16x16x32_bf16 v[52:55], v[68:71], a[32:35], v[52:55]
    s_waitcnt vmcnt(15) lgkmcnt(0)
    v_mfma_f32_16x16x32_bf16 v[8:11], v[72:75], a[36:39], v[8:11]
    s_add_u32 s3, s61, 129024
    buffer_load_dwordx4 a[24:27], v131, s[4:7], s3 offen offset:0 sc1
    v_mfma_f32_16x16x32_bf16 v[24:27], v[72:75], a[40:43], v[24:27]
    ds_read_b64_tr_b16 v[56:57], v88 offset:16384
    v_mfma_f32_16x16x32_bf16 v[40:43], v[72:75], a[44:47], v[40:43]
    buffer_load_dwordx4 a[28:31], v92, s[4:7], s3 offen offset:256 sc1
    v_mfma_f32_16x16x32_bf16 v[12:15], v[76:79], a[36:39], v[12:15]
    ds_read_b64_tr_b16 v[58:59], v88 offset:18432
    v_mfma_f32_16x16x32_bf16 v[28:31], v[76:79], a[40:43], v[28:31]
    buffer_load_dwordx4 a[32:35], v92, s[4:7], s3 offen offset:512 sc1
    v_mfma_f32_16x16x32_bf16 v[44:47], v[76:79], a[44:47], v[44:47]
    ds_read_b64_tr_b16 v[60:61], v89 offset:16384
    v_mfma_f32_16x16x32_bf16 v[16:19], v[80:83], a[36:39], v[16:19]
    ds_read_b64_tr_b16 v[62:63], v89 offset:18432
    v_mfma_f32_16x16x32_bf16 v[32:35], v[80:83], a[40:43], v[32:35]
    buffer_load_dword v95, v3, s[4:7], 0 offen offset:2048 sc1
    v_mfma_f32_16x16x32_bf16 v[48:51], v[80:83], a[44:47], v[48:51]
    ds_read_b64_tr_b16 v[64:65], v90 offset:16384
    v_mfma_f32_16x16x32_bf16 v[20:23], v[84:87], a[36:39], v[20:23]
    buffer_load_dword v95, v3, s[4:7], 0 offen offset:0 sc1
    ds_read_b64_tr_b16 v[66:67], v90 offset:18432
    v_mfma_f32_16x16x32_bf16 v[36:39], v[84:87], a[40:43], v[36:39]
    ds_read_b64_tr_b16 v[68:69], v91 offset:16384
    v_mfma_f32_16x16x32_bf16 v[52:55], v[84:87], a[44:47], v[52:55]
    ds_read_b64_tr_b16 v[70:71], v91 offset:18432
    s_waitcnt vmcnt(17) lgkmcnt(0)
    v_mfma_f32_16x16x32_bf16 v[8:11], v[56:59], a[48:51], v[8:11]
    s_add_u32 s3, s61, 147456
    buffer_load_dwordx4 a[36:39], v131, s[4:7], s3 offen offset:0 sc1
    v_mfma_f32_16x16x32_bf16 v[24:27], v[56:59], a[52:55], v[24:27]
    ds_read_b64_tr_b16 v[72:73], v88 offset:20480
    v_mfma_f32_16x16x32_bf16 v[40:43], v[56:59], a[56:59], v[40:43]
    ds_read_b64_tr_b16 v[74:75], v88 offset:22528
    v_mfma_f32_16x16x32_bf16 v[12:15], v[60:63], a[48:51], v[12:15]
    ds_read_b64_tr_b16 v[76:77], v89 offset:20480
    v_mfma_f32_16x16x32_bf16 v[28:31], v[60:63], a[52:55], v[28:31]
    buffer_load_dwordx4 a[40:43], v92, s[4:7], s3 offen offset:256 sc1
    v_mfma_f32_16x16x32_bf16 v[44:47], v[60:63], a[56:59], v[44:47]
    ds_read_b64_tr_b16 v[78:79], v89 offset:22528
    v_mfma_f32_16x16x32_bf16 v[16:19], v[64:67], a[48:51], v[16:19]
    ds_read_b64_tr_b16 v[80:81], v90 offset:20480
    v_mfma_f32_16x16x32_bf16 v[32:35], v[64:67], a[52:55], v[32:35]
    ds_read_b64_tr_b16 v[82:83], v90 offset:22528
    v_mfma_f32_16x16x32_bf16 v[48:51], v[64:67], a[56:59], v[48:51]
    buffer_load_dwordx4 a[44:47], v92, s[4:7], s3 offen offset:512 sc1
    v_mfma_f32_16x16x32_bf16 v[20:23], v[68:71], a[48:51], v[20:23]
    ds_read_b64_tr_b16 v[84:85], v91 offset:20480
    v_mfma_f32_16x16x32_bf16 v[36:39], v[68:71], a[52:55], v[36:39]
    ds_read_b64_tr_b16 v[86:87], v91 offset:22528
    v_mfma_f32_16x16x32_bf16 v[52:55], v[68:71], a[56:59], v[52:55]
    s_waitcnt vmcnt(14) lgkmcnt(0)
    v_mfma_f32_16x16x32_bf16 v[8:11], v[72:75], a[0:3], v[8:11]
    s_add_u32 s3, s61, 165888
    buffer_load_dwordx4 a[48:51], v131, s[4:7], s3 offen offset:0 sc1
    v_mfma_f32_16x16x32_bf16 v[24:27], v[72:75], a[4:7], v[24:27]
    ds_read_b64_tr_b16 v[56:57], v88 offset:24576
    v_mfma_f32_16x16x32_bf16 v[40:43], v[72:75], a[8:11], v[40:43]
    ds_read_b64_tr_b16 v[58:59], v88 offset:26624
    v_mfma_f32_16x16x32_bf16 v[12:15], v[76:79], a[0:3], v[12:15]
    ds_read_b64_tr_b16 v[60:61], v89 offset:24576
    v_mfma_f32_16x16x32_bf16 v[28:31], v[76:79], a[4:7], v[28:31]
    buffer_load_dwordx4 a[52:55], v92, s[4:7], s3 offen offset:256 sc1
    v_mfma_f32_16x16x32_bf16 v[44:47], v[76:79], a[8:11], v[44:47]
    ds_read_b64_tr_b16 v[62:63], v89 offset:26624
    v_mfma_f32_16x16x32_bf16 v[16:19], v[80:83], a[0:3], v[16:19]
    ds_read_b64_tr_b16 v[64:65], v90 offset:24576
    v_mfma_f32_16x16x32_bf16 v[32:35], v[80:83], a[4:7], v[32:35]
    ds_read_b64_tr_b16 v[66:67], v90 offset:26624
    v_mfma_f32_16x16x32_bf16 v[48:51], v[80:83], a[8:11], v[48:51]
    buffer_load_dwordx4 a[56:59], v92, s[4:7], s3 offen offset:512 sc1
    v_mfma_f32_16x16x32_bf16 v[20:23], v[84:87], a[0:3], v[20:23]
    ds_read_b64_tr_b16 v[68:69], v91 offset:24576
    v_mfma_f32_16x16x32_bf16 v[36:39], v[84:87], a[4:7], v[36:39]
    ds_read_b64_tr_b16 v[70:71], v91 offset:26624
    v_mfma_f32_16x16x32_bf16 v[52:55], v[84:87], a[8:11], v[52:55]
    s_waitcnt vmcnt(11) lgkmcnt(0)
    s_barrier
    v_mfma_f32_16x16x32_bf16 v[8:11], v[56:59], a[12:15], v[8:11]
    ds_read_b64_tr_b16 v[72:73], v88 offset:28672
    v_and_b32 v137, 0xffff0000, v100
    v_mfma_f32_16x16x32_bf16 v[24:27], v[56:59], a[16:19], v[24:27]
    ds_read_b64_tr_b16 v[74:75], v88 offset:30720
    v_lshlrev_b32 v136, 16, v100
    v_mfma_f32_16x16x32_bf16 v[40:43], v[56:59], a[20:23], v[40:43]
    ds_read_b64_tr_b16 v[76:77], v89 offset:28672
    v_and_b32 v139, 0xffff0000, v101
    v_mfma_f32_16x16x32_bf16 v[12:15], v[60:63], a[12:15], v[12:15]
    ds_read_b64_tr_b16 v[78:79], v89 offset:30720
    v_lshlrev_b32 v138, 16, v101
    v_mfma_f32_16x16x32_bf16 v[28:31], v[60:63], a[16:19], v[28:31]
    ds_read_b64_tr_b16 v[80:81], v90 offset:28672
    v_and_b32 v141, 0xffff0000, v102
    v_mfma_f32_16x16x32_bf16 v[44:47], v[60:63], a[20:23], v[44:47]
    ds_read_b64_tr_b16 v[82:83], v90 offset:30720
    v_lshlrev_b32 v140, 16, v102
    v_mfma_f32_16x16x32_bf16 v[16:19], v[64:67], a[12:15], v[16:19]
    ds_read_b64_tr_b16 v[84:85], v91 offset:28672
    v_mfma_f32_16x16x32_bf16 v[32:35], v[64:67], a[16:19], v[32:35]
    ds_read_b64_tr_b16 v[86:87], v91 offset:30720
    v_mfma_f32_16x16x32_bf16 v[48:51], v[64:67], a[20:23], v[48:51]
    v_mfma_f32_16x16x32_bf16 v[20:23], v[68:71], a[12:15], v[20:23]
    v_mfma_f32_16x16x32_bf16 v[36:39], v[68:71], a[16:19], v[36:39]
    v_mfma_f32_16x16x32_bf16 v[52:55], v[68:71], a[20:23], v[52:55]
    s_waitcnt vmcnt(8) lgkmcnt(0)
    v_mfma_f32_16x16x32_bf16 v[16:19], v[80:83], a[24:27], v[16:19]
    ds_read_b64_tr_b16 v[64:65], v90 offset:32768
    ds_read_b64_tr_b16 v[66:67], v90 offset:34816
    v_and_b32 v143, 0xffff0000, v103
    v_mfma_f32_16x16x32_bf16 v[32:35], v[80:83], a[28:31], v[32:35]
    ds_read_b64_tr_b16 v[68:69], v91 offset:32768
    ds_read_b64_tr_b16 v[70:71], v91 offset:34816
    v_lshlrev_b32 v142, 16, v103
    v_mfma_f32_16x16x32_bf16 v[48:51], v[80:83], a[32:35], v[48:51]
    v_and_b32 v145, 0xffff0000, v104
    v_mfma_f32_16x16x32_bf16 v[20:23], v[84:87], a[24:27], v[20:23]
    v_lshlrev_b32 v144, 16, v104
    v_mfma_f32_16x16x32_bf16 v[36:39], v[84:87], a[28:31], v[36:39]
    v_and_b32 v147, 0xffff0000, v105
    v_mfma_f32_16x16x32_bf16 v[52:55], v[84:87], a[32:35], v[52:55]
    v_lshlrev_b32 v146, 16, v105
    s_waitcnt vmcnt(3) lgkmcnt(0)
    v_mfma_f32_16x16x32_bf16 v[16:19], v[64:67], a[36:39], v[16:19]
    ds_read_b64_tr_b16 v[80:81], v90 offset:36864
    ds_read_b64_tr_b16 v[82:83], v90 offset:38912
    v_and_b32 v149, 0xffff0000, v106
    v_mfma_f32_16x16x32_bf16 v[32:35], v[64:67], a[40:43], v[32:35]
    ds_read_b64_tr_b16 v[84:85], v91 offset:36864
    ds_read_b64_tr_b16 v[86:87], v91 offset:38912
    v_lshlrev_b32 v148, 16, v106
    v_mfma_f32_16x16x32_bf16 v[48:51], v[64:67], a[44:47], v[48:51]
    v_and_b32 v151, 0xffff0000, v107
    v_mfma_f32_16x16x32_bf16 v[20:23], v[68:71], a[36:39], v[20:23]
    v_lshlrev_b32 v150, 16, v107
    v_mfma_f32_16x16x32_bf16 v[36:39], v[68:71], a[40:43], v[36:39]
    v_and_b32 v153, 0xffff0000, v108
    v_mfma_f32_16x16x32_bf16 v[52:55], v[68:71], a[44:47], v[52:55]
    v_lshlrev_b32 v152, 16, v108
    s_waitcnt vmcnt(0) lgkmcnt(0)
    v_mov_b32 v95, 1
    s_mov_b64 exec, 1
    s_cmp_eq_u32 s50, 0
    s_cbranch_scc0 L_td_69
    buffer_store_dword v95, v135, s[4:7], 0 offen offset:0
    s_branch L_te_70
L_td_69:
    buffer_store_dword v95, v135, s[4:7], 0 offen offset:0 sc1
L_te_70:
    s_mov_b64 exec, -1
    v_mfma_f32_16x16x32_bf16 v[16:19], v[80:83], a[48:51], v[16:19]
    ds_read_b64_tr_b16 v[56:57], v88 offset:32768
    ds_read_b64_tr_b16 v[58:59], v88 offset:34816
    v_and_b32 v155, 0xffff0000, v109
    v_mfma_f32_16x16x32_bf16 v[32:35], v[80:83], a[52:55], v[32:35]
    ds_read_b64_tr_b16 v[60:61], v89 offset:32768
    ds_read_b64_tr_b16 v[62:63], v89 offset:34816
    v_lshlrev_b32 v154, 16, v109
    v_mfma_f32_16x16x32_bf16 v[48:51], v[80:83], a[56:59], v[48:51]
    ds_read_b64_tr_b16 v[64:65], v88 offset:36864
    ds_read_b64_tr_b16 v[66:67], v88 offset:38912
    v_and_b32 v157, 0xffff0000, v110
    v_mfma_f32_16x16x32_bf16 v[20:23], v[84:87], a[48:51], v[20:23]
    ds_read_b64_tr_b16 v[68:69], v89 offset:36864
    ds_read_b64_tr_b16 v[70:71], v89 offset:38912
    v_lshlrev_b32 v156, 16, v110
    v_mfma_f32_16x16x32_bf16 v[36:39], v[84:87], a[52:55], v[36:39]
    v_and_b32 v159, 0xffff0000, v111
    v_mfma_f32_16x16x32_bf16 v[52:55], v[84:87], a[56:59], v[52:55]
    v_lshlrev_b32 v158, 16, v111
    v_mfma_f32_16x16x32_bf16 v[8:11], v[72:75], a[24:27], v[8:11]
    v_mfma_f32_16x16x32_bf16 v[24:27], v[72:75], a[28:31], v[24:27]
    ds_write_b128 v93, v[16:19] offset:0
    v_mfma_f32_16x16x32_bf16 v[40:43], v[72:75], a[32:35], v[40:43]
    v_mfma_f32_16x16x32_bf16 v[12:15], v[76:79], a[24:27], v[12:15]
    ds_write_b128 v93, v[32:35] offset:2048
    v_mfma_f32_16x16x32_bf16 v[28:31], v[76:79], a[28:31], v[28:31]
    v_mfma_f32_16x16x32_bf16 v[44:47], v[76:79], a[32:35], v[44:47]
    ds_write_b128 v93, v[48:51] offset:4096
    s_waitcnt lgkmcnt(3)
    v_mfma_f32_16x16x32_bf16 v[8:11], v[56:59], a[36:39], v[8:11]
    v_mfma_f32_16x16x32_bf16 v[24:27], v[56:59], a[40:43], v[24:27]
    ds_write_b128 v93, v[20:23] offset:1024
    v_mfma_f32_16x16x32_bf16 v[40:43], v[56:59], a[44:47], v[40:43]
    v_mfma_f32_16x16x32_bf16 v[12:15], v[60:63], a[36:39], v[12:15]
    ds_write_b128 v93, v[36:39] offset:3072
    v_mfma_f32_16x16x32_bf16 v[28:31], v[60:63], a[40:43], v[28:31]
    v_mfma_f32_16x16x32_bf16 v[44:47], v[60:63], a[44:47], v[44:47]
    ds_write_b128 v93, v[52:55] offset:5120
    v_mfma_f32_16x16x32_bf16 v[8:11], v[64:67], a[48:51], v[8:11]
    v_mfma_f32_16x16x32_bf16 v[24:27], v[64:67], a[52:55], v[24:27]
    v_mfma_f32_16x16x32_bf16 v[40:43], v[64:67], a[56:59], v[40:43]
    v_mfma_f32_16x16x32_bf16 v[12:15], v[68:71], a[48:51], v[12:15]
    v_mfma_f32_16x16x32_bf16 v[28:31], v[68:71], a[52:55], v[28:31]
    v_mfma_f32_16x16x32_bf16 v[44:47], v[68:71], a[56:59], v[44:47]
    s_waitcnt lgkmcnt(0)
    s_barrier
    buffer_load_dwordx2 v[126:127], v3, s[4:7], 0 offen offset:0 sc1
    ds_read_b128 v[16:19], v94 offset:0
    ds_read_b128 v[20:23], v94 offset:1024
    ds_read_b128 v[32:35], v94 offset:2048
    ds_read_b128 v[36:39], v94 offset:3072
    ds_read_b128 v[48:51], v94 offset:4096
    ds_read_b128 v[52:55], v94 offset:5120
    s_waitcnt lgkmcnt(4)
    v_pk_add_f32 v[8:9], v[8:9], v[16:17]
    v_pk_add_f32 v[10:11], v[10:11], v[18:19]
    v_pk_add_f32 v[12:13], v[12:13], v[20:21]
    v_pk_add_f32 v[14:15], v[14:15], v[22:23]
    s_waitcnt lgkmcnt(2)
    v_pk_add_f32 v[24:25], v[24:25], v[32:33]
    v_pk_add_f32 v[26:27], v[26:27], v[34:35]
    v_pk_add_f32 v[28:29], v[28:29], v[36:37]
    v_pk_add_f32 v[30:31], v[30:31], v[38:39]
    s_waitcnt lgkmcnt(0)
    s_barrier
    v_pk_add_f32 v[40:41], v[40:41], v[48:49]
    v_pk_add_f32 v[42:43], v[42:43], v[50:51]
    v_pk_add_f32 v[44:45], v[44:45], v[52:53]
    v_pk_add_f32 v[46:47], v[46:47], v[54:55]
    v_pk_add_f32 v[16:17], v[136:137], v[112:113] op_sel_hi:[1,0] neg_lo:[0,1] neg_hi:[0,1]
    v_pk_add_f32 v[18:19], v[138:139], v[112:113] op_sel_hi:[1,0] neg_lo:[0,1] neg_hi:[0,1]
    v_pk_add_f32 v[20:21], v[140:141], v[112:113] op_sel_hi:[1,0] neg_lo:[0,1] neg_hi:[0,1]
    v_pk_add_f32 v[22:23], v[142:143], v[112:113] op_sel_hi:[1,0] neg_lo:[0,1] neg_hi:[0,1]
    v_pk_fma_f32 v[8:9], v[16:17], v[112:113], v[8:9] op_sel:[0,1,0] op_sel_hi:[1,1,1]
    v_pk_fma_f32 v[10:11], v[18:19], v[112:113], v[10:11] op_sel:[0,1,0] op_sel_hi:[1,1,1]
    v_pk_fma_f32 v[12:13], v[20:21], v[112:113], v[12:13] op_sel:[0,1,0] op_sel_hi:[1,1,1]
    v_pk_fma_f32 v[14:15], v[22:23], v[112:113], v[14:15] op_sel:[0,1,0] op_sel_hi:[1,1,1]
    v_cvt_pk_bf16_f32 v100, v8, v9
    v_cvt_pk_bf16_f32 v101, v10, v11
    v_cvt_pk_bf16_f32 v102, v12, v13
    v_cvt_pk_bf16_f32 v103, v14, v15
    s_nop 1
    v_mfma_f32_16x16x32_bf16 v[60:63], v[100:103], v[100:103], 0
    v_mfma_f32_16x16x32_bf16 v[56:59], v[4:7], v[100:103], 0
    v_pk_add_f32 v[32:33], v[144:145], v[114:115] op_sel_hi:[1,0] neg_lo:[0,1] neg_hi:[0,1]
    v_pk_add_f32 v[34:35], v[146:147], v[114:115] op_sel_hi:[1,0] neg_lo:[0,1] neg_hi:[0,1]
    v_pk_add_f32 v[36:37], v[148:149], v[114:115] op_sel_hi:[1,0] neg_lo:[0,1] neg_hi:[0,1]
    v_pk_add_f32 v[38:39], v[150:151], v[114:115] op_sel_hi:[1,0] neg_lo:[0,1] neg_hi:[0,1]
    v_pk_fma_f32 v[24:25], v[32:33], v[114:115], v[24:25] op_sel:[0,1,0] op_sel_hi:[1,1,1]
    v_pk_fma_f32 v[26:27], v[34:35], v[114:115], v[26:27] op_sel:[0,1,0] op_sel_hi:[1,1,1]
    v_pk_fma_f32 v[28:29], v[36:37], v[114:115], v[28:29] op_sel:[0,1,0] op_sel_hi:[1,1,1]
    v_pk_fma_f32 v[30:31], v[38:39], v[114:115], v[30:31] op_sel:[0,1,0] op_sel_hi:[1,1,1]
    v_cvt_pk_bf16_f32 v104, v24, v25
    v_cvt_pk_bf16_f32 v105, v26, v27
    v_cvt_pk_bf16_f32 v106, v28, v29
    v_cvt_pk_bf16_f32 v107, v30, v31
    s_nop 1
    v_mfma_f32_16x16x32_bf16 v[68:71], v[104:107], v[104:107], 0
    v_mfma_f32_16x16x32_bf16 v[64:67], v[4:7], v[104:107], 0
    v_pk_add_f32 v[48:49], v[152:153], v[116:117] op_sel_hi:[1,0] neg_lo:[0,1] neg_hi:[0,1]
    v_pk_add_f32 v[50:51], v[154:155], v[116:117] op_sel_hi:[1,0] neg_lo:[0,1] neg_hi:[0,1]
    v_pk_add_f32 v[52:53], v[156:157], v[116:117] op_sel_hi:[1,0] neg_lo:[0,1] neg_hi:[0,1]
    v_pk_add_f32 v[54:55], v[158:159], v[116:117] op_sel_hi:[1,0] neg_lo:[0,1] neg_hi:[0,1]
    v_pk_fma_f32 v[40:41], v[48:49], v[116:117], v[40:41] op_sel:[0,1,0] op_sel_hi:[1,1,1]
    v_pk_fma_f32 v[42:43], v[50:51], v[116:117], v[42:43] op_sel:[0,1,0] op_sel_hi:[1,1,1]
    v_pk_fma_f32 v[44:45], v[52:53], v[116:117], v[44:45] op_sel:[0,1,0] op_sel_hi:[1,1,1]
    v_pk_fma_f32 v[46:47], v[54:55], v[116:117], v[46:47] op_sel:[0,1,0] op_sel_hi:[1,1,1]
    v_cvt_pk_bf16_f32 v108, v40, v41
    v_cvt_pk_bf16_f32 v109, v42, v43
    v_cvt_pk_bf16_f32 v110, v44, v45
    v_cvt_pk_bf16_f32 v111, v46, v47
    s_nop 1
    v_mfma_f32_16x16x32_bf16 v[76:79], v[108:111], v[108:111], 0
    v_mfma_f32_16x16x32_bf16 v[72:75], v[4:7], v[108:111], 0
    s_mul_i32 s3, s43, 20
    s_bfm_b64 s[30:31], 20, s3
    s_mov_b32 s62, 400000
L_t0:
    s_waitcnt vmcnt(0)
    v_and_b32 v126, v126, v127
    v_cmp_eq_u32 vcc, 0, v126
    s_nop 0
    s_and_b64 vcc, vcc, s[30:31]
    s_cbranch_vccz L_t1
    buffer_load_dwordx2 v[126:127], v3, s[4:7], 0 offen offset:0 sc1
    s_sub_u32 s62, s62, 1
    s_cbranch_scc0 L_t0
    s_endpgm
L_t1:
    s_cmp_lg_u32 s55, 0
    s_cbranch_scc1 L_du_71
    buffer_store_dwordx4 v[100:103], v96, s[4:7], 0 offen offset:0
L_du_71:
    buffer_store_dwordx4 v[104:107], v96, s[4:7], 0 offen offset:256
    buffer_store_dwordx4 v[108:111], v96, s[4:7], 0 offen offset:512
    v_cndmask_b32 v60, v60, v61, s[26:27]
    v_cndmask_b32 v62, v62, v63, s[26:27]
    v_cndmask_b32 v68, v68, v69, s[26:27]
    v_cndmask_b32 v70, v70, v71, s[26:27]
    v_cndmask_b32 v76, v76, v77, s[26:27]
    v_cndmask_b32 v78, v78, v79, s[26:27]
    s_movk_i32 s3, 5120
    v_cndmask_b32 v57, v60, v62, s[28:29]
    s_cmp_lg_u32 s55, 0
    s_cbranch_scc1 L_du_72
    buffer_store_dwordx2 v[56:57], v97, s[4:7], 0 offen offset:0
L_du_72:
    v_cndmask_b32 v65, v68, v70, s[28:29]
    buffer_store_dwordx2 v[64:65], v97, s[4:7], 0 offen offset:2560
    v_cndmask_b32 v73, v76, v78, s[28:29]
    buffer_store_dwordx2 v[72:73], v97, s[4:7], s3 offen offset:0
    v_mov_b32 v3, 1
    s_mov_b64 exec, 1
    s_cmp_eq_u32 s50, 0
    s_cbranch_scc0 L_pf_73
    s_waitcnt vmcnt(0)
    buffer_store_dword v3, v135, s[4:7], 0 offen offset:2048
    s_branch L_pg_74
L_pf_73:
    s_waitcnt vmcnt(0)
    buffer_wbl2 sc1
    s_waitcnt vmcnt(0)
    buffer_store_dword v3, v135, s[4:7], 0 offen offset:2048 sc1
L_pg_74:
    s_mov_b64 exec, -1
    v_and_b32 v17, 0xffff0000, v100
    v_lshlrev_b32 v16, 16, v100
    v_and_b32 v19, 0xffff0000, v101
    v_lshlrev_b32 v18, 16, v101
    v_and_b32 v21, 0xffff0000, v102
    v_lshlrev_b32 v20, 16, v102
    v_and_b32 v23, 0xffff0000, v103
    v_lshlrev_b32 v22, 16, v103
    v_pk_add_f32 v[136:137], v[136:137], v[16:17]
    v_pk_add_f32 v[138:139], v[138:139], v[18:19]
    v_pk_add_f32 v[140:141], v[140:141], v[20:21]
    v_pk_add_f32 v[142:143], v[142:143], v[22:23]
    v_and_b32 v33, 0xffff0000, v104
    v_lshlrev_b32 v32, 16, v104
    v_and_b32 v35, 0xffff0000, v105
    v_lshlrev_b32 v34, 16, v105
    v_and_b32 v37, 0xffff0000, v106
    v_lshlrev_b32 v36, 16, v106
    v_and_b32 v39, 0xffff0000, v107
    v_lshlrev_b32 v38, 16, v107
    v_pk_add_f32 v[144:145], v[144:145], v[32:33]
    v_pk_add_f32 v[146:147], v[146:147], v[34:35]
    v_pk_add_f32 v[148:149], v[148:149], v[36:37]
    v_pk_add_f32 v[150:151], v[150:151], v[38:39]
    v_and_b32 v49, 0xffff0000, v108
    v_lshlrev_b32 v48, 16, v108
    v_and_b32 v51, 0xffff0000, v109
    v_lshlrev_b32 v50, 16, v109
    v_and_b32 v53, 0xffff0000, v110
    v_lshlrev_b32 v52, 16, v110
    v_and_b32 v55, 0xffff0000, v111
    v_lshlrev_b32 v54, 16, v111
    v_pk_add_f32 v[152:153], v[152:153], v[48:49]
    v_pk_add_f32 v[154:155], v[154:155], v[50:51]
    v_pk_add_f32 v[156:157], v[156:157], v[52:53]
    v_pk_add_f32 v[158:159], v[158:159], v[54:55]
    s_cmp_ge_u32 s39, 28
    s_cbranch_scc0 L_p6
    s_barrier
    s_and_b32 s58, s39, 1
    s_lshl_b32 s58, s58, 2
    s_add_u32 s58, s58, s40
    s_load_dwordx2 s[30:31], s[0:1], 56
    s_waitcnt lgkmcnt(0)
    s_mov_b32 s12, s30
    s_mov_b32 s13, s31
    s_mov_b32 s14, 2211840
    s_mov_b32 s15, 0x20000
    s_lshl_b32 s3, s58, 6
    v_add_u32 v20, s3, v0
    s_mov_b32 s3, 819200
    s_mov_b32 s49, 13
    s_mul_i32 s52, s38, 13
    s_lshr_b32 s52, s52, 3
    s_mul_i32 s53, s52, 512
    v_add_u32 v20, s53, v20
L_vt_75:
    s_cmp_lg_u32 s52, 13
    s_cbranch_scc1 L_vw_76
    v_subrev_u32 v20, 6656, v20
L_vw_76:
    s_add_u32 s52, s52, 1
    v_min_u32 v21, 6399, v20
    v_lshlrev_b32 v21, 7, v21
    s_waitcnt vmcnt(2)
    buffer_load_dword v22, v21, s[12:15], s3 offen sc1
    v_add_u32 v20, 512, v20
    s_sub_u32 s49, s49, 1
    s_cmp_lg_u32 s49, 0
    s_cbranch_scc1 L_vt_75
    s_waitcnt vmcnt(0)
    s_barrier
    s_branch L_p7
L_p6:
    v_lshrrev_b32 v121, 2, v2
    v_lshl_add_u32 v121, v1, 2, v121
    v_and_b32 v122, 7, v121
    s_lshl_b32 s3, s40, 1
    v_xor_b32 v122, s3, v122
    v_lshlrev_b32 v122, 5, v122
    v_lshl_add_u32 v122, v121, 8, v122
    v_and_b32 v121, 3, v2
    v_lshl_add_u32 v112, v121, 3, v122
    v_xor_b32 v113, 32, v112
    v_xor_b32 v114, 64, v112
    v_xor_b32 v115, 96, v112
    v_xor_b32 v116, 128, v112
    v_xor_b32 v117, 160, v112
    v_xor_b32 v118, 192, v112
    v_xor_b32 v119, 224, v112
    s_cmp_ge_u32 s39, 14
    s_cselect_b32 s58, 8, 0
    s_lshl_b32 s3, s40, 1
    s_add_u32 s58, s58, s3
    s_lshl_b32 s3, s58, 8
    s_add_u32 s3, s3, 16640
    v_add_u32 v120, s3, v132
    s_mul_i32 s3, s48, 73728
    s_add_u32 s3, s3, 1031936
    v_add_u32 v121, s3, v120
    s_mul_i32 s3, s58, 2560
    s_add_u32 s3, s3, 2315264
    v_lshlrev_b32 v130, 8, v1
    v_lshl_add_u32 v130, v2, 4, v130
    v_add_u32 v130, s3, v130
    v_mov_b32 v131, 1073741824
    v_cmp_gt_u32 vcc, 32, v0
    s_nop 1
    v_cndmask_b32 v131, v131, v130, vcc
    v_add_u32 v122, 40960, v112
    v_add_u32 v123, 40960, v113
    ds_read_b64_tr_b16 v[80:81], v112 offset:0
    ds_read_b64_tr_b16 v[82:83], v112 offset:4096
    ds_read_b64_tr_b16 v[84:85], v113 offset:0
    ds_read_b64_tr_b16 v[86:87], v113 offset:4096
    ds_read_b64_tr_b16 v[88:89], v112 offset:8192
    ds_read_b64_tr_b16 v[90:91], v112 offset:12288
    ds_read_b64_tr_b16 v[92:93], v113 offset:8192
    ds_read_b64_tr_b16 v[94:95], v113 offset:12288
    ds_read_b64_tr_b16 v[96:97], v112 offset:16384
    ds_read_b64_tr_b16 v[98:99], v112 offset:20480
    ds_read_b64_tr_b16 v[100:101], v113 offset:16384
    ds_read_b64_tr_b16 v[102:103], v113 offset:20480
    ds_read_b64_tr_b16 v[104:105], v112 offset:24576
    ds_read_b64_tr_b16 v[106:107], v112 offset:28672
    ds_read_b64_tr_b16 v[108:109], v113 offset:24576
    ds_read_b64_tr_b16 v[110:111], v113 offset:28672
    s_waitcnt lgkmcnt(12)
    v_mfma_f32_16x16x32_bf16 v[72:75], v[80:83], v[4:7], 0
    v_mfma_f32_16x16x32_bf16 v[76:79], v[84:87], v[4:7], 0
    ds_read_b64_tr_b16 v[80:81], v112 offset:32768
    ds_read_b64_tr_b16 v[82:83], v112 offset:36864
    ds_read_b64_tr_b16 v[84:85], v113 offset:32768
    ds_read_b64_tr_b16 v[86:87], v113 offset:36864
    s_waitcnt lgkmcnt(12)
    v_mfma_f32_16x16x32_bf16 v[72:75], v[88:91], v[4:7], v[72:75]
    v_mfma_f32_16x16x32_bf16 v[76:79], v[92:95], v[4:7], v[76:79]
    ds_read_b64_tr_b16 v[88:89], v122 offset:0
    ds_read_b64_tr_b16 v[90:91], v122 offset:4096
    ds_read_b64_tr_b16 v[92:93], v123 offset:0
    ds_read_b64_tr_b16 v[94:95], v123 offset:4096
    s_waitcnt lgkmcnt(12)
    v_mfma_f32_16x16x32_bf16 v[72:75], v[96:99], v[4:7], v[72:75]
    v_mfma_f32_16x16x32_bf16 v[76:79], v[100:103], v[4:7], v[76:79]
    ds_read_b64_tr_b16 v[96:97], v122 offset:8192
    ds_read_b64_tr_b16 v[98:99], v122 offset:12288
    ds_read_b64_tr_b16 v[100:101], v123 offset:8192
    ds_read_b64_tr_b16 v[102:103], v123 offset:12288
    s_waitcnt lgkmcnt(12)
    v_mfma_f32_16x16x32_bf16 v[72:75], v[104:107], v[4:7], v[72:75]
    v_mfma_f32_16x16x32_bf16 v[76:79], v[108:111], v[4:7], v[76:79]
    ds_read_b64_tr_b16 v[104:105], v122 offset:16384
    ds_read_b64_tr_b16 v[106:107], v122 offset:20480
    ds_read_b64_tr_b16 v[108:109], v123 offset:16384
    ds_read_b64_tr_b16 v[110:111], v123 offset:20480
    s_waitcnt lgkmcnt(12)
    v_mfma_f32_16x16x32_bf16 v[72:75], v[80:83], v[4:7], v[72:75]
    v_mfma_f32_16x16x32_bf16 v[76:79], v[84:87], v[4:7], v[76:79]
    ds_read_b64_tr_b16 v[80:81], v122 offset:24576
    ds_read_b64_tr_b16 v[82:83], v122 offset:28672
    ds_read_b64_tr_b16 v[84:85], v123 offset:24576
    ds_read_b64_tr_b16 v[86:87], v123 offset:28672
    s_waitcnt lgkmcnt(12)
    v_mfma_f32_16x16x32_bf16 v[72:75], v[88:91], v[4:7], v[72:75]
    v_mfma_f32_16x16x32_bf16 v[76:79], v[92:95], v[4:7], v[76:79]
    ds_read_b64_tr_b16 v[88:89], v122 offset:32768
    ds_read_b64_tr_b16 v[90:91], v122 offset:36864
    ds_read_b64_tr_b16 v[92:93], v123 offset:32768
    ds_read_b64_tr_b16 v[94:95], v123 offset:36864
    s_waitcnt lgkmcnt(12)
    v_mfma_f32_16x16x32_bf16 v[72:75], v[96:99], v[4:7], v[72:75]
    v_mfma_f32_16x16x32_bf16 v[76:79], v[100:103], v[4:7], v[76:79]
    s_waitcnt lgkmcnt(8)
    v_mfma_f32_16x16x32_bf16 v[72:75], v[104:107], v[4:7], v[72:75]
    v_mfma_f32_16x16x32_bf16 v[76:79], v[108:111], v[4:7], v[76:79]
    s_waitcnt lgkmcnt(4)
    v_mfma_f32_16x16x32_bf16 v[72:75], v[80:83], v[4:7], v[72:75]
    v_mfma_f32_16x16x32_bf16 v[76:79], v[84:87], v[4:7], v[76:79]
    s_waitcnt lgkmcnt(0)
    v_mfma_f32_16x16x32_bf16 v[72:75], v[88:91], v[4:7], v[72:75]
    v_mfma_f32_16x16x32_bf16 v[76:79], v[92:95], v[4:7], v[76:79]
    ds_read_b64_tr_b16 v[80:81], v112 offset:0
    ds_read_b64_tr_b16 v[82:83], v112 offset:4096
    ds_read_b64_tr_b16 v[84:85], v113 offset:0
    ds_read_b64_tr_b16 v[86:87], v113 offset:4096
    ds_read_b64_tr_b16 v[88:89], v114 offset:0
    ds_read_b64_tr_b16 v[90:91], v114 offset:4096
    ds_read_b64_tr_b16 v[92:93], v115 offset:0
    ds_read_b64_tr_b16 v[94:95], v115 offset:4096
    ds_read_b64_tr_b16 v[96:97], v116 offset:0
    ds_read_b64_tr_b16 v[98:99], v116 offset:4096
    ds_read_b64_tr_b16 v[100:101], v117 offset:0
    ds_read_b64_tr_b16 v[102:103], v117 offset:4096
    ds_read_b64_tr_b16 v[104:105], v118 offset:0
    ds_read_b64_tr_b16 v[106:107], v118 offset:4096
    ds_read_b64_tr_b16 v[108:109], v119 offset:0
    ds_read_b64_tr_b16 v[110:111], v119 offset:4096
    s_cmp_ge_u32 s39, 14
    s_cselect_b32 s31, 10, 0
    s_mov_b32 s62, 400000
    v_lshlrev_b32 v3, 3, v0
    s_lshl_b32 s3, s31, 1
    s_lshl_b32 s52, 20, 1
    s_bfm_b64 exec, s52, s3
L_po_77:
    buffer_load_dwordx2 v[126:127], v3, s[4:7], 0 offen offset:2048 sc1
    s_waitcnt vmcnt(0)
    v_and_b32 v126, v126, v127
    v_cmp_eq_u32 vcc, 0, v126
    s_cbranch_vccz L_pp_78
    s_sub_u32 s62, s62, 1
    s_cbranch_scc0 L_po_77
    s_endpgm
L_pp_78:
    s_mov_b64 exec, -1
    s_cmp_eq_u32 s50, 0
    s_cbranch_scc1 L_pq_79
    buffer_inv sc1
    s_waitcnt vmcnt(0)
L_pq_79:
    s_mov_b32 s3, 0
    buffer_load_dwordx4 a[0:3], v120, s[4:7], s3 offen offset:0 sc1
    buffer_load_dwordx4 a[4:7], v120, s[4:7], s3 offen offset:256 sc1
    s_mov_b32 s3, 18432
    buffer_load_dwordx4 a[8:11], v120, s[4:7], s3 offen offset:0 sc1
    buffer_load_dwordx4 a[12:15], v120, s[4:7], s3 offen offset:256 sc1
    s_mov_b32 s3, 36864
    buffer_load_dwordx4 a[16:19], v120, s[4:7], s3 offen offset:0 sc1
    buffer_load_dwordx4 a[20:23], v120, s[4:7], s3 offen offset:256 sc1
    s_waitcnt vmcnt(4)
    s_waitcnt lgkmcnt(12)
    v_mfma_f32_16x16x32_bf16 v[8:11], v[80:83], a[0:3], 0
    s_mov_b32 s3, 55296
    buffer_load_dwordx4 a[24:27], v120, s[4:7], s3 offen offset:0 sc1
    v_mfma_f32_16x16x32_bf16 v[40:43], v[80:83], a[4:7], 0
    v_mfma_f32_16x16x32_bf16 v[12:15], v[84:87], a[0:3], 0
    ds_read_b64_tr_b16 v[80:81], v112 offset:8192
    buffer_load_dwordx4 a[28:31], v120, s[4:7], s3 offen offset:256 sc1
    v_mfma_f32_16x16x32_bf16 v[44:47], v[84:87], a[4:7], 0
    ds_read_b64_tr_b16 v[82:83], v112 offset:12288
    s_waitcnt lgkmcnt(10)
    v_mfma_f32_16x16x32_bf16 v[16:19], v[88:91], a[0:3], 0
    ds_read_b64_tr_b16 v[84:85], v113 offset:8192
    s_mov_b32 s3, 73728
    buffer_load_dwordx4 a[32:35], v120, s[4:7], s3 offen offset:0 sc1
    v_mfma_f32_16x16x32_bf16 v[48:51], v[88:91], a[4:7], 0
    ds_read_b64_tr_b16 v[86:87], v113 offset:12288
    v_mfma_f32_16x16x32_bf16 v[20:23], v[92:95], a[0:3], 0
    ds_read_b64_tr_b16 v[88:89], v114 offset:8192
    buffer_load_dwordx4 a[36:39], v120, s[4:7], s3 offen offset:256 sc1
    v_mfma_f32_16x16x32_bf16 v[52:55], v[92:95], a[4:7], 0
    ds_read_b64_tr_b16 v[90:91], v114 offset:12288
    s_waitcnt lgkmcnt(10)
    v_mfma_f32_16x16x32_bf16 v[24:27], v[96:99], a[0:3], 0
    ds_read_b64_tr_b16 v[92:93], v115 offset:8192
    v_mfma_f32_16x16x32_bf16 v[56:59], v[96:99], a[4:7], 0
    ds_read_b64_tr_b16 v[94:95], v115 offset:12288
    v_mfma_f32_16x16x32_bf16 v[28:31], v[100:103], a[0:3], 0
    ds_read_b64_tr_b16 v[96:97], v116 offset:8192
    v_mfma_f32_16x16x32_bf16 v[60:63], v[100:103], a[4:7], 0
    ds_read_b64_tr_b16 v[98:99], v116 offset:12288
    s_waitcnt lgkmcnt(10)
    v_mfma_f32_16x16x32_bf16 v[32:35], v[104:107], a[0:3], 0
    ds_read_b64_tr_b16 v[100:101], v117 offset:8192
    v_mfma_f32_16x16x32_bf16 v[64:67], v[104:107], a[4:7], 0
    ds_read_b64_tr_b16 v[102:103], v117 offset:12288
    v_mfma_f32_16x16x32_bf16 v[36:39], v[108:111], a[0:3], 0
    ds_read_b64_tr_b16 v[104:105], v118 offset:8192
    v_mfma_f32_16x16x32_bf16 v[68:71], v[108:111], a[4:7], 0
    ds_read_b64_tr_b16 v[106:107], v118 offset:12288
    s_waitcnt vmcnt(6)
    s_waitcnt lgkmcnt(10)
    v_mfma_f32_16x16x32_bf16 v[8:11], v[80:83], a[8:11], v[8:11]
    ds_read_b64_tr_b16 v[108:109], v119 offset:8192
    s_mov_b32 s3, 92160
    buffer_load_dwordx4 a[40:43], v120, s[4:7], s3 offen offset:0 sc1
    v_mfma_f32_16x16x32_bf16 v[40:43], v[80:83], a[12:15], v[40:43]
    ds_read_b64_tr_b16 v[110:111], v119 offset:12288
    v_mfma_f32_16x16x32_bf16 v[12:15], v[84:87], a[8:11], v[12:15]
    ds_read_b64_tr_b16 v[80:81], v112 offset:16384
    buffer_load_dwordx4 a[44:47], v120, s[4:7], s3 offen offset:256 sc1
    v_mfma_f32_16x16x32_bf16 v[44:47], v[84:87], a[12:15], v[44:47]
    ds_read_b64_tr_b16 v[82:83], v112 offset:20480
    s_waitcnt lgkmcnt(10)
    v_mfma_f32_16x16x32_bf16 v[16:19], v[88:91], a[8:11], v[16:19]
    ds_read_b64_tr_b16 v[84:85], v113 offset:16384
    s_mov_b32 s3, 110592
    buffer_load_dwordx4 a[48:51], v120, s[4:7], s3 offen offset:0 sc1
    v_mfma_f32_16x16x32_bf16 v[48:51], v[88:91], a[12:15], v[48:51]
    ds_read_b64_tr_b16 v[86:87], v113 offset:20480
    v_mfma_f32_16x16x32_bf16 v[20:23], v[92:95], a[8:11], v[20:23]
    ds_read_b64_tr_b16 v[88:89], v114 offset:16384
    buffer_load_dwordx4 a[52:55], v120, s[4:7], s3 offen offset:256 sc1
    v_mfma_f32_16x16x32_bf16 v[52:55], v[92:95], a[12:15], v[52:55]
    ds_read_b64_tr_b16 v[90:91], v114 offset:20480
    s_waitcnt lgkmcnt(10)
    v_mfma_f32_16x16x32_bf16 v[24:27], v[96:99], a[8:11], v[24:27]
    ds_read_b64_tr_b16 v[92:93], v115 offset:16384
    v_mfma_f32_16x16x32_bf16 v[56:59], v[96:99], a[12:15], v[56:59]
    ds_read_b64_tr_b16 v[94:95], v115 offset:20480
    v_mfma_f32_16x16x32_bf16 v[28:31], v[100:103], a[8:11], v[28:31]
    ds_read_b64_tr_b16 v[96:97], v116 offset:16384
    v_mfma_f32_16x16x32_bf16 v[60:63], v[100:103], a[12:15], v[60:63]
    ds_read_b64_tr_b16 v[98:99], v116 offset:20480
    s_waitcnt lgkmcnt(10)
    v_mfma_f32_16x16x32_bf16 v[32:35], v[104:107], a[8:11], v[32:35]
    ds_read_b64_tr_b16 v[100:101], v117 offset:16384
    v_mfma_f32_16x16x32_bf16 v[64:67], v[104:107], a[12:15], v[64:67]
    ds_read_b64_tr_b16 v[102:103], v117 offset:20480
    v_mfma_f32_16x16x32_bf16 v[36:39], v[108:111], a[8:11], v[36:39]
    ds_read_b64_tr_b16 v[104:105], v118 offset:16384
    v_mfma_f32_16x16x32_bf16 v[68:71], v[108:111], a[12:15], v[68:71]
    ds_read_b64_tr_b16 v[106:107], v118 offset:20480
    s_waitcnt vmcnt(8)
    s_waitcnt lgkmcnt(10)
    v_mfma_f32_16x16x32_bf16 v[8:11], v[80:83], a[16:19], v[8:11]
    ds_read_b64_tr_b16 v[108:109], v119 offset:16384
    s_mov_b32 s3, 129024
    buffer_load_dwordx4 a[56:59], v120, s[4:7], s3 offen offset:0 sc1
    v_mfma_f32_16x16x32_bf16 v[40:43], v[80:83], a[20:23], v[40:43]
    ds_read_b64_tr_b16 v[110:111], v119 offset:20480
    v_mfma_f32_16x16x32_bf16 v[12:15], v[84:87], a[16:19], v[12:15]
    ds_read_b64_tr_b16 v[80:81], v112 offset:24576
    buffer_load_dwordx4 a[60:63], v120, s[4:7], s3 offen offset:256 sc1
    v_mfma_f32_16x16x32_bf16 v[44:47], v[84:87], a[20:23], v[44:47]
    ds_read_b64_tr_b16 v[82:83], v112 offset:28672
    s_waitcnt lgkmcnt(10)
    v_mfma_f32_16x16x32_bf16 v[16:19], v[88:91], a[16:19], v[16:19]
    ds_read_b64_tr_b16 v[84:85], v113 offset:24576
    s_mov_b32 s3, 147456
    buffer_load_dwordx4 a[64:67], v120, s[4:7], s3 offen offset:0 sc1
    v_mfma_f32_16x16x32_bf16 v[48:51], v[88:91], a[20:23], v[48:51]
    ds_read_b64_tr_b16 v[86:87], v113 offset:28672
    v_mfma_f32_16x16x32_bf16 v[20:23], v[92:95], a[16:19], v[20:23]
    ds_read_b64_tr_b16 v[88:89], v114 offset:24576
    buffer_load_dwordx4 a[68:71], v120, s[4:7], s3 offen offset:256 sc1
    v_mfma_f32_16x16x32_bf16 v[52:55], v[92:95], a[20:23], v[52:55]
    ds_read_b64_tr_b16 v[90:91], v114 offset:28672
    s_waitcnt lgkmcnt(10)
    v_mfma_f32_16x16x32_bf16 v[24:27], v[96:99], a[16:19], v[24:27]
    ds_read_b64_tr_b16 v[92:93], v115 offset:24576
    v_mfma_f32_16x16x32_bf16 v[56:59], v[96:99], a[20:23], v[56:59]
    ds_read_b64_tr_b16 v[94:95], v115 offset:28672
    v_mfma_f32_16x16x32_bf16 v[28:31], v[100:103], a[16:19], v[28:31]
    ds_read_b64_tr_b16 v[96:97], v116 offset:24576
    v_mfma_f32_16x16x32_bf16 v[60:63], v[100:103], a[20:23], v[60:63]
    ds_read_b64_tr_b16 v[98:99], v116 offset:28672
    s_waitcnt lgkmcnt(10)
    v_mfma_f32_16x16x32_bf16 v[32:35], v[104:107], a[16:19], v[32:35]
    ds_read_b64_tr_b16 v[100:101], v117 offset:24576
    v_mfma_f32_16x16x32_bf16 v[64:67], v[104:107], a[20:23], v[64:67]
    ds_read_b64_tr_b16 v[102:103], v117 offset:28672
    v_mfma_f32_16x16x32_bf16 v[36:39], v[108:111], a[16:19], v[36:39]
    ds_read_b64_tr_b16 v[104:105], v118 offset:24576
    v_mfma_f32_16x16x32_bf16 v[68:71], v[108:111], a[20:23], v[68:71]
    ds_read_b64_tr_b16 v[106:107], v118 offset:28672
    s_waitcnt vmcnt(10)
    s_waitcnt lgkmcnt(10)
    v_mfma_f32_16x16x32_bf16 v[8:11], v[80:83], a[24:27], v[8:11]
    ds_read_b64_tr_b16 v[108:109], v119 offset:24576
    s_mov_b32 s3, 165888
    buffer_load_dwordx4 a[0:3], v120, s[4:7], s3 offen offset:0 sc1
    v_mfma_f32_16x16x32_bf16 v[40:43], v[80:83], a[28:31], v[40:43]
    ds_read_b64_tr_b16 v[110:111], v119 offset:28672
    v_mfma_f32_16x16x32_bf16 v[12:15], v[84:87], a[24:27], v[12:15]
    ds_read_b64_tr_b16 v[80:81], v112 offset:32768
    buffer_load_dwordx4 a[4:7], v120, s[4:7], s3 offen offset:256 sc1
    v_mfma_f32_16x16x32_bf16 v[44:47], v[84:87], a[28:31], v[44:47]
    ds_read_b64_tr_b16 v[82:83], v112 offset:36864
    s_waitcnt lgkmcnt(10)
    v_mfma_f32_16x16x32_bf16 v[16:19], v[88:91], a[24:27], v[16:19]
    ds_read_b64_tr_b16 v[84:85], v113 offset:32768
    s_mov_b32 s3, 184320
    buffer_load_dwordx4 a[8:11], v120, s[4:7], s3 offen offset:0 sc1
    v_mfma_f32_16x16x32_bf16 v[48:51], v[88:91], a[28:31], v[48:51]
    ds_read_b64_tr_b16 v[86:87], v113 offset:36864
    v_mfma_f32_16x16x32_bf16 v[20:23], v[92:95], a[24:27], v[20:23]
    ds_read_b64_tr_b16 v[88:89], v114 offset:32768
    buffer_load_dwordx4 a[12:15], v120, s[4:7], s3 offen offset:256 sc1
    v_mfma_f32_16x16x32_bf16 v[52:55], v[92:95], a[28:31], v[52:55]
    ds_read_b64_tr_b16 v[90:91], v114 offset:36864
    s_waitcnt lgkmcnt(10)
    v_mfma_f32_16x16x32_bf16 v[24:27], v[96:99], a[24:27], v[24:27]
    ds_read_b64_tr_b16 v[92:93], v115 offset:32768
    v_mfma_f32_16x16x32_bf16 v[56:59], v[96:99], a[28:31], v[56:59]
    ds_read_b64_tr_b16 v[94:95], v115 offset:36864
    v_mfma_f32_16x16x32_bf16 v[28:31], v[100:103], a[24:27], v[28:31]
    ds_read_b64_tr_b16 v[96:97], v116 offset:32768
    v_mfma_f32_16x16x32_bf16 v[60:63], v[100:103], a[28:31], v[60:63]
    ds_read_b64_tr_b16 v[98:99], v116 offset:36864
    s_waitcnt lgkmcnt(10)
    v_mfma_f32_16x16x32_bf16 v[32:35], v[104:107], a[24:27], v[32:35]
    ds_read_b64_tr_b16 v[100:101], v117 offset:32768
    v_mfma_f32_16x16x32_bf16 v[64:67], v[104:107], a[28:31], v[64:67]
    ds_read_b64_tr_b16 v[102:103], v117 offset:36864
    v_mfma_f32_16x16x32_bf16 v[36:39], v[108:111], a[24:27], v[36:39]
    ds_read_b64_tr_b16 v[104:105], v118 offset:32768
    v_mfma_f32_16x16x32_bf16 v[68:71], v[108:111], a[28:31], v[68:71]
    ds_read_b64_tr_b16 v[106:107], v118 offset:36864
    s_waitcnt vmcnt(12)
    s_waitcnt lgkmcnt(10)
    v_mfma_f32_16x16x32_bf16 v[8:11], v[80:83], a[32:35], v[8:11]
    ds_read_b64_tr_b16 v[108:109], v119 offset:32768
    s_mov_b32 s3, 202752
    buffer_load_dwordx4 a[16:19], v120, s[4:7], s3 offen offset:0 sc1
    v_mfma_f32_16x16x32_bf16 v[40:43], v[80:83], a[36:39], v[40:43]
    ds_read_b64_tr_b16 v[110:111], v119 offset:36864
    v_mfma_f32_16x16x32_bf16 v[12:15], v[84:87], a[32:35], v[12:15]
    v_add_u32 v112, 40960, v112
    ds_read_b64_tr_b16 v[80:81], v112 offset:0
    buffer_load_dwordx4 a[20:23], v120, s[4:7], s3 offen offset:256 sc1
    v_mfma_f32_16x16x32_bf16 v[44:47], v[84:87], a[36:39], v[44:47]
    ds_read_b64_tr_b16 v[82:83], v112 offset:4096
    s_waitcnt lgkmcnt(10)
    v_mfma_f32_16x16x32_bf16 v[16:19], v[88:91], a[32:35], v[16:19]
    v_add_u32 v113, 40960, v113
    ds_read_b64_tr_b16 v[84:85], v113 offset:0
    s_mov_b32 s3, 221184
    buffer_load_dwordx4 a[24:27], v120, s[4:7], s3 offen offset:0 sc1
    v_mfma_f32_16x16x32_bf16 v[48:51], v[88:91], a[36:39], v[48:51]
    ds_read_b64_tr_b16 v[86:87], v113 offset:4096
    v_mfma_f32_16x16x32_bf16 v[20:23], v[92:95], a[32:35], v[20:23]
    v_add_u32 v114, 40960, v114
    ds_read_b64_tr_b16 v[88:89], v114 offset:0
    buffer_load_dwordx4 a[28:31], v120, s[4:7], s3 offen offset:256 sc1
    v_mfma_f32_16x16x32_bf16 v[52:55], v[92:95], a[36:39], v[52:55]
    ds_read_b64_tr_b16 v[90:91], v114 offset:4096
    s_waitcnt lgkmcnt(10)
    v_mfma_f32_16x16x32_bf16 v[24:27], v[96:99], a[32:35], v[24:27]
    v_add_u32 v115, 40960, v115
    ds_read_b64_tr_b16 v[92:93], v115 offset:0
    v_mfma_f32_16x16x32_bf16 v[56:59], v[96:99], a[36:39], v[56:59]
    ds_read_b64_tr_b16 v[94:95], v115 offset:4096
    v_mfma_f32_16x16x32_bf16 v[28:31], v[100:103], a[32:35], v[28:31]
    v_add_u32 v116, 40960, v116
    ds_read_b64_tr_b16 v[96:97], v116 offset:0
    v_mfma_f32_16x16x32_bf16 v[60:63], v[100:103], a[36:39], v[60:63]
    ds_read_b64_tr_b16 v[98:99], v116 offset:4096
    s_waitcnt lgkmcnt(10)
    v_mfma_f32_16x16x32_bf16 v[32:35], v[104:107], a[32:35], v[32:35]
    v_add_u32 v117, 40960, v117
    ds_read_b64_tr_b16 v[100:101], v117 offset:0
    v_mfma_f32_16x16x32_bf16 v[64:67], v[104:107], a[36:39], v[64:67]
    ds_read_b64_tr_b16 v[102:103], v117 offset:4096
    v_mfma_f32_16x16x32_bf16 v[36:39], v[108:111], a[32:35], v[36:39]
    v_add_u32 v118, 40960, v118
    ds_read_b64_tr_b16 v[104:105], v118 offset:0
    v_mfma_f32_16x16x32_bf16 v[68:71], v[108:111], a[36:39], v[68:71]
    ds_read_b64_tr_b16 v[106:107], v118 offset:4096
    s_waitcnt vmcnt(14)
    s_waitcnt lgkmcnt(10)
    v_mfma_f32_16x16x32_bf16 v[8:11], v[80:83], a[40:43], v[8:11]
    v_add_u32 v119, 40960, v119
    ds_read_b64_tr_b16 v[108:109], v119 offset:0
    s_mov_b32 s3, 239616
    buffer_load_dwordx4 a[32:35], v120, s[4:7], s3 offen offset:0 sc1
    v_mfma_f32_16x16x32_bf16 v[40:43], v[80:83], a[44:47], v[40:43]
    ds_read_b64_tr_b16 v[110:111], v119 offset:4096
    v_mfma_f32_16x16x32_bf16 v[12:15], v[84:87], a[40:43], v[12:15]
    ds_read_b64_tr_b16 v[80:81], v112 offset:8192
    buffer_load_dwordx4 a[36:39], v120, s[4:7], s3 offen offset:256 sc1
    v_mfma_f32_16x16x32_bf16 v[44:47], v[84:87], a[44:47], v[44:47]
    ds_read_b64_tr_b16 v[82:83], v112 offset:12288
    s_waitcnt lgkmcnt(10)
    v_mfma_f32_16x16x32_bf16 v[16:19], v[88:91], a[40:43], v[16:19]
    ds_read_b64_tr_b16 v[84:85], v113 offset:8192
    buffer_load_dword v3, v3, s[4:7], 0 offen offset:2560 sc1
    v_mfma_f32_16x16x32_bf16 v[48:51], v[88:91], a[44:47], v[48:51]
    ds_read_b64_tr_b16 v[86:87], v113 offset:12288
    v_mfma_f32_16x16x32_bf16 v[20:23], v[92:95], a[40:43], v[20:23]
    ds_read_b64_tr_b16 v[88:89], v114 offset:8192
    v_mfma_f32_16x16x32_bf16 v[52:55], v[92:95], a[44:47], v[52:55]
    ds_read_b64_tr_b16 v[90:91], v114 offset:12288
    s_waitcnt lgkmcnt(10)
    v_mfma_f32_16x16x32_bf16 v[24:27], v[96:99], a[40:43], v[24:27]
    ds_read_b64_tr_b16 v[92:93], v115 offset:8192
    v_mfma_f32_16x16x32_bf16 v[56:59], v[96:99], a[44:47], v[56:59]
    ds_read_b64_tr_b16 v[94:95], v115 offset:12288
    v_mfma_f32_16x16x32_bf16 v[28:31], v[100:103], a[40:43], v[28:31]
    ds_read_b64_tr_b16 v[96:97], v116 offset:8192
    v_mfma_f32_16x16x32_bf16 v[60:63], v[100:103], a[44:47], v[60:63]
    ds_read_b64_tr_b16 v[98:99], v116 offset:12288
    s_waitcnt lgkmcnt(10)
    v_mfma_f32_16x16x32_bf16 v[32:35], v[104:107], a[40:43], v[32:35]
    ds_read_b64_tr_b16 v[100:101], v117 offset:8192
    v_mfma_f32_16x16x32_bf16 v[64:67], v[104:107], a[44:47], v[64:67]
    ds_read_b64_tr_b16 v[102:103], v117 offset:12288
    v_mfma_f32_16x16x32_bf16 v[36:39], v[108:111], a[40:43], v[36:39]
    ds_read_b64_tr_b16 v[104:105], v118 offset:8192
    v_mfma_f32_16x16x32_bf16 v[68:71], v[108:111], a[44:47], v[68:71]
    ds_read_b64_tr_b16 v[106:107], v118 offset:12288
    s_waitcnt vmcnt(15)
    s_waitcnt lgkmcnt(10)
    v_mfma_f32_16x16x32_bf16 v[8:11], v[80:83], a[48:51], v[8:11]
    ds_read_b64_tr_b16 v[108:109], v119 offset:8192
    s_mov_b32 s3, 258048
    buffer_load_dwordx4 a[40:43], v120, s[4:7], s3 offen offset:0 sc1
    v_mfma_f32_16x16x32_bf16 v[40:43], v[80:83], a[52:55], v[40:43]
    ds_read_b64_tr_b16 v[110:111], v119 offset:12288
    v_mfma_f32_16x16x32_bf16 v[12:15], v[84:87], a[48:51], v[12:15]
    ds_read_b64_tr_b16 v[80:81], v112 offset:16384
    buffer_load_dwordx4 a[44:47], v120, s[4:7], s3 offen offset:256 sc1
    v_mfma_f32_16x16x32_bf16 v[44:47], v[84:87], a[52:55], v[44:47]
    ds_read_b64_tr_b16 v[82:83], v112 offset:20480
    s_waitcnt lgkmcnt(10)
    v_mfma_f32_16x16x32_bf16 v[16:19], v[88:91], a[48:51], v[16:19]
    ds_read_b64_tr_b16 v[84:85], v113 offset:16384
    v_mfma_f32_16x16x32_bf16 v[48:51], v[88:91], a[52:55], v[48:51]
    ds_read_b64_tr_b16 v[86:87], v113 offset:20480
    v_mfma_f32_16x16x32_bf16 v[20:23], v[92:95], a[48:51], v[20:23]
    ds_read_b64_tr_b16 v[88:89], v114 offset:16384
    v_mfma_f32_16x16x32_bf16 v[52:55], v[92:95], a[52:55], v[52:55]
    ds_read_b64_tr_b16 v[90:91], v114 offset:20480
    s_waitcnt lgkmcnt(10)
    v_mfma_f32_16x16x32_bf16 v[24:27], v[96:99], a[48:51], v[24:27]
    ds_read_b64_tr_b16 v[92:93], v115 offset:16384
    v_mfma_f32_16x16x32_bf16 v[56:59], v[96:99], a[52:55], v[56:59]
    ds_read_b64_tr_b16 v[94:95], v115 offset:20480
    v_mfma_f32_16x16x32_bf16 v[28:31], v[100:103], a[48:51], v[28:31]
    ds_read_b64_tr_b16 v[96:97], v116 offset:16384
    v_mfma_f32_16x16x32_bf16 v[60:63], v[100:103], a[52:55], v[60:63]
    ds_read_b64_tr_b16 v[98:99], v116 offset:20480
    s_waitcnt lgkmcnt(10)
    v_mfma_f32_16x16x32_bf16 v[32:35], v[104:107], a[48:51], v[32:35]
    ds_read_b64_tr_b16 v[100:101], v117 offset:16384
    v_mfma_f32_16x16x32_bf16 v[64:67], v[104:107], a[52:55], v[64:67]
    ds_read_b64_tr_b16 v[102:103], v117 offset:20480
    v_mfma_f32_16x16x32_bf16 v[36:39], v[108:111], a[48:51], v[36:39]
    ds_read_b64_tr_b16 v[104:105], v118 offset:16384
    v_mfma_f32_16x16x32_bf16 v[68:71], v[108:111], a[52:55], v[68:71]
    ds_read_b64_tr_b16 v[106:107], v118 offset:20480
    s_waitcnt vmcnt(15)
    s_waitcnt lgkmcnt(10)
    v_mfma_f32_16x16x32_bf16 v[8:11], v[80:83], a[56:59], v[8:11]
    ds_read_b64_tr_b16 v[108:109], v119 offset:16384
    s_mov_b32 s3, 276480
    buffer_load_dwordx4 a[48:51], v120, s[4:7], s3 offen offset:0 sc1
    v_mfma_f32_16x16x32_bf16 v[40:43], v[80:83], a[60:63], v[40:43]
    ds_read_b64_tr_b16 v[110:111], v119 offset:20480
    v_mfma_f32_16x16x32_bf16 v[12:15], v[84:87], a[56:59], v[12:15]
    ds_read_b64_tr_b16 v[80:81], v112 offset:24576
    buffer_load_dwordx4 a[52:55], v120, s[4:7], s3 offen offset:256 sc1
    v_mfma_f32_16x16x32_bf16 v[44:47], v[84:87], a[60:63], v[44:47]
    ds_read_b64_tr_b16 v[82:83], v112 offset:28672
    s_waitcnt lgkmcnt(10)
    v_mfma_f32_16x16x32_bf16 v[16:19], v[88:91], a[56:59], v[16:19]
    ds_read_b64_tr_b16 v[84:85], v113 offset:24576
    v_mfma_f32_16x16x32_bf16 v[48:51], v[88:91], a[60:63], v[48:51]
    ds_read_b64_tr_b16 v[86:87], v113 offset:28672
    v_mfma_f32_16x16x32_bf16 v[20:23], v[92:95], a[56:59], v[20:23]
    ds_read_b64_tr_b16 v[88:89], v114 offset:24576
    v_mfma_f32_16x16x32_bf16 v[52:55], v[92:95], a[60:63], v[52:55]
    ds_read_b64_tr_b16 v[90:91], v114 offset:28672
    s_waitcnt lgkmcnt(10)
    v_mfma_f32_16x16x32_bf16 v[24:27], v[96:99], a[56:59], v[24:27]
    ds_read_b64_tr_b16 v[92:93], v115 offset:24576
    v_mfma_f32_16x16x32_bf16 v[56:59], v[96:99], a[60:63], v[56:59]
    ds_read_b64_tr_b16 v[94:95], v115 offset:28672
    v_mfma_f32_16x16x32_bf16 v[28:31], v[100:103], a[56:59], v[28:31]
    ds_read_b64_tr_b16 v[96:97], v116 offset:24576
    v_mfma_f32_16x16x32_bf16 v[60:63], v[100:103], a[60:63], v[60:63]
    ds_read_b64_tr_b16 v[98:99], v116 offset:28672
    s_waitcnt lgkmcnt(10)
    v_mfma_f32_16x16x32_bf16 v[32:35], v[104:107], a[56:59], v[32:35]
    ds_read_b64_tr_b16 v[100:101], v117 offset:24576
    v_mfma_f32_16x16x32_bf16 v[64:67], v[104:107], a[60:63], v[64:67]
    ds_read_b64_tr_b16 v[102:103], v117 offset:28672
    v_mfma_f32_16x16x32_bf16 v[36:39], v[108:111], a[56:59], v[36:39]
    ds_read_b64_tr_b16 v[104:105], v118 offset:24576
    v_mfma_f32_16x16x32_bf16 v[68:71], v[108:111], a[60:63], v[68:71]
    ds_read_b64_tr_b16 v[106:107], v118 offset:28672
    s_waitcnt vmcnt(15)
    s_waitcnt lgkmcnt(10)
    v_mfma_f32_16x16x32_bf16 v[8:11], v[80:83], a[64:67], v[8:11]
    ds_read_b64_tr_b16 v[108:109], v119 offset:24576
    s_mov_b32 s3, 294912
    buffer_load_dwordx4 a[56:59], v120, s[4:7], s3 offen offset:0 sc1
    v_mfma_f32_16x16x32_bf16 v[40:43], v[80:83], a[68:71], v[40:43]
    ds_read_b64_tr_b16 v[110:111], v119 offset:28672
    v_mfma_f32_16x16x32_bf16 v[12:15], v[84:87], a[64:67], v[12:15]
    ds_read_b64_tr_b16 v[80:81], v112 offset:32768
    buffer_load_dwordx4 a[60:63], v120, s[4:7], s3 offen offset:256 sc1
    v_mfma_f32_16x16x32_bf16 v[44:47], v[84:87], a[68:71], v[44:47]
    ds_read_b64_tr_b16 v[82:83], v112 offset:36864
    s_waitcnt lgkmcnt(10)
    v_mfma_f32_16x16x32_bf16 v[16:19], v[88:91], a[64:67], v[16:19]
    ds_read_b64_tr_b16 v[84:85], v113 offset:32768
    s_mov_b32 s3, 331776
    buffer_load_dwordx4 a[72:75], v120, s[4:7], s3 offen offset:0 sc1
    v_mfma_f32_16x16x32_bf16 v[48:51], v[88:91], a[68:71], v[48:51]
    ds_read_b64_tr_b16 v[86:87], v113 offset:36864
    v_mfma_f32_16x16x32_bf16 v[20:23], v[92:95], a[64:67], v[20:23]
    ds_read_b64_tr_b16 v[88:89], v114 offset:32768
    buffer_load_dwordx4 a[76:79], v120, s[4:7], s3 offen offset:256 sc1
    v_mfma_f32_16x16x32_bf16 v[52:55], v[92:95], a[68:71], v[52:55]
    ds_read_b64_tr_b16 v[90:91], v114 offset:36864
    s_waitcnt lgkmcnt(10)
    v_mfma_f32_16x16x32_bf16 v[24:27], v[96:99], a[64:67], v[24:27]
    ds_read_b64_tr_b16 v[92:93], v115 offset:32768
    s_mov_b32 s3, 350208
    buffer_load_dwordx4 a[80:83], v120, s[4:7], s3 offen offset:0 sc1
    v_mfma_f32_16x16x32_bf16 v[56:59], v[96:99], a[68:71], v[56:59]
    ds_read_b64_tr_b16 v[94:95], v115 offset:36864
    v_mfma_f32_16x16x32_bf16 v[28:31], v[100:103], a[64:67], v[28:31]
    ds_read_b64_tr_b16 v[96:97], v116 offset:32768
    buffer_load_dwordx4 a[84:87], v120, s[4:7], s3 offen offset:256 sc1
    v_mfma_f32_16x16x32_bf16 v[60:63], v[100:103], a[68:71], v[60:63]
    ds_read_b64_tr_b16 v[98:99], v116 offset:36864
    s_waitcnt lgkmcnt(10)
    v_mfma_f32_16x16x32_bf16 v[32:35], v[104:107], a[64:67], v[32:35]
    ds_read_b64_tr_b16 v[100:101], v117 offset:32768
    v_mfma_f32_16x16x32_bf16 v[64:67], v[104:107], a[68:71], v[64:67]
    ds_read_b64_tr_b16 v[102:103], v117 offset:36864
    v_mfma_f32_16x16x32_bf16 v[36:39], v[108:111], a[64:67], v[36:39]
    ds_read_b64_tr_b16 v[104:105], v118 offset:32768
    v_mfma_f32_16x16x32_bf16 v[68:71], v[108:111], a[68:71], v[68:71]
    ds_read_b64_tr_b16 v[106:107], v118 offset:36864
    ds_read_b64_tr_b16 v[108:109], v119 offset:32768
    ds_read_b64_tr_b16 v[110:111], v119 offset:36864
    s_waitcnt vmcnt(19)
    s_mov_b32 s3, 313344
    buffer_load_dwordx4 a[64:67], v120, s[4:7], s3 offen offset:0 sc1
    buffer_load_dwordx4 a[68:71], v120, s[4:7], s3 offen offset:256 sc1
    s_waitcnt lgkmcnt(0)
    s_barrier
    s_waitcnt lgkmcnt(12)
    v_mfma_f32_16x16x32_bf16 v[8:11], v[80:83], a[0:3], v[8:11]
    v_mfma_f32_16x16x32_bf16 v[40:43], v[80:83], a[4:7], v[40:43]
    v_mfma_f32_16x16x32_bf16 v[12:15], v[84:87], a[0:3], v[12:15]
    v_add_u32 v112, 40960, v112
    ds_read_b64_tr_b16 v[80:81], v112 offset:0
    v_mfma_f32_16x16x32_bf16 v[44:47], v[84:87], a[4:7], v[44:47]
    ds_read_b64_tr_b16 v[82:83], v112 offset:4096
    s_waitcnt lgkmcnt(10)
    v_mfma_f32_16x16x32_bf16 v[16:19], v[88:91], a[0:3], v[16:19]
    v_add_u32 v113, 40960, v113
    ds_read_b64_tr_b16 v[84:85], v113 offset:0
    v_mfma_f32_16x16x32_bf16 v[48:51], v[88:91], a[4:7], v[48:51]
    ds_read_b64_tr_b16 v[86:87], v113 offset:4096
    v_mfma_f32_16x16x32_bf16 v[20:23], v[92:95], a[0:3], v[20:23]
    v_add_u32 v114, 40960, v114
    ds_read_b64_tr_b16 v[88:89], v114 offset:0
    v_mfma_f32_16x16x32_bf16 v[52:55], v[92:95], a[4:7], v[52:55]
    ds_read_b64_tr_b16 v[90:91], v114 offset:4096
    s_waitcnt lgkmcnt(10)
    v_mfma_f32_16x16x32_bf16 v[24:27], v[96:99], a[0:3], v[24:27]
    v_add_u32 v115, 40960, v115
    ds_read_b64_tr_b16 v[92:93], v115 offset:0
    v_mfma_f32_16x16x32_bf16 v[56:59], v[96:99], a[4:7], v[56:59]
    ds_read_b64_tr_b16 v[94:95], v115 offset:4096
    v_mfma_f32_16x16x32_bf16 v[28:31], v[100:103], a[0:3], v[28:31]
    v_add_u32 v116, 40960, v116
    ds_read_b64_tr_b16 v[96:97], v116 offset:0
    v_mfma_f32_16x16x32_bf16 v[60:63], v[100:103], a[4:7], v[60:63]
    ds_read_b64_tr_b16 v[98:99], v116 offset:4096
    s_waitcnt lgkmcnt(10)
    v_mfma_f32_16x16x32_bf16 v[32:35], v[104:107], a[0:3], v[32:35]
    v_add_u32 v117, 40960, v117
    ds_read_b64_tr_b16 v[100:101], v117 offset:0
    v_mfma_f32_16x16x32_bf16 v[64:67], v[104:107], a[4:7], v[64:67]
    ds_read_b64_tr_b16 v[102:103], v117 offset:4096
    v_mfma_f32_16x16x32_bf16 v[36:39], v[108:111], a[0:3], v[36:39]
    v_add_u32 v118, 40960, v118
    ds_read_b64_tr_b16 v[104:105], v118 offset:0
    v_mfma_f32_16x16x32_bf16 v[68:71], v[108:111], a[4:7], v[68:71]
    ds_read_b64_tr_b16 v[106:107], v118 offset:4096
    s_waitcnt vmcnt(19)
    s_waitcnt lgkmcnt(10)
    v_mfma_f32_16x16x32_bf16 v[8:11], v[80:83], a[8:11], v[8:11]
    v_add_u32 v119, 40960, v119
    ds_read_b64_tr_b16 v[108:109], v119 offset:0
    v_mfma_f32_16x16x32_bf16 v[40:43], v[80:83], a[12:15], v[40:43]
    ds_read_b64_tr_b16 v[110:111], v119 offset:4096
    v_mfma_f32_16x16x32_bf16 v[72:75], v[80:83], v[4:7], v[72:75]
    v_mfma_f32_16x16x32_bf16 v[12:15], v[84:87], a[8:11], v[12:15]
    ds_read_b64_tr_b16 v[80:81], v112 offset:8192
    v_mfma_f32_16x16x32_bf16 v[44:47], v[84:87], a[12:15], v[44:47]
    ds_read_b64_tr_b16 v[82:83], v112 offset:12288
    v_mfma_f32_16x16x32_bf16 v[76:79], v[84:87], v[4:7], v[76:79]
    s_waitcnt lgkmcnt(10)
    v_mfma_f32_16x16x32_bf16 v[16:19], v[88:91], a[8:11], v[16:19]
    ds_read_b64_tr_b16 v[84:85], v113 offset:8192
    v_mfma_f32_16x16x32_bf16 v[48:51], v[88:91], a[12:15], v[48:51]
    ds_read_b64_tr_b16 v[86:87], v113 offset:12288
    v_mfma_f32_16x16x32_bf16 v[20:23], v[92:95], a[8:11], v[20:23]
    ds_read_b64_tr_b16 v[88:89], v114 offset:8192
    v_mfma_f32_16x16x32_bf16 v[52:55], v[92:95], a[12:15], v[52:55]
    ds_read_b64_tr_b16 v[90:91], v114 offset:12288
    s_waitcnt lgkmcnt(10)
    v_mfma_f32_16x16x32_bf16 v[24:27], v[96:99], a[8:11], v[24:27]
    ds_read_b64_tr_b16 v[92:93], v115 offset:8192
    v_mfma_f32_16x16x32_bf16 v[56:59], v[96:99], a[12:15], v[56:59]
    ds_read_b64_tr_b16 v[94:95], v115 offset:12288
    v_mfma_f32_16x16x32_bf16 v[28:31], v[100:103], a[8:11], v[28:31]
    ds_read_b64_tr_b16 v[96:97], v116 offset:8192
    v_mfma_f32_16x16x32_bf16 v[60:63], v[100:103], a[12:15], v[60:63]
    ds_read_b64_tr_b16 v[98:99], v116 offset:12288
    s_waitcnt lgkmcnt(10)
    v_mfma_f32_16x16x32_bf16 v[32:35], v[104:107], a[8:11], v[32:35]
    ds_read_b64_tr_b16 v[100:101], v117 offset:8192
    v_mfma_f32_16x16x32_bf16 v[64:67], v[104:107], a[12:15], v[64:67]
    ds_read_b64_tr_b16 v[102:103], v117 offset:12288
    v_mfma_f32_16x16x32_bf16 v[36:39], v[108:111], a[8:11], v[36:39]
    ds_read_b64_tr_b16 v[104:105], v118 offset:8192
    v_mfma_f32_16x16x32_bf16 v[68:71], v[108:111], a[12:15], v[68:71]
    ds_read_b64_tr_b16 v[106:107], v118 offset:12288
    s_waitcnt vmcnt(17)
    s_waitcnt lgkmcnt(10)
    v_mfma_f32_16x16x32_bf16 v[8:11], v[80:83], a[16:19], v[8:11]
    ds_read_b64_tr_b16 v[108:109], v119 offset:8192
    v_mfma_f32_16x16x32_bf16 v[40:43], v[80:83], a[20:23], v[40:43]
    ds_read_b64_tr_b16 v[110:111], v119 offset:12288
    v_mfma_f32_16x16x32_bf16 v[72:75], v[80:83], v[4:7], v[72:75]
    v_mfma_f32_16x16x32_bf16 v[12:15], v[84:87], a[16:19], v[12:15]
    ds_read_b64_tr_b16 v[80:81], v112 offset:16384
    v_mfma_f32_16x16x32_bf16 v[44:47], v[84:87], a[20:23], v[44:47]
    ds_read_b64_tr_b16 v[82:83], v112 offset:20480
    v_mfma_f32_16x16x32_bf16 v[76:79], v[84:87], v[4:7], v[76:79]
    s_waitcnt lgkmcnt(10)
    v_mfma_f32_16x16x32_bf16 v[16:19], v[88:91], a[16:19], v[16:19]
    ds_read_b64_tr_b16 v[84:85], v113 offset:16384
    v_mfma_f32_16x16x32_bf16 v[48:51], v[88:91], a[20:23], v[48:51]
    ds_read_b64_tr_b16 v[86:87], v113 offset:20480
    v_mfma_f32_16x16x32_bf16 v[20:23], v[92:95], a[16:19], v[20:23]
    ds_read_b64_tr_b16 v[88:89], v114 offset:16384
    v_mfma_f32_16x16x32_bf16 v[52:55], v[92:95], a[20:23], v[52:55]
    ds_read_b64_tr_b16 v[90:91], v114 offset:20480
    s_waitcnt lgkmcnt(10)
    v_mfma_f32_16x16x32_bf16 v[24:27], v[96:99], a[16:19], v[24:27]
    ds_read_b64_tr_b16 v[92:93], v115 offset:16384
    v_mfma_f32_16x16x32_bf16 v[56:59], v[96:99], a[20:23], v[56:59]
    ds_read_b64_tr_b16 v[94:95], v115 offset:20480
    v_mfma_f32_16x16x32_bf16 v[28:31], v[100:103], a[16:19], v[28:31]
    ds_read_b64_tr_b16 v[96:97], v116 offset:16384
    v_mfma_f32_16x16x32_bf16 v[60:63], v[100:103], a[20:23], v[60:63]
    ds_read_b64_tr_b16 v[98:99], v116 offset:20480
    s_waitcnt lgkmcnt(10)
    v_mfma_f32_16x16x32_bf16 v[32:35], v[104:107], a[16:19], v[32:35]
    ds_read_b64_tr_b16 v[100:101], v117 offset:16384
    v_mfma_f32_16x16x32_bf16 v[64:67], v[104:107], a[20:23], v[64:67]
    ds_read_b64_tr_b16 v[102:103], v117 offset:20480
    v_mfma_f32_16x16x32_bf16 v[36:39], v[108:111], a[16:19], v[36:39]
    ds_read_b64_tr_b16 v[104:105], v118 offset:16384
    v_mfma_f32_16x16x32_bf16 v[68:71], v[108:111], a[20:23], v[68:71]
    ds_read_b64_tr_b16 v[106:107], v118 offset:20480
    s_waitcnt vmcnt(15)
    s_waitcnt lgkmcnt(10)
    v_mfma_f32_16x16x32_bf16 v[8:11], v[80:83], a[24:27], v[8:11]
    ds_read_b64_tr_b16 v[108:109], v119 offset:16384
    v_mfma_f32_16x16x32_bf16 v[40:43], v[80:83], a[28:31], v[40:43]
    ds_read_b64_tr_b16 v[110:111], v119 offset:20480
    v_mfma_f32_16x16x32_bf16 v[72:75], v[80:83], v[4:7], v[72:75]
    v_mfma_f32_16x16x32_bf16 v[12:15], v[84:87], a[24:27], v[12:15]
    ds_read_b64_tr_b16 v[80:81], v112 offset:24576
    v_mfma_f32_16x16x32_bf16 v[44:47], v[84:87], a[28:31], v[44:47]
    ds_read_b64_tr_b16 v[82:83], v112 offset:28672
    v_mfma_f32_16x16x32_bf16 v[76:79], v[84:87], v[4:7], v[76:79]
    s_waitcnt lgkmcnt(10)
    v_mfma_f32_16x16x32_bf16 v[16:19], v[88:91], a[24:27], v[16:19]
    ds_read_b64_tr_b16 v[84:85], v113 offset:24576
    v_mfma_f32_16x16x32_bf16 v[48:51], v[88:91], a[28:31], v[48:51]
    ds_read_b64_tr_b16 v[86:87], v113 offset:28672
    v_mfma_f32_16x16x32_bf16 v[20:23], v[92:95], a[24:27], v[20:23]
    ds_read_b64_tr_b16 v[88:89], v114 offset:24576
    v_mfma_f32_16x16x32_bf16 v[52:55], v[92:95], a[28:31], v[52:55]
    ds_read_b64_tr_b16 v[90:91], v114 offset:28672
    s_waitcnt lgkmcnt(10)
    v_mfma_f32_16x16x32_bf16 v[24:27], v[96:99], a[24:27], v[24:27]
    ds_read_b64_tr_b16 v[92:93], v115 offset:24576
    v_mfma_f32_16x16x32_bf16 v[56:59], v[96:99], a[28:31], v[56:59]
    ds_read_b64_tr_b16 v[94:95], v115 offset:28672
    v_mfma_f32_16x16x32_bf16 v[28:31], v[100:103], a[24:27], v[28:31]
    ds_read_b64_tr_b16 v[96:97], v116 offset:24576
    v_mfma_f32_16x16x32_bf16 v[60:63], v[100:103], a[28:31], v[60:63]
    ds_read_b64_tr_b16 v[98:99], v116 offset:28672
    s_waitcnt lgkmcnt(10)
    v_mfma_f32_16x16x32_bf16 v[32:35], v[104:107], a[24:27], v[32:35]
    ds_read_b64_tr_b16 v[100:101], v117 offset:24576
    v_mfma_f32_16x16x32_bf16 v[64:67], v[104:107], a[28:31], v[64:67]
    ds_read_b64_tr_b16 v[102:103], v117 offset:28672
    v_mfma_f32_16x16x32_bf16 v[36:39], v[108:111], a[24:27], v[36:39]
    ds_read_b64_tr_b16 v[104:105], v118 offset:24576
    v_mfma_f32_16x16x32_bf16 v[68:71], v[108:111], a[28:31], v[68:71]
    ds_read_b64_tr_b16 v[106:107], v118 offset:28672
    s_waitcnt vmcnt(13)
    s_waitcnt lgkmcnt(10)
    v_mfma_f32_16x16x32_bf16 v[8:11], v[80:83], a[32:35], v[8:11]
    ds_read_b64_tr_b16 v[108:109], v119 offset:24576
    v_mfma_f32_16x16x32_bf16 v[40:43], v[80:83], a[36:39], v[40:43]
    ds_read_b64_tr_b16 v[110:111], v119 offset:28672
    v_mfma_f32_16x16x32_bf16 v[72:75], v[80:83], v[4:7], v[72:75]
    v_mfma_f32_16x16x32_bf16 v[12:15], v[84:87], a[32:35], v[12:15]
    ds_read_b64_tr_b16 v[80:81], v112 offset:32768
    v_mfma_f32_16x16x32_bf16 v[44:47], v[84:87], a[36:39], v[44:47]
    ds_read_b64_tr_b16 v[82:83], v112 offset:36864
    v_mfma_f32_16x16x32_bf16 v[76:79], v[84:87], v[4:7], v[76:79]
    s_waitcnt lgkmcnt(10)
    v_mfma_f32_16x16x32_bf16 v[16:19], v[88:91], a[32:35], v[16:19]
    ds_read_b64_tr_b16 v[84:85], v113 offset:32768
    v_mfma_f32_16x16x32_bf16 v[48:51], v[88:91], a[36:39], v[48:51]
    ds_read_b64_tr_b16 v[86:87], v113 offset:36864
    v_mfma_f32_16x16x32_bf16 v[20:23], v[92:95], a[32:35], v[20:23]
    ds_read_b64_tr_b16 v[88:89], v114 offset:32768
    v_mfma_f32_16x16x32_bf16 v[52:55], v[92:95], a[36:39], v[52:55]
    ds_read_b64_tr_b16 v[90:91], v114 offset:36864
    s_waitcnt lgkmcnt(10)
    v_mfma_f32_16x16x32_bf16 v[24:27], v[96:99], a[32:35], v[24:27]
    ds_read_b64_tr_b16 v[92:93], v115 offset:32768
    v_mfma_f32_16x16x32_bf16 v[56:59], v[96:99], a[36:39], v[56:59]
    ds_read_b64_tr_b16 v[94:95], v115 offset:36864
    v_mfma_f32_16x16x32_bf16 v[28:31], v[100:103], a[32:35], v[28:31]
    ds_read_b64_tr_b16 v[96:97], v116 offset:32768
    v_mfma_f32_16x16x32_bf16 v[60:63], v[100:103], a[36:39], v[60:63]
    ds_read_b64_tr_b16 v[98:99], v116 offset:36864
    s_waitcnt lgkmcnt(10)
    v_mfma_f32_16x16x32_bf16 v[32:35], v[104:107], a[32:35], v[32:35]
    ds_read_b64_tr_b16 v[100:101], v117 offset:32768
    v_mfma_f32_16x16x32_bf16 v[64:67], v[104:107], a[36:39], v[64:67]
    ds_read_b64_tr_b16 v[102:103], v117 offset:36864
    v_mfma_f32_16x16x32_bf16 v[36:39], v[108:111], a[32:35], v[36:39]
    ds_read_b64_tr_b16 v[104:105], v118 offset:32768
    v_mfma_f32_16x16x32_bf16 v[68:71], v[108:111], a[36:39], v[68:71]
    ds_read_b64_tr_b16 v[106:107], v118 offset:36864
    s_waitcnt vmcnt(10)
    s_waitcnt lgkmcnt(10)
    v_mfma_f32_16x16x32_bf16 v[8:11], v[80:83], a[40:43], v[8:11]
    ds_read_b64_tr_b16 v[108:109], v119 offset:32768
    v_mfma_f32_16x16x32_bf16 v[40:43], v[80:83], a[44:47], v[40:43]
    ds_read_b64_tr_b16 v[110:111], v119 offset:36864
    v_mfma_f32_16x16x32_bf16 v[72:75], v[80:83], v[4:7], v[72:75]
    v_mfma_f32_16x16x32_bf16 v[12:15], v[84:87], a[40:43], v[12:15]
    v_add_u32 v112, 40960, v112
    ds_read_b64_tr_b16 v[80:81], v112 offset:0
    v_mfma_f32_16x16x32_bf16 v[44:47], v[84:87], a[44:47], v[44:47]
    ds_read_b64_tr_b16 v[82:83], v112 offset:4096
    v_mfma_f32_16x16x32_bf16 v[76:79], v[84:87], v[4:7], v[76:79]
    s_waitcnt lgkmcnt(10)
    v_mfma_f32_16x16x32_bf16 v[16:19], v[88:91], a[40:43], v[16:19]
    v_add_u32 v113, 40960, v113
    ds_read_b64_tr_b16 v[84:85], v113 offset:0
    v_mfma_f32_16x16x32_bf16 v[48:51], v[88:91], a[44:47], v[48:51]
    ds_read_b64_tr_b16 v[86:87], v113 offset:4096
    v_mfma_f32_16x16x32_bf16 v[20:23], v[92:95], a[40:43], v[20:23]
    v_add_u32 v114, 40960, v114
    ds_read_b64_tr_b16 v[88:89], v114 offset:0
    v_mfma_f32_16x16x32_bf16 v[52:55], v[92:95], a[44:47], v[52:55]
    ds_read_b64_tr_b16 v[90:91], v114 offset:4096
    s_waitcnt lgkmcnt(10)
    v_mfma_f32_16x16x32_bf16 v[24:27], v[96:99], a[40:43], v[24:27]
    v_add_u32 v115, 40960, v115
    ds_read_b64_tr_b16 v[92:93], v115 offset:0
    v_mfma_f32_16x16x32_bf16 v[56:59], v[96:99], a[44:47], v[56:59]
    ds_read_b64_tr_b16 v[94:95], v115 offset:4096
    v_mfma_f32_16x16x32_bf16 v[28:31], v[100:103], a[40:43], v[28:31]
    v_add_u32 v116, 40960, v116
    ds_read_b64_tr_b16 v[96:97], v116 offset:0
    v_mfma_f32_16x16x32_bf16 v[60:63], v[100:103], a[44:47], v[60:63]
    ds_read_b64_tr_b16 v[98:99], v116 offset:4096
    s_waitcnt lgkmcnt(10)
    v_mfma_f32_16x16x32_bf16 v[32:35], v[104:107], a[40:43], v[32:35]
    v_add_u32 v117, 40960, v117
    ds_read_b64_tr_b16 v[100:101], v117 offset:0
    v_mfma_f32_16x16x32_bf16 v[64:67], v[104:107], a[44:47], v[64:67]
    ds_read_b64_tr_b16 v[102:103], v117 offset:4096
    v_mfma_f32_16x16x32_bf16 v[36:39], v[108:111], a[40:43], v[36:39]
    v_add_u32 v118, 40960, v118
    ds_read_b64_tr_b16 v[104:105], v118 offset:0
    v_mfma_f32_16x16x32_bf16 v[68:71], v[108:111], a[44:47], v[68:71]
    ds_read_b64_tr_b16 v[106:107], v118 offset:4096
    s_waitcnt vmcnt(8)
    s_waitcnt lgkmcnt(10)
    v_mfma_f32_16x16x32_bf16 v[8:11], v[80:83], a[48:51], v[8:11]
    v_add_u32 v119, 40960, v119
    ds_read_b64_tr_b16 v[108:109], v119 offset:0
    v_mfma_f32_16x16x32_bf16 v[40:43], v[80:83], a[52:55], v[40:43]
    ds_read_b64_tr_b16 v[110:111], v119 offset:4096
    v_mfma_f32_16x16x32_bf16 v[72:75], v[80:83], v[4:7], v[72:75]
    v_mfma_f32_16x16x32_bf16 v[12:15], v[84:87], a[48:51], v[12:15]
    ds_read_b64_tr_b16 v[80:81], v112 offset:8192
    v_mfma_f32_16x16x32_bf16 v[44:47], v[84:87], a[52:55], v[44:47]
    ds_read_b64_tr_b16 v[82:83], v112 offset:12288
    v_mfma_f32_16x16x32_bf16 v[76:79], v[84:87], v[4:7], v[76:79]
    s_waitcnt lgkmcnt(10)
    v_mfma_f32_16x16x32_bf16 v[16:19], v[88:91], a[48:51], v[16:19]
    ds_read_b64_tr_b16 v[84:85], v113 offset:8192
    v_mfma_f32_16x16x32_bf16 v[48:51], v[88:91], a[52:55], v[48:51]
    ds_read_b64_tr_b16 v[86:87], v113 offset:12288
    v_mfma_f32_16x16x32_bf16 v[20:23], v[92:95], a[48:51], v[20:23]
    ds_read_b64_tr_b16 v[88:89], v114 offset:8192
    v_mfma_f32_16x16x32_bf16 v[52:55], v[92:95], a[52:55], v[52:55]
    ds_read_b64_tr_b16 v[90:91], v114 offset:12288
    s_waitcnt lgkmcnt(10)
    v_mfma_f32_16x16x32_bf16 v[24:27], v[96:99], a[48:51], v[24:27]
    ds_read_b64_tr_b16 v[92:93], v115 offset:8192
    v_mfma_f32_16x16x32_bf16 v[56:59], v[96:99], a[52:55], v[56:59]
    ds_read_b64_tr_b16 v[94:95], v115 offset:12288
    v_mfma_f32_16x16x32_bf16 v[28:31], v[100:103], a[48:51], v[28:31]
    ds_read_b64_tr_b16 v[96:97], v116 offset:8192
    v_mfma_f32_16x16x32_bf16 v[60:63], v[100:103], a[52:55], v[60:63]
    ds_read_b64_tr_b16 v[98:99], v116 offset:12288
    s_waitcnt lgkmcnt(10)
    v_mfma_f32_16x16x32_bf16 v[32:35], v[104:107], a[48:51], v[32:35]
    ds_read_b64_tr_b16 v[100:101], v117 offset:8192
    v_mfma_f32_16x16x32_bf16 v[64:67], v[104:107], a[52:55], v[64:67]
    ds_read_b64_tr_b16 v[102:103], v117 offset:12288
    v_mfma_f32_16x16x32_bf16 v[36:39], v[108:111], a[48:51], v[36:39]
    ds_read_b64_tr_b16 v[104:105], v118 offset:8192
    v_mfma_f32_16x16x32_bf16 v[68:71], v[108:111], a[52:55], v[68:71]
    ds_read_b64_tr_b16 v[106:107], v118 offset:12288
    s_waitcnt vmcnt(6)
    s_waitcnt lgkmcnt(10)
    v_mfma_f32_16x16x32_bf16 v[8:11], v[80:83], a[56:59], v[8:11]
    ds_read_b64_tr_b16 v[108:109], v119 offset:8192
    v_mfma_f32_16x16x32_bf16 v[40:43], v[80:83], a[60:63], v[40:43]
    ds_read_b64_tr_b16 v[110:111], v119 offset:12288
    v_mfma_f32_16x16x32_bf16 v[72:75], v[80:83], v[4:7], v[72:75]
    v_mfma_f32_16x16x32_bf16 v[12:15], v[84:87], a[56:59], v[12:15]
    ds_read_b64_tr_b16 v[80:81], v112 offset:16384
    v_mfma_f32_16x16x32_bf16 v[44:47], v[84:87], a[60:63], v[44:47]
    ds_read_b64_tr_b16 v[82:83], v112 offset:20480
    v_mfma_f32_16x16x32_bf16 v[76:79], v[84:87], v[4:7], v[76:79]
    s_waitcnt lgkmcnt(10)
    v_mfma_f32_16x16x32_bf16 v[16:19], v[88:91], a[56:59], v[16:19]
    ds_read_b64_tr_b16 v[84:85], v113 offset:16384
    v_mfma_f32_16x16x32_bf16 v[48:51], v[88:91], a[60:63], v[48:51]
    ds_read_b64_tr_b16 v[86:87], v113 offset:20480
    v_mfma_f32_16x16x32_bf16 v[20:23], v[92:95], a[56:59], v[20:23]
    ds_read_b64_tr_b16 v[88:89], v114 offset:16384
    v_mfma_f32_16x16x32_bf16 v[52:55], v[92:95], a[60:63], v[52:55]
    ds_read_b64_tr_b16 v[90:91], v114 offset:20480
    s_waitcnt lgkmcnt(10)
    v_mfma_f32_16x16x32_bf16 v[24:27], v[96:99], a[56:59], v[24:27]
    ds_read_b64_tr_b16 v[92:93], v115 offset:16384
    v_mfma_f32_16x16x32_bf16 v[56:59], v[96:99], a[60:63], v[56:59]
    ds_read_b64_tr_b16 v[94:95], v115 offset:20480
    v_mfma_f32_16x16x32_bf16 v[28:31], v[100:103], a[56:59], v[28:31]
    ds_read_b64_tr_b16 v[96:97], v116 offset:16384
    v_mfma_f32_16x16x32_bf16 v[60:63], v[100:103], a[60:63], v[60:63]
    ds_read_b64_tr_b16 v[98:99], v116 offset:20480
    s_waitcnt lgkmcnt(10)
    v_mfma_f32_16x16x32_bf16 v[32:35], v[104:107], a[56:59], v[32:35]
    ds_read_b64_tr_b16 v[100:101], v117 offset:16384
    v_mfma_f32_16x16x32_bf16 v[64:67], v[104:107], a[60:63], v[64:67]
    ds_read_b64_tr_b16 v[102:103], v117 offset:20480
    v_mfma_f32_16x16x32_bf16 v[36:39], v[108:111], a[56:59], v[36:39]
    ds_read_b64_tr_b16 v[104:105], v118 offset:16384
    v_mfma_f32_16x16x32_bf16 v[68:71], v[108:111], a[60:63], v[68:71]
    ds_read_b64_tr_b16 v[106:107], v118 offset:20480
    s_waitcnt vmcnt(0)
    s_waitcnt lgkmcnt(10)
    v_mfma_f32_16x16x32_bf16 v[8:11], v[80:83], a[64:67], v[8:11]
    ds_read_b64_tr_b16 v[108:109], v119 offset:16384
    v_mfma_f32_16x16x32_bf16 v[40:43], v[80:83], a[68:71], v[40:43]
    ds_read_b64_tr_b16 v[110:111], v119 offset:20480
    v_mfma_f32_16x16x32_bf16 v[72:75], v[80:83], v[4:7], v[72:75]
    v_mfma_f32_16x16x32_bf16 v[12:15], v[84:87], a[64:67], v[12:15]
    ds_read_b64_tr_b16 v[80:81], v112 offset:24576
    v_mfma_f32_16x16x32_bf16 v[44:47], v[84:87], a[68:71], v[44:47]
    ds_read_b64_tr_b16 v[82:83], v112 offset:28672
    v_mfma_f32_16x16x32_bf16 v[76:79], v[84:87], v[4:7], v[76:79]
    s_waitcnt lgkmcnt(10)
    v_mfma_f32_16x16x32_bf16 v[16:19], v[88:91], a[64:67], v[16:19]
    ds_read_b64_tr_b16 v[84:85], v113 offset:24576
    v_mfma_f32_16x16x32_bf16 v[48:51], v[88:91], a[68:71], v[48:51]
    ds_read_b64_tr_b16 v[86:87], v113 offset:28672
    v_mfma_f32_16x16x32_bf16 v[20:23], v[92:95], a[64:67], v[20:23]
    ds_read_b64_tr_b16 v[88:89], v114 offset:24576
    v_mfma_f32_16x16x32_bf16 v[52:55], v[92:95], a[68:71], v[52:55]
    ds_read_b64_tr_b16 v[90:91], v114 offset:28672
    s_waitcnt lgkmcnt(10)
    v_mfma_f32_16x16x32_bf16 v[24:27], v[96:99], a[64:67], v[24:27]
    ds_read_b64_tr_b16 v[92:93], v115 offset:24576
    v_mfma_f32_16x16x32_bf16 v[56:59], v[96:99], a[68:71], v[56:59]
    ds_read_b64_tr_b16 v[94:95], v115 offset:28672
    v_mfma_f32_16x16x32_bf16 v[28:31], v[100:103], a[64:67], v[28:31]
    ds_read_b64_tr_b16 v[96:97], v116 offset:24576
    v_mfma_f32_16x16x32_bf16 v[60:63], v[100:103], a[68:71], v[60:63]
    ds_read_b64_tr_b16 v[98:99], v116 offset:28672
    s_waitcnt lgkmcnt(10)
    v_mfma_f32_16x16x32_bf16 v[32:35], v[104:107], a[64:67], v[32:35]
    ds_read_b64_tr_b16 v[100:101], v117 offset:24576
    v_mfma_f32_16x16x32_bf16 v[64:67], v[104:107], a[68:71], v[64:67]
    ds_read_b64_tr_b16 v[102:103], v117 offset:28672
    v_mfma_f32_16x16x32_bf16 v[36:39], v[108:111], a[64:67], v[36:39]
    ds_read_b64_tr_b16 v[104:105], v118 offset:24576
    v_mfma_f32_16x16x32_bf16 v[68:71], v[108:111], a[68:71], v[68:71]
    ds_read_b64_tr_b16 v[106:107], v118 offset:28672
    s_waitcnt vmcnt(4)
    s_waitcnt lgkmcnt(10)
    v_mfma_f32_16x16x32_bf16 v[8:11], v[80:83], a[72:75], v[8:11]
    ds_read_b64_tr_b16 v[108:109], v119 offset:24576
    v_mfma_f32_16x16x32_bf16 v[40:43], v[80:83], a[76:79], v[40:43]
    ds_read_b64_tr_b16 v[110:111], v119 offset:28672
    v_mfma_f32_16x16x32_bf16 v[72:75], v[80:83], v[4:7], v[72:75]
    v_mfma_f32_16x16x32_bf16 v[12:15], v[84:87], a[72:75], v[12:15]
    ds_read_b64_tr_b16 v[80:81], v112 offset:32768
    v_mfma_f32_16x16x32_bf16 v[44:47], v[84:87], a[76:79], v[44:47]
    ds_read_b64_tr_b16 v[82:83], v112 offset:36864
    v_mfma_f32_16x16x32_bf16 v[76:79], v[84:87], v[4:7], v[76:79]
    s_waitcnt lgkmcnt(10)
    v_mfma_f32_16x16x32_bf16 v[16:19], v[88:91], a[72:75], v[16:19]
    ds_read_b64_tr_b16 v[84:85], v113 offset:32768
    v_mfma_f32_16x16x32_bf16 v[48:51], v[88:91], a[76:79], v[48:51]
    ds_read_b64_tr_b16 v[86:87], v113 offset:36864
    v_mfma_f32_16x16x32_bf16 v[20:23], v[92:95], a[72:75], v[20:23]
    ds_read_b64_tr_b16 v[88:89], v114 offset:32768
    v_mfma_f32_16x16x32_bf16 v[52:55], v[92:95], a[76:79], v[52:55]
    ds_read_b64_tr_b16 v[90:91], v114 offset:36864
    s_waitcnt lgkmcnt(10)
    v_mfma_f32_16x16x32_bf16 v[24:27], v[96:99], a[72:75], v[24:27]
    ds_read_b64_tr_b16 v[92:93], v115 offset:32768
    v_mfma_f32_16x16x32_bf16 v[56:59], v[96:99], a[76:79], v[56:59]
    ds_read_b64_tr_b16 v[94:95], v115 offset:36864
    v_mfma_f32_16x16x32_bf16 v[28:31], v[100:103], a[72:75], v[28:31]
    ds_read_b64_tr_b16 v[96:97], v116 offset:32768
    v_mfma_f32_16x16x32_bf16 v[60:63], v[100:103], a[76:79], v[60:63]
    ds_read_b64_tr_b16 v[98:99], v116 offset:36864
    s_waitcnt lgkmcnt(10)
    v_mfma_f32_16x16x32_bf16 v[32:35], v[104:107], a[72:75], v[32:35]
    ds_read_b64_tr_b16 v[100:101], v117 offset:32768
    v_mfma_f32_16x16x32_bf16 v[64:67], v[104:107], a[76:79], v[64:67]
    ds_read_b64_tr_b16 v[102:103], v117 offset:36864
    v_mfma_f32_16x16x32_bf16 v[36:39], v[108:111], a[72:75], v[36:39]
    ds_read_b64_tr_b16 v[104:105], v118 offset:32768
    v_mfma_f32_16x16x32_bf16 v[68:71], v[108:111], a[76:79], v[68:71]
    ds_read_b64_tr_b16 v[106:107], v118 offset:36864
    s_waitcnt vmcnt(2)
    s_waitcnt lgkmcnt(10)
    v_mfma_f32_16x16x32_bf16 v[8:11], v[80:83], a[80:83], v[8:11]
    ds_read_b64_tr_b16 v[108:109], v119 offset:32768
    v_mfma_f32_16x16x32_bf16 v[40:43], v[80:83], a[84:87], v[40:43]
    ds_read_b64_tr_b16 v[110:111], v119 offset:36864
    v_mfma_f32_16x16x32_bf16 v[72:75], v[80:83], v[4:7], v[72:75]
    v_mfma_f32_16x16x32_bf16 v[12:15], v[84:87], a[80:83], v[12:15]
    v_mfma_f32_16x16x32_bf16 v[44:47], v[84:87], a[84:87], v[44:47]
    v_mfma_f32_16x16x32_bf16 v[76:79], v[84:87], v[4:7], v[76:79]
    s_waitcnt lgkmcnt(8)
    v_mfma_f32_16x16x32_bf16 v[16:19], v[88:91], a[80:83], v[16:19]
    v_mfma_f32_16x16x32_bf16 v[48:51], v[88:91], a[84:87], v[48:51]
    v_mfma_f32_16x16x32_bf16 v[20:23], v[92:95], a[80:83], v[20:23]
    v_mfma_f32_16x16x32_bf16 v[52:55], v[92:95], a[84:87], v[52:55]
    s_waitcnt lgkmcnt(4)
    v_mfma_f32_16x16x32_bf16 v[24:27], v[96:99], a[80:83], v[24:27]
    v_mfma_f32_16x16x32_bf16 v[56:59], v[96:99], a[84:87], v[56:59]
    v_mfma_f32_16x16x32_bf16 v[28:31], v[100:103], a[80:83], v[28:31]
    v_mfma_f32_16x16x32_bf16 v[60:63], v[100:103], a[84:87], v[60:63]
    s_waitcnt lgkmcnt(0)
    v_mfma_f32_16x16x32_bf16 v[32:35], v[104:107], a[80:83], v[32:35]
    v_mfma_f32_16x16x32_bf16 v[64:67], v[104:107], a[84:87], v[64:67]
    v_mfma_f32_16x16x32_bf16 v[36:39], v[108:111], a[80:83], v[36:39]
    v_mfma_f32_16x16x32_bf16 v[68:71], v[108:111], a[84:87], v[68:71]
    s_lshl_b32 s3, s40, 7
    s_add_u32 s3, s3, 139264
    v_lshl_add_u32 v112, v1, 4, s3
    s_xor_b32 s3, s40, 0
    s_lshl_b32 s3, s3, 7
    s_add_u32 s3, s3, 139264
    v_lshl_add_u32 v113, v1, 4, s3
    s_xor_b32 s3, s40, 1
    s_lshl_b32 s3, s3, 7
    s_add_u32 s3, s3, 139264
    v_lshl_add_u32 v114, v1, 4, s3
    s_xor_b32 s3, s40, 2
    s_lshl_b32 s3, s3, 7
    s_add_u32 s3, s3, 139264
    v_lshl_add_u32 v115, v1, 4, s3
    s_xor_b32 s3, s40, 3
    s_lshl_b32 s3, s3, 7
    s_add_u32 s3, s3, 139264
    v_lshl_add_u32 v116, v1, 4, s3
    s_lshl_b32 s3, s40, 9
    s_add_u32 s3, s3, 140288
    v_lshl_add_u32 v117, v2, 4, s3
    v_mov_b32 v118, v121
    s_barrier
    ds_write_b128 v112, v[72:75]
    ds_write_b128 v112, v[76:79] offset:64
    s_waitcnt lgkmcnt(0)
    s_barrier
    ds_read_b128 v[120:123], v117
    ds_read_b128 v[124:127], v117 offset:256
    ds_read_b128 v[80:83], v113
    ds_read_b128 v[84:87], v113 offset:64
    ds_read_b128 v[88:91], v114
    ds_read_b128 v[92:95], v114 offset:64
    ds_read_b128 v[96:99], v115
    ds_read_b128 v[100:103], v115 offset:64
    ds_read_b128 v[104:107], v116
    ds_read_b128 v[108:111], v116 offset:64
    s_waitcnt lgkmcnt(0)
    s_barrier
    v_pk_fma_f32 v[8:9], v[80:81], v[122:123], v[8:9] op_sel:[0,1,0] op_sel_hi:[1,1,1] neg_lo:[0,1,0] neg_hi:[0,1,0]
    v_pk_fma_f32 v[10:11], v[82:83], v[122:123], v[10:11] op_sel:[0,1,0] op_sel_hi:[1,1,1] neg_lo:[0,1,0] neg_hi:[0,1,0]
    v_pk_fma_f32 v[12:13], v[84:85], v[122:123], v[12:13] op_sel:[0,1,0] op_sel_hi:[1,1,1] neg_lo:[0,1,0] neg_hi:[0,1,0]
    v_pk_fma_f32 v[14:15], v[86:87], v[122:123], v[14:15] op_sel:[0,1,0] op_sel_hi:[1,1,1] neg_lo:[0,1,0] neg_hi:[0,1,0]
    v_pk_fma_f32 v[40:41], v[80:81], v[126:127], v[40:41] op_sel:[0,1,0] op_sel_hi:[1,1,1] neg_lo:[0,1,0] neg_hi:[0,1,0]
    v_pk_fma_f32 v[42:43], v[82:83], v[126:127], v[42:43] op_sel:[0,1,0] op_sel_hi:[1,1,1] neg_lo:[0,1,0] neg_hi:[0,1,0]
    v_pk_fma_f32 v[44:45], v[84:85], v[126:127], v[44:45] op_sel:[0,1,0] op_sel_hi:[1,1,1] neg_lo:[0,1,0] neg_hi:[0,1,0]
    v_pk_fma_f32 v[46:47], v[86:87], v[126:127], v[46:47] op_sel:[0,1,0] op_sel_hi:[1,1,1] neg_lo:[0,1,0] neg_hi:[0,1,0]
    v_pk_mul_f32 v[72:73], v[8:9], v[8:9]
    v_pk_mul_f32 v[74:75], v[10:11], v[10:11]
    v_pk_mul_f32 v[76:77], v[12:13], v[12:13]
    v_pk_mul_f32 v[78:79], v[14:15], v[14:15]
    v_pk_fma_f32 v[72:73], v[72:73], v[120:121], v[120:121] op_sel:[0,0,1] op_sel_hi:[1,0,1]
    v_pk_fma_f32 v[74:75], v[74:75], v[120:121], v[120:121] op_sel:[0,0,1] op_sel_hi:[1,0,1]
    v_pk_fma_f32 v[76:77], v[76:77], v[120:121], v[120:121] op_sel:[0,0,1] op_sel_hi:[1,0,1]
    v_pk_fma_f32 v[78:79], v[78:79], v[120:121], v[120:121] op_sel:[0,0,1] op_sel_hi:[1,0,1]
    v_pk_mul_f32 v[72:73], v[72:73], v[8:9]
    v_pk_mul_f32 v[74:75], v[74:75], v[10:11]
    v_pk_mul_f32 v[76:77], v[76:77], v[12:13]
    v_pk_mul_f32 v[78:79], v[78:79], v[14:15]
    v_exp_f32 v72, v72
    v_exp_f32 v73, v73
    v_exp_f32 v74, v74
    v_exp_f32 v75, v75
    v_exp_f32 v76, v76
    v_exp_f32 v77, v77
    v_exp_f32 v78, v78
    v_exp_f32 v79, v79
    v_pk_fma_f32 v[72:73], v[72:73], v[122:123], v[122:123] op_sel:[0,0,0] op_sel_hi:[1,0,0]
    v_pk_fma_f32 v[74:75], v[74:75], v[122:123], v[122:123] op_sel:[0,0,0] op_sel_hi:[1,0,0]
    v_pk_fma_f32 v[76:77], v[76:77], v[122:123], v[122:123] op_sel:[0,0,0] op_sel_hi:[1,0,0]
    v_pk_fma_f32 v[78:79], v[78:79], v[122:123], v[122:123] op_sel:[0,0,0] op_sel_hi:[1,0,0]
    v_rcp_f32 v72, v72
    v_rcp_f32 v73, v73
    v_rcp_f32 v74, v74
    v_rcp_f32 v75, v75
    v_rcp_f32 v76, v76
    v_rcp_f32 v77, v77
    v_rcp_f32 v78, v78
    v_rcp_f32 v79, v79
    v_pk_mul_f32 v[8:9], v[8:9], v[72:73]
    v_pk_mul_f32 v[10:11], v[10:11], v[74:75]
    v_pk_mul_f32 v[12:13], v[12:13], v[76:77]
    v_pk_mul_f32 v[14:15], v[14:15], v[78:79]
    v_cvt_pk_bf16_f32 v8, v8, v9
    v_cvt_pk_bf16_f32 v9, v10, v11
    v_cvt_pk_bf16_f32 v10, v12, v13
    v_cvt_pk_bf16_f32 v11, v14, v15
    v_pk_mul_f32 v[72:73], v[40:41], v[40:41]
    v_pk_mul_f32 v[74:75], v[42:43], v[42:43]
    v_pk_mul_f32 v[76:77], v[44:45], v[44:45]
    v_pk_mul_f32 v[78:79], v[46:47], v[46:47]
    v_pk_fma_f32 v[72:73], v[72:73], v[124:125], v[124:125] op_sel:[0,0,1] op_sel_hi:[1,0,1]
    v_pk_fma_f32 v[74:75], v[74:75], v[124:125], v[124:125] op_sel:[0,0,1] op_sel_hi:[1,0,1]
    v_pk_fma_f32 v[76:77], v[76:77], v[124:125], v[124:125] op_sel:[0,0,1] op_sel_hi:[1,0,1]
    v_pk_fma_f32 v[78:79], v[78:79], v[124:125], v[124:125] op_sel:[0,0,1] op_sel_hi:[1,0,1]
    v_pk_mul_f32 v[72:73], v[72:73], v[40:41]
    v_pk_mul_f32 v[74:75], v[74:75], v[42:43]
    v_pk_mul_f32 v[76:77], v[76:77], v[44:45]
    v_pk_mul_f32 v[78:79], v[78:79], v[46:47]
    v_exp_f32 v72, v72
    v_exp_f32 v73, v73
    v_exp_f32 v74, v74
    v_exp_f32 v75, v75
    v_exp_f32 v76, v76
    v_exp_f32 v77, v77
    v_exp_f32 v78, v78
    v_exp_f32 v79, v79
    v_pk_fma_f32 v[72:73], v[72:73], v[126:127], v[126:127] op_sel:[0,0,0] op_sel_hi:[1,0,0]
    v_pk_fma_f32 v[74:75], v[74:75], v[126:127], v[126:127] op_sel:[0,0,0] op_sel_hi:[1,0,0]
    v_pk_fma_f32 v[76:77], v[76:77], v[126:127], v[126:127] op_sel:[0,0,0] op_sel_hi:[1,0,0]
    v_pk_fma_f32 v[78:79], v[78:79], v[126:127], v[126:127] op_sel:[0,0,0] op_sel_hi:[1,0,0]
    v_rcp_f32 v72, v72
    v_rcp_f32 v73, v73
    v_rcp_f32 v74, v74
    v_rcp_f32 v75, v75
    v_rcp_f32 v76, v76
    v_rcp_f32 v77, v77
    v_rcp_f32 v78, v78
    v_rcp_f32 v79, v79
    v_pk_mul_f32 v[40:41], v[40:41], v[72:73]
    v_pk_mul_f32 v[42:43], v[42:43], v[74:75]
    v_pk_mul_f32 v[44:45], v[44:45], v[76:77]
    v_pk_mul_f32 v[46:47], v[46:47], v[78:79]
    v_cvt_pk_bf16_f32 v40, v40, v41
    v_cvt_pk_bf16_f32 v41, v42, v43
    v_cvt_pk_bf16_f32 v42, v44, v45
    v_cvt_pk_bf16_f32 v43, v46, v47
    s_xor_b32 s3, s40, 0
    s_mul_i32 s3, s3, 18432
    buffer_store_dwordx4 v[8:11], v118, s[4:7], s3 offen offset:0 sc1
    buffer_store_dwordx4 v[40:43], v118, s[4:7], s3 offen offset:256 sc1
    v_pk_fma_f32 v[16:17], v[88:89], v[122:123], v[16:17] op_sel:[0,1,0] op_sel_hi:[1,1,1] neg_lo:[0,1,0] neg_hi:[0,1,0]
    v_pk_fma_f32 v[18:19], v[90:91], v[122:123], v[18:19] op_sel:[0,1,0] op_sel_hi:[1,1,1] neg_lo:[0,1,0] neg_hi:[0,1,0]
    v_pk_fma_f32 v[20:21], v[92:93], v[122:123], v[20:21] op_sel:[0,1,0] op_sel_hi:[1,1,1] neg_lo:[0,1,0] neg_hi:[0,1,0]
    v_pk_fma_f32 v[22:23], v[94:95], v[122:123], v[22:23] op_sel:[0,1,0] op_sel_hi:[1,1,1] neg_lo:[0,1,0] neg_hi:[0,1,0]
    v_pk_fma_f32 v[48:49], v[88:89], v[126:127], v[48:49] op_sel:[0,1,0] op_sel_hi:[1,1,1] neg_lo:[0,1,0] neg_hi:[0,1,0]
    v_pk_fma_f32 v[50:51], v[90:91], v[126:127], v[50:51] op_sel:[0,1,0] op_sel_hi:[1,1,1] neg_lo:[0,1,0] neg_hi:[0,1,0]
    v_pk_fma_f32 v[52:53], v[92:93], v[126:127], v[52:53] op_sel:[0,1,0] op_sel_hi:[1,1,1] neg_lo:[0,1,0] neg_hi:[0,1,0]
    v_pk_fma_f32 v[54:55], v[94:95], v[126:127], v[54:55] op_sel:[0,1,0] op_sel_hi:[1,1,1] neg_lo:[0,1,0] neg_hi:[0,1,0]
    v_pk_mul_f32 v[72:73], v[16:17], v[16:17]
    v_pk_mul_f32 v[74:75], v[18:19], v[18:19]
    v_pk_mul_f32 v[76:77], v[20:21], v[20:21]
    v_pk_mul_f32 v[78:79], v[22:23], v[22:23]
    v_pk_fma_f32 v[72:73], v[72:73], v[120:121], v[120:121] op_sel:[0,0,1] op_sel_hi:[1,0,1]
    v_pk_fma_f32 v[74:75], v[74:75], v[120:121], v[120:121] op_sel:[0,0,1] op_sel_hi:[1,0,1]
    v_pk_fma_f32 v[76:77], v[76:77], v[120:121], v[120:121] op_sel:[0,0,1] op_sel_hi:[1,0,1]
    v_pk_fma_f32 v[78:79], v[78:79], v[120:121], v[120:121] op_sel:[0,0,1] op_sel_hi:[1,0,1]
    v_pk_mul_f32 v[72:73], v[72:73], v[16:17]
    v_pk_mul_f32 v[74:75], v[74:75], v[18:19]
    v_pk_mul_f32 v[76:77], v[76:77], v[20:21]
    v_pk_mul_f32 v[78:79], v[78:79], v[22:23]
    v_exp_f32 v72, v72
    v_exp_f32 v73, v73
    v_exp_f32 v74, v74
    v_exp_f32 v75, v75
    v_exp_f32 v76, v76
    v_exp_f32 v77, v77
    v_exp_f32 v78, v78
    v_exp_f32 v79, v79
    v_pk_fma_f32 v[72:73], v[72:73], v[122:123], v[122:123] op_sel:[0,0,0] op_sel_hi:[1,0,0]
    v_pk_fma_f32 v[74:75], v[74:75], v[122:123], v[122:123] op_sel:[0,0,0] op_sel_hi:[1,0,0]
    v_pk_fma_f32 v[76:77], v[76:77], v[122:123], v[122:123] op_sel:[0,0,0] op_sel_hi:[1,0,0]
    v_pk_fma_f32 v[78:79], v[78:79], v[122:123], v[122:123] op_sel:[0,0,0] op_sel_hi:[1,0,0]
    v_rcp_f32 v72, v72
    v_rcp_f32 v73, v73
    v_rcp_f32 v74, v74
    v_rcp_f32 v75, v75
    v_rcp_f32 v76, v76
    v_rcp_f32 v77, v77
    v_rcp_f32 v78, v78
    v_rcp_f32 v79, v79
    v_pk_mul_f32 v[16:17], v[16:17], v[72:73]
    v_pk_mul_f32 v[18:19], v[18:19], v[74:75]
    v_pk_mul_f32 v[20:21], v[20:21], v[76:77]
    v_pk_mul_f32 v[22:23], v[22:23], v[78:79]
    v_cvt_pk_bf16_f32 v16, v16, v17
    v_cvt_pk_bf16_f32 v17, v18, v19
    v_cvt_pk_bf16_f32 v18, v20, v21
    v_cvt_pk_bf16_f32 v19, v22, v23
    v_pk_mul_f32 v[72:73], v[48:49], v[48:49]
    v_pk_mul_f32 v[74:75], v[50:51], v[50:51]
    v_pk_mul_f32 v[76:77], v[52:53], v[52:53]
    v_pk_mul_f32 v[78:79], v[54:55], v[54:55]
    v_pk_fma_f32 v[72:73], v[72:73], v[124:125], v[124:125] op_sel:[0,0,1] op_sel_hi:[1,0,1]
    v_pk_fma_f32 v[74:75], v[74:75], v[124:125], v[124:125] op_sel:[0,0,1] op_sel_hi:[1,0,1]
    v_pk_fma_f32 v[76:77], v[76:77], v[124:125], v[124:125] op_sel:[0,0,1] op_sel_hi:[1,0,1]
    v_pk_fma_f32 v[78:79], v[78:79], v[124:125], v[124:125] op_sel:[0,0,1] op_sel_hi:[1,0,1]
    v_pk_mul_f32 v[72:73], v[72:73], v[48:49]
    v_pk_mul_f32 v[74:75], v[74:75], v[50:51]
    v_pk_mul_f32 v[76:77], v[76:77], v[52:53]
    v_pk_mul_f32 v[78:79], v[78:79], v[54:55]
    v_exp_f32 v72, v72
    v_exp_f32 v73, v73
    v_exp_f32 v74, v74
    v_exp_f32 v75, v75
    v_exp_f32 v76, v76
    v_exp_f32 v77, v77
    v_exp_f32 v78, v78
    v_exp_f32 v79, v79
    v_pk_fma_f32 v[72:73], v[72:73], v[126:127], v[126:127] op_sel:[0,0,0] op_sel_hi:[1,0,0]
    v_pk_fma_f32 v[74:75], v[74:75], v[126:127], v[126:127] op_sel:[0,0,0] op_sel_hi:[1,0,0]
    v_pk_fma_f32 v[76:77], v[76:77], v[126:127], v[126:127] op_sel:[0,0,0] op_sel_hi:[1,0,0]
    v_pk_fma_f32 v[78:79], v[78:79], v[126:127], v[126:127] op_sel:[0,0,0] op_sel_hi:[1,0,0]
    v_rcp_f32 v72, v72
    v_rcp_f32 v73, v73
    v_rcp_f32 v74, v74
    v_rcp_f32 v75, v75
    v_rcp_f32 v76, v76
    v_rcp_f32 v77, v77
    v_rcp_f32 v78, v78
    v_rcp_f32 v79, v79
    v_pk_mul_f32 v[48:49], v[48:49], v[72:73]
    v_pk_mul_f32 v[50:51], v[50:51], v[74:75]
    v_pk_mul_f32 v[52:53], v[52:53], v[76:77]
    v_pk_mul_f32 v[54:55], v[54:55], v[78:79]
    v_cvt_pk_bf16_f32 v48, v48, v49
    v_cvt_pk_bf16_f32 v49, v50, v51
    v_cvt_pk_bf16_f32 v50, v52, v53
    v_cvt_pk_bf16_f32 v51, v54, v55
    s_xor_b32 s3, s40, 1
    s_mul_i32 s3, s3, 18432
    buffer_store_dwordx4 v[16:19], v118, s[4:7], s3 offen offset:0 sc1
    buffer_store_dwordx4 v[48:51], v118, s[4:7], s3 offen offset:256 sc1
    v_pk_fma_f32 v[24:25], v[96:97], v[122:123], v[24:25] op_sel:[0,1,0] op_sel_hi:[1,1,1] neg_lo:[0,1,0] neg_hi:[0,1,0]
    v_pk_fma_f32 v[26:27], v[98:99], v[122:123], v[26:27] op_sel:[0,1,0] op_sel_hi:[1,1,1] neg_lo:[0,1,0] neg_hi:[0,1,0]
    v_pk_fma_f32 v[28:29], v[100:101], v[122:123], v[28:29] op_sel:[0,1,0] op_sel_hi:[1,1,1] neg_lo:[0,1,0] neg_hi:[0,1,0]
    v_pk_fma_f32 v[30:31], v[102:103], v[122:123], v[30:31] op_sel:[0,1,0] op_sel_hi:[1,1,1] neg_lo:[0,1,0] neg_hi:[0,1,0]
    v_pk_fma_f32 v[56:57], v[96:97], v[126:127], v[56:57] op_sel:[0,1,0] op_sel_hi:[1,1,1] neg_lo:[0,1,0] neg_hi:[0,1,0]
    v_pk_fma_f32 v[58:59], v[98:99], v[126:127], v[58:59] op_sel:[0,1,0] op_sel_hi:[1,1,1] neg_lo:[0,1,0] neg_hi:[0,1,0]
    v_pk_fma_f32 v[60:61], v[100:101], v[126:127], v[60:61] op_sel:[0,1,0] op_sel_hi:[1,1,1] neg_lo:[0,1,0] neg_hi:[0,1,0]
    v_pk_fma_f32 v[62:63], v[102:103], v[126:127], v[62:63] op_sel:[0,1,0] op_sel_hi:[1,1,1] neg_lo:[0,1,0] neg_hi:[0,1,0]
    v_pk_mul_f32 v[72:73], v[24:25], v[24:25]
    v_pk_mul_f32 v[74:75], v[26:27], v[26:27]
    v_pk_mul_f32 v[76:77], v[28:29], v[28:29]
    v_pk_mul_f32 v[78:79], v[30:31], v[30:31]
    v_pk_fma_f32 v[72:73], v[72:73], v[120:121], v[120:121] op_sel:[0,0,1] op_sel_hi:[1,0,1]
    v_pk_fma_f32 v[74:75], v[74:75], v[120:121], v[120:121] op_sel:[0,0,1] op_sel_hi:[1,0,1]
    v_pk_fma_f32 v[76:77], v[76:77], v[120:121], v[120:121] op_sel:[0,0,1] op_sel_hi:[1,0,1]
    v_pk_fma_f32 v[78:79], v[78:79], v[120:121], v[120:121] op_sel:[0,0,1] op_sel_hi:[1,0,1]
    v_pk_mul_f32 v[72:73], v[72:73], v[24:25]
    v_pk_mul_f32 v[74:75], v[74:75], v[26:27]
    v_pk_mul_f32 v[76:77], v[76:77], v[28:29]
    v_pk_mul_f32 v[78:79], v[78:79], v[30:31]
    v_exp_f32 v72, v72
    v_exp_f32 v73, v73
    v_exp_f32 v74, v74
    v_exp_f32 v75, v75
    v_exp_f32 v76, v76
    v_exp_f32 v77, v77
    v_exp_f32 v78, v78
    v_exp_f32 v79, v79
    v_pk_fma_f32 v[72:73], v[72:73], v[122:123], v[122:123] op_sel:[0,0,0] op_sel_hi:[1,0,0]
    v_pk_fma_f32 v[74:75], v[74:75], v[122:123], v[122:123] op_sel:[0,0,0] op_sel_hi:[1,0,0]
    v_pk_fma_f32 v[76:77], v[76:77], v[122:123], v[122:123] op_sel:[0,0,0] op_sel_hi:[1,0,0]
    v_pk_fma_f32 v[78:79], v[78:79], v[122:123], v[122:123] op_sel:[0,0,0] op_sel_hi:[1,0,0]
    v_rcp_f32 v72, v72
    v_rcp_f32 v73, v73
    v_rcp_f32 v74, v74
    v_rcp_f32 v75, v75
    v_rcp_f32 v76, v76
    v_rcp_f32 v77, v77
    v_rcp_f32 v78, v78
    v_rcp_f32 v79, v79
    v_pk_mul_f32 v[24:25], v[24:25], v[72:73]
    v_pk_mul_f32 v[26:27], v[26:27], v[74:75]
    v_pk_mul_f32 v[28:29], v[28:29], v[76:77]
    v_pk_mul_f32 v[30:31], v[30:31], v[78:79]
    v_cvt_pk_bf16_f32 v24, v24, v25
    v_cvt_pk_bf16_f32 v25, v26, v27
    v_cvt_pk_bf16_f32 v26, v28, v29
    v_cvt_pk_bf16_f32 v27, v30, v31
    v_pk_mul_f32 v[72:73], v[56:57], v[56:57]
    v_pk_mul_f32 v[74:75], v[58:59], v[58:59]
    v_pk_mul_f32 v[76:77], v[60:61], v[60:61]
    v_pk_mul_f32 v[78:79], v[62:63], v[62:63]
    v_pk_fma_f32 v[72:73], v[72:73], v[124:125], v[124:125] op_sel:[0,0,1] op_sel_hi:[1,0,1]
    v_pk_fma_f32 v[74:75], v[74:75], v[124:125], v[124:125] op_sel:[0,0,1] op_sel_hi:[1,0,1]
    v_pk_fma_f32 v[76:77], v[76:77], v[124:125], v[124:125] op_sel:[0,0,1] op_sel_hi:[1,0,1]
    v_pk_fma_f32 v[78:79], v[78:79], v[124:125], v[124:125] op_sel:[0,0,1] op_sel_hi:[1,0,1]
    v_pk_mul_f32 v[72:73], v[72:73], v[56:57]
    v_pk_mul_f32 v[74:75], v[74:75], v[58:59]
    v_pk_mul_f32 v[76:77], v[76:77], v[60:61]
    v_pk_mul_f32 v[78:79], v[78:79], v[62:63]
    v_exp_f32 v72, v72
    v_exp_f32 v73, v73
    v_exp_f32 v74, v74
    v_exp_f32 v75, v75
    v_exp_f32 v76, v76
    v_exp_f32 v77, v77
    v_exp_f32 v78, v78
    v_exp_f32 v79, v79
    v_pk_fma_f32 v[72:73], v[72:73], v[126:127], v[126:127] op_sel:[0,0,0] op_sel_hi:[1,0,0]
    v_pk_fma_f32 v[74:75], v[74:75], v[126:127], v[126:127] op_sel:[0,0,0] op_sel_hi:[1,0,0]
    v_pk_fma_f32 v[76:77], v[76:77], v[126:127], v[126:127] op_sel:[0,0,0] op_sel_hi:[1,0,0]
    v_pk_fma_f32 v[78:79], v[78:79], v[126:127], v[126:127] op_sel:[0,0,0] op_sel_hi:[1,0,0]
    v_rcp_f32 v72, v72
    v_rcp_f32 v73, v73
    v_rcp_f32 v74, v74
    v_rcp_f32 v75, v75
    v_rcp_f32 v76, v76
    v_rcp_f32 v77, v77
    v_rcp_f32 v78, v78
    v_rcp_f32 v79, v79
    v_pk_mul_f32 v[56:57], v[56:57], v[72:73]
    v_pk_mul_f32 v[58:59], v[58:59], v[74:75]
    v_pk_mul_f32 v[60:61], v[60:61], v[76:77]
    v_pk_mul_f32 v[62:63], v[62:63], v[78:79]
    v_cvt_pk_bf16_f32 v56, v56, v57
    v_cvt_pk_bf16_f32 v57, v58, v59
    v_cvt_pk_bf16_f32 v58, v60, v61
    v_cvt_pk_bf16_f32 v59, v62, v63
    s_xor_b32 s3, s40, 2
    s_mul_i32 s3, s3, 18432
    buffer_store_dwordx4 v[24:27], v118, s[4:7], s3 offen offset:0 sc1
    buffer_store_dwordx4 v[56:59], v118, s[4:7], s3 offen offset:256 sc1
    v_pk_fma_f32 v[32:33], v[104:105], v[122:123], v[32:33] op_sel:[0,1,0] op_sel_hi:[1,1,1] neg_lo:[0,1,0] neg_hi:[0,1,0]
    v_pk_fma_f32 v[34:35], v[106:107], v[122:123], v[34:35] op_sel:[0,1,0] op_sel_hi:[1,1,1] neg_lo:[0,1,0] neg_hi:[0,1,0]
    v_pk_fma_f32 v[36:37], v[108:109], v[122:123], v[36:37] op_sel:[0,1,0] op_sel_hi:[1,1,1] neg_lo:[0,1,0] neg_hi:[0,1,0]
    v_pk_fma_f32 v[38:39], v[110:111], v[122:123], v[38:39] op_sel:[0,1,0] op_sel_hi:[1,1,1] neg_lo:[0,1,0] neg_hi:[0,1,0]
    v_pk_fma_f32 v[64:65], v[104:105], v[126:127], v[64:65] op_sel:[0,1,0] op_sel_hi:[1,1,1] neg_lo:[0,1,0] neg_hi:[0,1,0]
    v_pk_fma_f32 v[66:67], v[106:107], v[126:127], v[66:67] op_sel:[0,1,0] op_sel_hi:[1,1,1] neg_lo:[0,1,0] neg_hi:[0,1,0]
    v_pk_fma_f32 v[68:69], v[108:109], v[126:127], v[68:69] op_sel:[0,1,0] op_sel_hi:[1,1,1] neg_lo:[0,1,0] neg_hi:[0,1,0]
    v_pk_fma_f32 v[70:71], v[110:111], v[126:127], v[70:71] op_sel:[0,1,0] op_sel_hi:[1,1,1] neg_lo:[0,1,0] neg_hi:[0,1,0]
    v_pk_mul_f32 v[72:73], v[32:33], v[32:33]
    v_pk_mul_f32 v[74:75], v[34:35], v[34:35]
    v_pk_mul_f32 v[76:77], v[36:37], v[36:37]
    v_pk_mul_f32 v[78:79], v[38:39], v[38:39]
    v_pk_fma_f32 v[72:73], v[72:73], v[120:121], v[120:121] op_sel:[0,0,1] op_sel_hi:[1,0,1]
    v_pk_fma_f32 v[74:75], v[74:75], v[120:121], v[120:121] op_sel:[0,0,1] op_sel_hi:[1,0,1]
    v_pk_fma_f32 v[76:77], v[76:77], v[120:121], v[120:121] op_sel:[0,0,1] op_sel_hi:[1,0,1]
    v_pk_fma_f32 v[78:79], v[78:79], v[120:121], v[120:121] op_sel:[0,0,1] op_sel_hi:[1,0,1]
    v_pk_mul_f32 v[72:73], v[72:73], v[32:33]
    v_pk_mul_f32 v[74:75], v[74:75], v[34:35]
    v_pk_mul_f32 v[76:77], v[76:77], v[36:37]
    v_pk_mul_f32 v[78:79], v[78:79], v[38:39]
    v_exp_f32 v72, v72
    v_exp_f32 v73, v73
    v_exp_f32 v74, v74
    v_exp_f32 v75, v75
    v_exp_f32 v76, v76
    v_exp_f32 v77, v77
    v_exp_f32 v78, v78
    v_exp_f32 v79, v79
    v_pk_fma_f32 v[72:73], v[72:73], v[122:123], v[122:123] op_sel:[0,0,0] op_sel_hi:[1,0,0]
    v_pk_fma_f32 v[74:75], v[74:75], v[122:123], v[122:123] op_sel:[0,0,0] op_sel_hi:[1,0,0]
    v_pk_fma_f32 v[76:77], v[76:77], v[122:123], v[122:123] op_sel:[0,0,0] op_sel_hi:[1,0,0]
    v_pk_fma_f32 v[78:79], v[78:79], v[122:123], v[122:123] op_sel:[0,0,0] op_sel_hi:[1,0,0]
    v_rcp_f32 v72, v72
    v_rcp_f32 v73, v73
    v_rcp_f32 v74, v74
    v_rcp_f32 v75, v75
    v_rcp_f32 v76, v76
    v_rcp_f32 v77, v77
    v_rcp_f32 v78, v78
    v_rcp_f32 v79, v79
    v_pk_mul_f32 v[32:33], v[32:33], v[72:73]
    v_pk_mul_f32 v[34:35], v[34:35], v[74:75]
    v_pk_mul_f32 v[36:37], v[36:37], v[76:77]
    v_pk_mul_f32 v[38:39], v[38:39], v[78:79]
    v_cvt_pk_bf16_f32 v32, v32, v33
    v_cvt_pk_bf16_f32 v33, v34, v35
    v_cvt_pk_bf16_f32 v34, v36, v37
    v_cvt_pk_bf16_f32 v35, v38, v39
    v_pk_mul_f32 v[72:73], v[64:65], v[64:65]
    v_pk_mul_f32 v[74:75], v[66:67], v[66:67]
    v_pk_mul_f32 v[76:77], v[68:69], v[68:69]
    v_pk_mul_f32 v[78:79], v[70:71], v[70:71]
    v_pk_fma_f32 v[72:73], v[72:73], v[124:125], v[124:125] op_sel:[0,0,1] op_sel_hi:[1,0,1]
    v_pk_fma_f32 v[74:75], v[74:75], v[124:125], v[124:125] op_sel:[0,0,1] op_sel_hi:[1,0,1]
    v_pk_fma_f32 v[76:77], v[76:77], v[124:125], v[124:125] op_sel:[0,0,1] op_sel_hi:[1,0,1]
    v_pk_fma_f32 v[78:79], v[78:79], v[124:125], v[124:125] op_sel:[0,0,1] op_sel_hi:[1,0,1]
    v_pk_mul_f32 v[72:73], v[72:73], v[64:65]
    v_pk_mul_f32 v[74:75], v[74:75], v[66:67]
    v_pk_mul_f32 v[76:77], v[76:77], v[68:69]
    v_pk_mul_f32 v[78:79], v[78:79], v[70:71]
    v_exp_f32 v72, v72
    v_exp_f32 v73, v73
    v_exp_f32 v74, v74
    v_exp_f32 v75, v75
    v_exp_f32 v76, v76
    v_exp_f32 v77, v77
    v_exp_f32 v78, v78
    v_exp_f32 v79, v79
    v_pk_fma_f32 v[72:73], v[72:73], v[126:127], v[126:127] op_sel:[0,0,0] op_sel_hi:[1,0,0]
    v_pk_fma_f32 v[74:75], v[74:75], v[126:127], v[126:127] op_sel:[0,0,0] op_sel_hi:[1,0,0]
    v_pk_fma_f32 v[76:77], v[76:77], v[126:127], v[126:127] op_sel:[0,0,0] op_sel_hi:[1,0,0]
    v_pk_fma_f32 v[78:79], v[78:79], v[126:127], v[126:127] op_sel:[0,0,0] op_sel_hi:[1,0,0]
    v_rcp_f32 v72, v72
    v_rcp_f32 v73, v73
    v_rcp_f32 v74, v74
    v_rcp_f32 v75, v75
    v_rcp_f32 v76, v76
    v_rcp_f32 v77, v77
    v_rcp_f32 v78, v78
    v_rcp_f32 v79, v79
    v_pk_mul_f32 v[64:65], v[64:65], v[72:73]
    v_pk_mul_f32 v[66:67], v[66:67], v[74:75]
    v_pk_mul_f32 v[68:69], v[68:69], v[76:77]
    v_pk_mul_f32 v[70:71], v[70:71], v[78:79]
    v_cvt_pk_bf16_f32 v64, v64, v65
    v_cvt_pk_bf16_f32 v65, v66, v67
    v_cvt_pk_bf16_f32 v66, v68, v69
    v_cvt_pk_bf16_f32 v67, v70, v71
    s_xor_b32 s3, s40, 3
    s_mul_i32 s3, s3, 18432
    buffer_store_dwordx4 v[32:35], v118, s[4:7], s3 offen offset:0 sc1
    buffer_store_dwordx4 v[64:67], v118, s[4:7], s3 offen offset:256 sc1
    v_mov_b32 v3, 1
    s_mov_b64 exec, 1
    s_cmp_eq_u32 s50, 0
    s_cbranch_scc0 L_pf_80
    s_waitcnt vmcnt(0)
    buffer_store_dword v3, v135, s[4:7], 0 offen offset:2560
    s_branch L_pg_81
L_pf_80:
    s_waitcnt vmcnt(0)
    buffer_wbl2 sc1
    s_waitcnt vmcnt(0)
    buffer_store_dword v3, v135, s[4:7], 0 offen offset:2560 sc1
L_pg_81:
    s_mov_b64 exec, -1
L_p7:
    s_mul_i32 s3, s46, 40960
    s_add_u32 s3, s3, 0
    v_add_u32 v88, s3, v134
    v_xor_b32 v89, 32, v88
    v_xor_b32 v90, 64, v88
    v_xor_b32 v91, 96, v88
    s_lshl_b32 s3, s57, 8
    s_add_u32 s3, s3, 1048576
    v_add_u32 v92, s3, v132
    s_cmp_eq_u32 s55, 0
    s_cselect_b32 s3, 0, 1073741824
    v_add_u32 v131, s3, v92
    s_mul_i32 s3, s40, 6144
    s_add_u32 s3, s3, 139264
    v_lshl_add_u32 v93, v0, 4, s3
    s_xor_b32 s52, s40, 1
    s_mul_i32 s3, s52, 6144
    s_add_u32 s3, s3, 139264
    v_lshl_add_u32 v94, v0, 4, s3
    s_mov_b32 s8, s32
    s_mov_b32 s9, s33
    s_mov_b32 s10, 2621440
    s_mov_b32 s11, 0x20000
    s_lshl_b32 s3, s57, 4
    s_lshl_b32 s52, s38, 8
    s_add_u32 s3, s3, s52
    v_add_u32 v97, s3, v2
    v_mul_u32_u24 v97, 1280, v97
    v_add_u32 v96, v133, v97
    s_mov_b32 s59, 4294873088
    s_cmp_eq_u32 s46, 0
    s_cmov_b32 s59, 4294885376
    v_pk_mov_b32 v[8:9], v[136:137], v[136:137] op_sel:[0,1]
    v_pk_mov_b32 v[10:11], v[138:139], v[138:139] op_sel:[0,1]
    v_pk_mov_b32 v[12:13], v[140:141], v[140:141] op_sel:[0,1]
    v_pk_mov_b32 v[14:15], v[142:143], v[142:143] op_sel:[0,1]
    v_pk_mov_b32 v[24:25], v[144:145], v[144:145] op_sel:[0,1]
    v_pk_mov_b32 v[26:27], v[146:147], v[146:147] op_sel:[0,1]
    v_pk_mov_b32 v[28:29], v[148:149], v[148:149] op_sel:[0,1]
    v_pk_mov_b32 v[30:31], v[150:151], v[150:151] op_sel:[0,1]
    v_pk_mov_b32 v[40:41], v[152:153], v[152:153] op_sel:[0,1]
    v_pk_mov_b32 v[42:43], v[154:155], v[154:155] op_sel:[0,1]
    v_pk_mov_b32 v[44:45], v[156:157], v[156:157] op_sel:[0,1]
    v_pk_mov_b32 v[46:47], v[158:159], v[158:159] op_sel:[0,1]
    s_cmp_eq_u32 s43, 2
    s_cselect_b32 s31, 14, 0
    s_cmp_eq_u32 s43, 1
    s_cselect_b32 s30, 28, 14
    s_mov_b32 s62, 400000
    v_lshlrev_b32 v3, 3, v0
    s_lshl_b32 s3, s31, 1
    s_lshl_b32 s52, s30, 1
    s_bfm_b64 exec, s52, s3
L_po_82:
    buffer_load_dwordx2 v[126:127], v3, s[4:7], 0 offen offset:2560 sc1
    s_waitcnt vmcnt(0)
    v_and_b32 v126, v126, v127
    v_cmp_eq_u32 vcc, 0, v126
    s_cbranch_vccz L_pp_83
    s_sub_u32 s62, s62, 1
    s_cbranch_scc0 L_po_82
    s_endpgm
L_pp_83:
    s_mov_b64 exec, -1
    s_cmp_eq_u32 s50, 0
    s_cbranch_scc1 L_pq_84
    buffer_inv sc1
    s_waitcnt vmcnt(0)
L_pq_84:
    s_add_u32 s3, s61, 0
    buffer_load_dwordx4 a[0:3], v131, s[4:7], s3 offen offset:0 sc1
    buffer_load_dwordx4 a[4:7], v92, s[4:7], s3 offen offset:256 sc1
    buffer_load_dwordx4 a[8:11], v92, s[4:7], s3 offen offset:512 sc1
    s_add_u32 s3, s61, 18432
    buffer_load_dwordx4 a[12:15], v131, s[4:7], s3 offen offset:0 sc1
    buffer_load_dwordx4 a[16:19], v92, s[4:7], s3 offen offset:256 sc1
    buffer_load_dwordx4 a[20:23], v92, s[4:7], s3 offen offset:512 sc1
    s_add_u32 s3, s61, 36864
    buffer_load_dwordx4 a[24:27], v131, s[4:7], s3 offen offset:0 sc1
    buffer_load_dwordx4 a[28:31], v92, s[4:7], s3 offen offset:256 sc1
    buffer_load_dwordx4 a[32:35], v92, s[4:7], s3 offen offset:512 sc1
    s_add_u32 s3, s61, 55296
    buffer_load_dwordx4 a[36:39], v131, s[4:7], s3 offen offset:0 sc1
    buffer_load_dwordx4 a[40:43], v92, s[4:7], s3 offen offset:256 sc1
    buffer_load_dwordx4 a[44:47], v92, s[4:7], s3 offen offset:512 sc1
    ds_read_b64_tr_b16 v[56:57], v88 offset:0
    ds_read_b64_tr_b16 v[58:59], v88 offset:2048
    ds_read_b64_tr_b16 v[60:61], v89 offset:0
    ds_read_b64_tr_b16 v[62:63], v89 offset:2048
    ds_read_b64_tr_b16 v[64:65], v90 offset:0
    ds_read_b64_tr_b16 v[66:67], v90 offset:2048
    ds_read_b64_tr_b16 v[68:69], v91 offset:0
    ds_read_b64_tr_b16 v[70:71], v91 offset:2048
    s_waitcnt vmcnt(9) lgkmcnt(0)
    v_mfma_f32_16x16x32_bf16 v[8:11], v[56:59], a[0:3], v[8:11]
    s_add_u32 s3, s61, 73728
    buffer_load_dwordx4 a[48:51], v131, s[4:7], s3 offen offset:0 sc1
    v_mfma_f32_16x16x32_bf16 v[24:27], v[56:59], a[4:7], v[24:27]
    ds_read_b64_tr_b16 v[72:73], v88 offset:4096
    v_mfma_f32_16x16x32_bf16 v[40:43], v[56:59], a[8:11], v[40:43]
    ds_read_b64_tr_b16 v[74:75], v88 offset:6144
    v_mfma_f32_16x16x32_bf16 v[12:15], v[60:63], a[0:3], v[12:15]
    ds_read_b64_tr_b16 v[76:77], v89 offset:4096
    v_mfma_f32_16x16x32_bf16 v[28:31], v[60:63], a[4:7], v[28:31]
    buffer_load_dwordx4 a[52:55], v92, s[4:7], s3 offen offset:256 sc1
    v_mfma_f32_16x16x32_bf16 v[44:47], v[60:63], a[8:11], v[44:47]
    ds_read_b64_tr_b16 v[78:79], v89 offset:6144
    v_mfma_f32_16x16x32_bf16 v[16:19], v[64:67], a[0:3], 0
    ds_read_b64_tr_b16 v[80:81], v90 offset:4096
    v_mfma_f32_16x16x32_bf16 v[32:35], v[64:67], a[4:7], 0
    ds_read_b64_tr_b16 v[82:83], v90 offset:6144
    v_mfma_f32_16x16x32_bf16 v[48:51], v[64:67], a[8:11], 0
    buffer_load_dwordx4 a[56:59], v92, s[4:7], s3 offen offset:512 sc1
    v_mfma_f32_16x16x32_bf16 v[20:23], v[68:71], a[0:3], 0
    ds_read_b64_tr_b16 v[84:85], v91 offset:4096
    v_mfma_f32_16x16x32_bf16 v[36:39], v[68:71], a[4:7], 0
    ds_read_b64_tr_b16 v[86:87], v91 offset:6144
    v_mfma_f32_16x16x32_bf16 v[52:55], v[68:71], a[8:11], 0
    s_waitcnt vmcnt(9) lgkmcnt(0)
    v_mfma_f32_16x16x32_bf16 v[8:11], v[72:75], a[12:15], v[8:11]
    s_add_u32 s3, s61, 92160
    buffer_load_dwordx4 a[0:3], v131, s[4:7], s3 offen offset:0 sc1
    v_mfma_f32_16x16x32_bf16 v[24:27], v[72:75], a[16:19], v[24:27]
    ds_read_b64_tr_b16 v[56:57], v88 offset:8192
    v_mfma_f32_16x16x32_bf16 v[40:43], v[72:75], a[20:23], v[40:43]
    ds_read_b64_tr_b16 v[58:59], v88 offset:10240
    v_mfma_f32_16x16x32_bf16 v[12:15], v[76:79], a[12:15], v[12:15]
    ds_read_b64_tr_b16 v[60:61], v89 offset:8192
    v_mfma_f32_16x16x32_bf16 v[28:31], v[76:79], a[16:19], v[28:31]
    buffer_load_dwordx4 a[4:7], v92, s[4:7], s3 offen offset:256 sc1
    v_mfma_f32_16x16x32_bf16 v[44:47], v[76:79], a[20:23], v[44:47]
    ds_read_b64_tr_b16 v[62:63], v89 offset:10240
    v_mfma_f32_16x16x32_bf16 v[16:19], v[80:83], a[12:15], v[16:19]
    ds_read_b64_tr_b16 v[64:65], v90 offset:8192
    v_mfma_f32_16x16x32_bf16 v[32:35], v[80:83], a[16:19], v[32:35]
    ds_read_b64_tr_b16 v[66:67], v90 offset:10240
    v_mfma_f32_16x16x32_bf16 v[48:51], v[80:83], a[20:23], v[48:51]
    buffer_load_dwordx4 a[8:11], v92, s[4:7], s3 offen offset:512 sc1
    v_mfma_f32_16x16x32_bf16 v[20:23], v[84:87], a[12:15], v[20:23]
    ds_read_b64_tr_b16 v[68:69], v91 offset:8192
    v_mfma_f32_16x16x32_bf16 v[36:39], v[84:87], a[16:19], v[36:39]
    ds_read_b64_tr_b16 v[70:71], v91 offset:10240
    v_mfma_f32_16x16x32_bf16 v[52:55], v[84:87], a[20:23], v[52:55]
    s_waitcnt vmcnt(9) lgkmcnt(0)
    v_mfma_f32_16x16x32_bf16 v[8:11], v[56:59], a[24:27], v[8:11]
    s_add_u32 s3, s61, 110592
    buffer_load_dwordx4 a[12:15], v131, s[4:7], s3 offen offset:0 sc1
    v_mfma_f32_16x16x32_bf16 v[24:27], v[56:59], a[28:31], v[24:27]
    ds_read_b64_tr_b16 v[72:73], v88 offset:12288
    v_mfma_f32_16x16x32_bf16 v[40:43], v[56:59], a[32:35], v[40:43]
    ds_read_b64_tr_b16 v[74:75], v88 offset:14336
    v_mfma_f32_16x16x32_bf16 v[12:15], v[60:63], a[24:27], v[12:15]
    ds_read_b64_tr_b16 v[76:77], v89 offset:12288
    v_mfma_f32_16x16x32_bf16 v[28:31], v[60:63], a[28:31], v[28:31]
    buffer_load_dwordx4 a[16:19], v92, s[4:7], s3 offen offset:256 sc1
    v_mfma_f32_16x16x32_bf16 v[44:47], v[60:63], a[32:35], v[44:47]
    ds_read_b64_tr_b16 v[78:79], v89 offset:14336
    v_mfma_f32_16x16x32_bf16 v[16:19], v[64:67], a[24:27], v[16:19]
    ds_read_b64_tr_b16 v[80:81], v90 offset:12288
    v_mfma_f32_16x16x32_bf16 v[32:35], v[64:67], a[28:31], v[32:35]
    ds_read_b64_tr_b16 v[82:83], v90 offset:14336
    v_mfma_f32_16x16x32_bf16 v[48:51], v[64:67], a[32:35], v[48:51]
    buffer_load_dwordx4 a[20:23], v92, s[4:7], s3 offen offset:512 sc1
    v_mfma_f32_16x16x32_bf16 v[20:23], v[68:71], a[24:27], v[20:23]
    ds_read_b64_tr_b16 v[84:85], v91 offset:12288
    v_mfma_f32_16x16x32_bf16 v[36:39], v[68:71], a[28:31], v[36:39]
    ds_read_b64_tr_b16 v[86:87], v91 offset:14336
    v_mfma_f32_16x16x32_bf16 v[52:55], v[68:71], a[32:35], v[52:55]
    s_waitcnt vmcnt(9) lgkmcnt(0)
    v_mfma_f32_16x16x32_bf16 v[8:11], v[72:75], a[36:39], v[8:11]
    s_add_u32 s3, s61, 129024
    buffer_load_dwordx4 a[24:27], v131, s[4:7], s3 offen offset:0 sc1
    v_mfma_f32_16x16x32_bf16 v[24:27], v[72:75], a[40:43], v[24:27]
    ds_read_b64_tr_b16 v[56:57], v88 offset:16384
    v_mfma_f32_16x16x32_bf16 v[40:43], v[72:75], a[44:47], v[40:43]
    ds_read_b64_tr_b16 v[58:59], v88 offset:18432
    v_mfma_f32_16x16x32_bf16 v[12:15], v[76:79], a[36:39], v[12:15]
    ds_read_b64_tr_b16 v[60:61], v89 offset:16384
    v_mfma_f32_16x16x32_bf16 v[28:31], v[76:79], a[40:43], v[28:31]
    buffer_load_dwordx4 a[28:31], v92, s[4:7], s3 offen offset:256 sc1
    v_mfma_f32_16x16x32_bf16 v[44:47], v[76:79], a[44:47], v[44:47]
    ds_read_b64_tr_b16 v[62:63], v89 offset:18432
    v_mfma_f32_16x16x32_bf16 v[16:19], v[80:83], a[36:39], v[16:19]
    ds_read_b64_tr_b16 v[64:65], v90 offset:16384
    v_mfma_f32_16x16x32_bf16 v[32:35], v[80:83], a[40:43], v[32:35]
    ds_read_b64_tr_b16 v[66:67], v90 offset:18432
    v_mfma_f32_16x16x32_bf16 v[48:51], v[80:83], a[44:47], v[48:51]
    buffer_load_dwordx4 a[32:35], v92, s[4:7], s3 offen offset:512 sc1
    v_mfma_f32_16x16x32_bf16 v[20:23], v[84:87], a[36:39], v[20:23]
    ds_read_b64_tr_b16 v[68:69], v91 offset:16384
    v_mfma_f32_16x16x32_bf16 v[36:39], v[84:87], a[40:43], v[36:39]
    ds_read_b64_tr_b16 v[70:71], v91 offset:18432
    v_mfma_f32_16x16x32_bf16 v[52:55], v[84:87], a[44:47], v[52:55]
    s_waitcnt vmcnt(9) lgkmcnt(0)
    v_mfma_f32_16x16x32_bf16 v[8:11], v[56:59], a[48:51], v[8:11]
    s_add_u32 s3, s61, 147456
    buffer_load_dwordx4 a[36:39], v131, s[4:7], s3 offen offset:0 sc1
    v_mfma_f32_16x16x32_bf16 v[24:27], v[56:59], a[52:55], v[24:27]
    ds_read_b64_tr_b16 v[72:73], v88 offset:20480
    v_mfma_f32_16x16x32_bf16 v[40:43], v[56:59], a[56:59], v[40:43]
    ds_read_b64_tr_b16 v[74:75], v88 offset:22528
    v_mfma_f32_16x16x32_bf16 v[12:15], v[60:63], a[48:51], v[12:15]
    ds_read_b64_tr_b16 v[76:77], v89 offset:20480
    v_mfma_f32_16x16x32_bf16 v[28:31], v[60:63], a[52:55], v[28:31]
    buffer_load_dwordx4 a[40:43], v92, s[4:7], s3 offen offset:256 sc1
    v_mfma_f32_16x16x32_bf16 v[44:47], v[60:63], a[56:59], v[44:47]
    ds_read_b64_tr_b16 v[78:79], v89 offset:22528
    v_mfma_f32_16x16x32_bf16 v[16:19], v[64:67], a[48:51], v[16:19]
    ds_read_b64_tr_b16 v[80:81], v90 offset:20480
    v_mfma_f32_16x16x32_bf16 v[32:35], v[64:67], a[52:55], v[32:35]
    ds_read_b64_tr_b16 v[82:83], v90 offset:22528
    v_mfma_f32_16x16x32_bf16 v[48:51], v[64:67], a[56:59], v[48:51]
    buffer_load_dwordx4 a[44:47], v92, s[4:7], s3 offen offset:512 sc1
    v_mfma_f32_16x16x32_bf16 v[20:23], v[68:71], a[48:51], v[20:23]
    ds_read_b64_tr_b16 v[84:85], v91 offset:20480
    v_mfma_f32_16x16x32_bf16 v[36:39], v[68:71], a[52:55], v[36:39]
    ds_read_b64_tr_b16 v[86:87], v91 offset:22528
    v_mfma_f32_16x16x32_bf16 v[52:55], v[68:71], a[56:59], v[52:55]
    s_waitcnt vmcnt(9) lgkmcnt(0)
    v_mfma_f32_16x16x32_bf16 v[8:11], v[72:75], a[0:3], v[8:11]
    s_add_u32 s3, s61, 165888
    buffer_load_dwordx4 a[48:51], v131, s[4:7], s3 offen offset:0 sc1
    v_mfma_f32_16x16x32_bf16 v[24:27], v[72:75], a[4:7], v[24:27]
    ds_read_b64_tr_b16 v[56:57], v88 offset:24576
    v_mfma_f32_16x16x32_bf16 v[40:43], v[72:75], a[8:11], v[40:43]
    ds_read_b64_tr_b16 v[58:59], v88 offset:26624
    v_mfma_f32_16x16x32_bf16 v[12:15], v[76:79], a[0:3], v[12:15]
    ds_read_b64_tr_b16 v[60:61], v89 offset:24576
    v_mfma_f32_16x16x32_bf16 v[28:31], v[76:79], a[4:7], v[28:31]
    buffer_load_dwordx4 a[52:55], v92, s[4:7], s3 offen offset:256 sc1
    v_mfma_f32_16x16x32_bf16 v[44:47], v[76:79], a[8:11], v[44:47]
    ds_read_b64_tr_b16 v[62:63], v89 offset:26624
    v_mfma_f32_16x16x32_bf16 v[16:19], v[80:83], a[0:3], v[16:19]
    ds_read_b64_tr_b16 v[64:65], v90 offset:24576
    v_mfma_f32_16x16x32_bf16 v[32:35], v[80:83], a[4:7], v[32:35]
    ds_read_b64_tr_b16 v[66:67], v90 offset:26624
    v_mfma_f32_16x16x32_bf16 v[48:51], v[80:83], a[8:11], v[48:51]
    buffer_load_dwordx4 a[56:59], v92, s[4:7], s3 offen offset:512 sc1
    v_mfma_f32_16x16x32_bf16 v[20:23], v[84:87], a[0:3], v[20:23]
    ds_read_b64_tr_b16 v[68:69], v91 offset:24576
    v_mfma_f32_16x16x32_bf16 v[36:39], v[84:87], a[4:7], v[36:39]
    ds_read_b64_tr_b16 v[70:71], v91 offset:26624
    v_mfma_f32_16x16x32_bf16 v[52:55], v[84:87], a[8:11], v[52:55]
    s_waitcnt vmcnt(9) lgkmcnt(0)
    s_barrier
    v_mfma_f32_16x16x32_bf16 v[8:11], v[56:59], a[12:15], v[8:11]
    s_add_u32 s3, s61, 368640
    buffer_load_dwordx4 a[0:3], v131, s[4:7], s3 offen offset:0 sc1
    v_mfma_f32_16x16x32_bf16 v[24:27], v[56:59], a[16:19], v[24:27]
    ds_read_b64_tr_b16 v[72:73], v88 offset:28672
    v_mfma_f32_16x16x32_bf16 v[40:43], v[56:59], a[20:23], v[40:43]
    ds_read_b64_tr_b16 v[74:75], v88 offset:30720
    v_mfma_f32_16x16x32_bf16 v[12:15], v[60:63], a[12:15], v[12:15]
    ds_read_b64_tr_b16 v[76:77], v89 offset:28672
    v_mfma_f32_16x16x32_bf16 v[28:31], v[60:63], a[16:19], v[28:31]
    buffer_load_dwordx4 a[4:7], v92, s[4:7], s3 offen offset:256 sc1
    v_mfma_f32_16x16x32_bf16 v[44:47], v[60:63], a[20:23], v[44:47]
    ds_read_b64_tr_b16 v[78:79], v89 offset:30720
    v_mfma_f32_16x16x32_bf16 v[16:19], v[64:67], a[12:15], v[16:19]
    ds_read_b64_tr_b16 v[80:81], v90 offset:28672
    v_mfma_f32_16x16x32_bf16 v[32:35], v[64:67], a[16:19], v[32:35]
    ds_read_b64_tr_b16 v[82:83], v90 offset:30720
    v_mfma_f32_16x16x32_bf16 v[48:51], v[64:67], a[20:23], v[48:51]
    buffer_load_dwordx4 a[8:11], v92, s[4:7], s3 offen offset:512 sc1
    v_mfma_f32_16x16x32_bf16 v[20:23], v[68:71], a[12:15], v[20:23]
    ds_read_b64_tr_b16 v[84:85], v91 offset:28672
    v_mfma_f32_16x16x32_bf16 v[36:39], v[68:71], a[16:19], v[36:39]
    ds_read_b64_tr_b16 v[86:87], v91 offset:30720
    v_mfma_f32_16x16x32_bf16 v[52:55], v[68:71], a[20:23], v[52:55]
    s_waitcnt vmcnt(9) lgkmcnt(0)
    v_mfma_f32_16x16x32_bf16 v[8:11], v[72:75], a[24:27], v[8:11]
    s_add_u32 s3, s61, 387072
    buffer_load_dwordx4 a[12:15], v131, s[4:7], s3 offen offset:0 sc1
    v_mfma_f32_16x16x32_bf16 v[24:27], v[72:75], a[28:31], v[24:27]
    ds_read_b64_tr_b16 v[56:57], v88 offset:32768
    v_mfma_f32_16x16x32_bf16 v[40:43], v[72:75], a[32:35], v[40:43]
    ds_read_b64_tr_b16 v[58:59], v88 offset:34816
    v_mfma_f32_16x16x32_bf16 v[12:15], v[76:79], a[24:27], v[12:15]
    ds_read_b64_tr_b16 v[60:61], v89 offset:32768
    v_mfma_f32_16x16x32_bf16 v[28:31], v[76:79], a[28:31], v[28:31]
    buffer_load_dwordx4 a[16:19], v92, s[4:7], s3 offen offset:256 sc1
    v_mfma_f32_16x16x32_bf16 v[44:47], v[76:79], a[32:35], v[44:47]
    ds_read_b64_tr_b16 v[62:63], v89 offset:34816
    v_mfma_f32_16x16x32_bf16 v[16:19], v[80:83], a[24:27], v[16:19]
    ds_read_b64_tr_b16 v[64:65], v90 offset:32768
    v_mfma_f32_16x16x32_bf16 v[32:35], v[80:83], a[28:31], v[32:35]
    ds_read_b64_tr_b16 v[66:67], v90 offset:34816
    v_mfma_f32_16x16x32_bf16 v[48:51], v[80:83], a[32:35], v[48:51]
    buffer_load_dwordx4 a[20:23], v92, s[4:7], s3 offen offset:512 sc1
    v_mfma_f32_16x16x32_bf16 v[20:23], v[84:87], a[24:27], v[20:23]
    ds_read_b64_tr_b16 v[68:69], v91 offset:32768
    v_mfma_f32_16x16x32_bf16 v[36:39], v[84:87], a[28:31], v[36:39]
    ds_read_b64_tr_b16 v[70:71], v91 offset:34816
    v_mfma_f32_16x16x32_bf16 v[52:55], v[84:87], a[32:35], v[52:55]
    s_waitcnt vmcnt(9) lgkmcnt(0)
    v_mfma_f32_16x16x32_bf16 v[8:11], v[56:59], a[36:39], v[8:11]
    s_add_u32 s3, s61, 405504
    buffer_load_dwordx4 a[24:27], v131, s[4:7], s3 offen offset:0 sc1
    v_mfma_f32_16x16x32_bf16 v[24:27], v[56:59], a[40:43], v[24:27]
    ds_read_b64_tr_b16 v[72:73], v88 offset:36864
    v_mfma_f32_16x16x32_bf16 v[40:43], v[56:59], a[44:47], v[40:43]
    ds_read_b64_tr_b16 v[74:75], v88 offset:38912
    v_mfma_f32_16x16x32_bf16 v[12:15], v[60:63], a[36:39], v[12:15]
    ds_read_b64_tr_b16 v[76:77], v89 offset:36864
    v_mfma_f32_16x16x32_bf16 v[28:31], v[60:63], a[40:43], v[28:31]
    buffer_load_dwordx4 a[28:31], v92, s[4:7], s3 offen offset:256 sc1
    v_mfma_f32_16x16x32_bf16 v[44:47], v[60:63], a[44:47], v[44:47]
    ds_read_b64_tr_b16 v[78:79], v89 offset:38912
    v_mfma_f32_16x16x32_bf16 v[16:19], v[64:67], a[36:39], v[16:19]
    ds_read_b64_tr_b16 v[80:81], v90 offset:36864
    v_mfma_f32_16x16x32_bf16 v[32:35], v[64:67], a[40:43], v[32:35]
    ds_read_b64_tr_b16 v[82:83], v90 offset:38912
    v_mfma_f32_16x16x32_bf16 v[48:51], v[64:67], a[44:47], v[48:51]
    buffer_load_dwordx4 a[32:35], v92, s[4:7], s3 offen offset:512 sc1
    v_mfma_f32_16x16x32_bf16 v[20:23], v[68:71], a[36:39], v[20:23]
    ds_read_b64_tr_b16 v[84:85], v91 offset:36864
    v_mfma_f32_16x16x32_bf16 v[36:39], v[68:71], a[40:43], v[36:39]
    ds_read_b64_tr_b16 v[86:87], v91 offset:38912
    v_mfma_f32_16x16x32_bf16 v[52:55], v[68:71], a[44:47], v[52:55]
    s_waitcnt vmcnt(9) lgkmcnt(0)
    v_add_u32 v88, 81920, v88
    v_add_u32 v89, 81920, v89
    v_add_u32 v90, 81920, v90
    v_add_u32 v91, 81920, v91
    v_mfma_f32_16x16x32_bf16 v[8:11], v[72:75], a[48:51], v[8:11]
    s_add_u32 s3, s61, 423936
    buffer_load_dwordx4 a[36:39], v131, s[4:7], s3 offen offset:0 sc1
    v_mfma_f32_16x16x32_bf16 v[24:27], v[72:75], a[52:55], v[24:27]
    ds_read_b64_tr_b16 v[56:57], v88 offset:0
    v_mfma_f32_16x16x32_bf16 v[40:43], v[72:75], a[56:59], v[40:43]
    ds_read_b64_tr_b16 v[58:59], v88 offset:2048
    v_mfma_f32_16x16x32_bf16 v[12:15], v[76:79], a[48:51], v[12:15]
    ds_read_b64_tr_b16 v[60:61], v89 offset:0
    v_mfma_f32_16x16x32_bf16 v[28:31], v[76:79], a[52:55], v[28:31]
    buffer_load_dwordx4 a[40:43], v92, s[4:7], s3 offen offset:256 sc1
    v_mfma_f32_16x16x32_bf16 v[44:47], v[76:79], a[56:59], v[44:47]
    ds_read_b64_tr_b16 v[62:63], v89 offset:2048
    v_mfma_f32_16x16x32_bf16 v[16:19], v[80:83], a[48:51], v[16:19]
    ds_read_b64_tr_b16 v[64:65], v90 offset:0
    v_mfma_f32_16x16x32_bf16 v[32:35], v[80:83], a[52:55], v[32:35]
    ds_read_b64_tr_b16 v[66:67], v90 offset:2048
    v_mfma_f32_16x16x32_bf16 v[48:51], v[80:83], a[56:59], v[48:51]
    buffer_load_dwordx4 a[44:47], v92, s[4:7], s3 offen offset:512 sc1
    v_mfma_f32_16x16x32_bf16 v[20:23], v[84:87], a[48:51], v[20:23]
    ds_read_b64_tr_b16 v[68:69], v91 offset:0
    v_mfma_f32_16x16x32_bf16 v[36:39], v[84:87], a[52:55], v[36:39]
    ds_read_b64_tr_b16 v[70:71], v91 offset:2048
    v_mfma_f32_16x16x32_bf16 v[52:55], v[84:87], a[56:59], v[52:55]
    s_waitcnt vmcnt(9) lgkmcnt(0)
    v_mfma_f32_16x16x32_bf16 v[8:11], v[56:59], a[0:3], v[8:11]
    s_add_u32 s3, s61, 442368
    buffer_load_dwordx4 a[48:51], v131, s[4:7], s3 offen offset:0 sc1
    v_mfma_f32_16x16x32_bf16 v[24:27], v[56:59], a[4:7], v[24:27]
    ds_read_b64_tr_b16 v[72:73], v88 offset:4096
    v_mfma_f32_16x16x32_bf16 v[40:43], v[56:59], a[8:11], v[40:43]
    ds_read_b64_tr_b16 v[74:75], v88 offset:6144
    v_mfma_f32_16x16x32_bf16 v[12:15], v[60:63], a[0:3], v[12:15]
    ds_read_b64_tr_b16 v[76:77], v89 offset:4096
    v_mfma_f32_16x16x32_bf16 v[28:31], v[60:63], a[4:7], v[28:31]
    buffer_load_dwordx4 a[52:55], v92, s[4:7], s3 offen offset:256 sc1
    v_mfma_f32_16x16x32_bf16 v[44:47], v[60:63], a[8:11], v[44:47]
    ds_read_b64_tr_b16 v[78:79], v89 offset:6144
    v_mfma_f32_16x16x32_bf16 v[16:19], v[64:67], a[0:3], v[16:19]
    ds_read_b64_tr_b16 v[80:81], v90 offset:4096
    v_mfma_f32_16x16x32_bf16 v[32:35], v[64:67], a[4:7], v[32:35]
    ds_read_b64_tr_b16 v[82:83], v90 offset:6144
    v_mfma_f32_16x16x32_bf16 v[48:51], v[64:67], a[8:11], v[48:51]
    buffer_load_dwordx4 a[56:59], v92, s[4:7], s3 offen offset:512 sc1
    v_mfma_f32_16x16x32_bf16 v[20:23], v[68:71], a[0:3], v[20:23]
    ds_read_b64_tr_b16 v[84:85], v91 offset:4096
    v_mfma_f32_16x16x32_bf16 v[36:39], v[68:71], a[4:7], v[36:39]
    ds_read_b64_tr_b16 v[86:87], v91 offset:6144
    v_mfma_f32_16x16x32_bf16 v[52:55], v[68:71], a[8:11], v[52:55]
    s_waitcnt vmcnt(9) lgkmcnt(0)
    v_mfma_f32_16x16x32_bf16 v[8:11], v[72:75], a[12:15], v[8:11]
    s_add_u32 s3, s61, 460800
    buffer_load_dwordx4 a[0:3], v131, s[4:7], s3 offen offset:0 sc1
    v_mfma_f32_16x16x32_bf16 v[24:27], v[72:75], a[16:19], v[24:27]
    ds_read_b64_tr_b16 v[56:57], v88 offset:8192
    v_mfma_f32_16x16x32_bf16 v[40:43], v[72:75], a[20:23], v[40:43]
    ds_read_b64_tr_b16 v[58:59], v88 offset:10240
    v_mfma_f32_16x16x32_bf16 v[12:15], v[76:79], a[12:15], v[12:15]
    ds_read_b64_tr_b16 v[60:61], v89 offset:8192
    v_mfma_f32_16x16x32_bf16 v[28:31], v[76:79], a[16:19], v[28:31]
    buffer_load_dwordx4 a[4:7], v92, s[4:7], s3 offen offset:256 sc1
    v_mfma_f32_16x16x32_bf16 v[44:47], v[76:79], a[20:23], v[44:47]
    ds_read_b64_tr_b16 v[62:63], v89 offset:10240
    v_mfma_f32_16x16x32_bf16 v[16:19], v[80:83], a[12:15], v[16:19]
    ds_read_b64_tr_b16 v[64:65], v90 offset:8192
    v_mfma_f32_16x16x32_bf16 v[32:35], v[80:83], a[16:19], v[32:35]
    ds_read_b64_tr_b16 v[66:67], v90 offset:10240
    v_mfma_f32_16x16x32_bf16 v[48:51], v[80:83], a[20:23], v[48:51]
    buffer_load_dwordx4 a[8:11], v92, s[4:7], s3 offen offset:512 sc1
    v_mfma_f32_16x16x32_bf16 v[20:23], v[84:87], a[12:15], v[20:23]
    ds_read_b64_tr_b16 v[68:69], v91 offset:8192
    v_mfma_f32_16x16x32_bf16 v[36:39], v[84:87], a[16:19], v[36:39]
    ds_read_b64_tr_b16 v[70:71], v91 offset:10240
    v_mfma_f32_16x16x32_bf16 v[52:55], v[84:87], a[20:23], v[52:55]
    s_waitcnt vmcnt(9) lgkmcnt(0)
    v_mfma_f32_16x16x32_bf16 v[8:11], v[56:59], a[24:27], v[8:11]
    s_add_u32 s3, s61, 479232
    buffer_load_dwordx4 a[12:15], v131, s[4:7], s3 offen offset:0 sc1
    v_mfma_f32_16x16x32_bf16 v[24:27], v[56:59], a[28:31], v[24:27]
    ds_read_b64_tr_b16 v[72:73], v88 offset:12288
    v_mfma_f32_16x16x32_bf16 v[40:43], v[56:59], a[32:35], v[40:43]
    ds_read_b64_tr_b16 v[74:75], v88 offset:14336
    v_mfma_f32_16x16x32_bf16 v[12:15], v[60:63], a[24:27], v[12:15]
    ds_read_b64_tr_b16 v[76:77], v89 offset:12288
    v_mfma_f32_16x16x32_bf16 v[28:31], v[60:63], a[28:31], v[28:31]
    buffer_load_dwordx4 a[16:19], v92, s[4:7], s3 offen offset:256 sc1
    v_mfma_f32_16x16x32_bf16 v[44:47], v[60:63], a[32:35], v[44:47]
    ds_read_b64_tr_b16 v[78:79], v89 offset:14336
    v_mfma_f32_16x16x32_bf16 v[16:19], v[64:67], a[24:27], v[16:19]
    ds_read_b64_tr_b16 v[80:81], v90 offset:12288
    v_mfma_f32_16x16x32_bf16 v[32:35], v[64:67], a[28:31], v[32:35]
    ds_read_b64_tr_b16 v[82:83], v90 offset:14336
    v_mfma_f32_16x16x32_bf16 v[48:51], v[64:67], a[32:35], v[48:51]
    buffer_load_dwordx4 a[20:23], v92, s[4:7], s3 offen offset:512 sc1
    v_mfma_f32_16x16x32_bf16 v[20:23], v[68:71], a[24:27], v[20:23]
    ds_read_b64_tr_b16 v[84:85], v91 offset:12288
    v_mfma_f32_16x16x32_bf16 v[36:39], v[68:71], a[28:31], v[36:39]
    ds_read_b64_tr_b16 v[86:87], v91 offset:14336
    v_mfma_f32_16x16x32_bf16 v[52:55], v[68:71], a[32:35], v[52:55]
    s_waitcnt vmcnt(9) lgkmcnt(0)
    v_mfma_f32_16x16x32_bf16 v[8:11], v[72:75], a[36:39], v[8:11]
    s_add_u32 s3, s61, 497664
    buffer_load_dwordx4 a[24:27], v131, s[4:7], s3 offen offset:0 sc1
    v_mfma_f32_16x16x32_bf16 v[24:27], v[72:75], a[40:43], v[24:27]
    ds_read_b64_tr_b16 v[56:57], v88 offset:16384
    v_mfma_f32_16x16x32_bf16 v[40:43], v[72:75], a[44:47], v[40:43]
    ds_read_b64_tr_b16 v[58:59], v88 offset:18432
    v_mfma_f32_16x16x32_bf16 v[12:15], v[76:79], a[36:39], v[12:15]
    ds_read_b64_tr_b16 v[60:61], v89 offset:16384
    v_mfma_f32_16x16x32_bf16 v[28:31], v[76:79], a[40:43], v[28:31]
    buffer_load_dwordx4 a[28:31], v92, s[4:7], s3 offen offset:256 sc1
    v_mfma_f32_16x16x32_bf16 v[44:47], v[76:79], a[44:47], v[44:47]
    ds_read_b64_tr_b16 v[62:63], v89 offset:18432
    v_mfma_f32_16x16x32_bf16 v[16:19], v[80:83], a[36:39], v[16:19]
    ds_read_b64_tr_b16 v[64:65], v90 offset:16384
    v_mfma_f32_16x16x32_bf16 v[32:35], v[80:83], a[40:43], v[32:35]
    ds_read_b64_tr_b16 v[66:67], v90 offset:18432
    v_mfma_f32_16x16x32_bf16 v[48:51], v[80:83], a[44:47], v[48:51]
    buffer_load_dwordx4 a[32:35], v92, s[4:7], s3 offen offset:512 sc1
    v_mfma_f32_16x16x32_bf16 v[20:23], v[84:87], a[36:39], v[20:23]
    ds_read_b64_tr_b16 v[68:69], v91 offset:16384
    v_mfma_f32_16x16x32_bf16 v[36:39], v[84:87], a[40:43], v[36:39]
    ds_read_b64_tr_b16 v[70:71], v91 offset:18432
    v_mfma_f32_16x16x32_bf16 v[52:55], v[84:87], a[44:47], v[52:55]
    s_waitcnt vmcnt(9) lgkmcnt(0)
    v_mfma_f32_16x16x32_bf16 v[8:11], v[56:59], a[48:51], v[8:11]
    s_add_u32 s3, s61, 516096
    buffer_load_dwordx4 a[36:39], v131, s[4:7], s3 offen offset:0 sc1
    v_mfma_f32_16x16x32_bf16 v[24:27], v[56:59], a[52:55], v[24:27]
    ds_read_b64_tr_b16 v[72:73], v88 offset:20480
    v_mfma_f32_16x16x32_bf16 v[40:43], v[56:59], a[56:59], v[40:43]
    ds_read_b64_tr_b16 v[74:75], v88 offset:22528
    v_mfma_f32_16x16x32_bf16 v[12:15], v[60:63], a[48:51], v[12:15]
    ds_read_b64_tr_b16 v[76:77], v89 offset:20480
    v_mfma_f32_16x16x32_bf16 v[28:31], v[60:63], a[52:55], v[28:31]
    buffer_load_dwordx4 a[40:43], v92, s[4:7], s3 offen offset:256 sc1
    v_mfma_f32_16x16x32_bf16 v[44:47], v[60:63], a[56:59], v[44:47]
    ds_read_b64_tr_b16 v[78:79], v89 offset:22528
    v_mfma_f32_16x16x32_bf16 v[16:19], v[64:67], a[48:51], v[16:19]
    ds_read_b64_tr_b16 v[80:81], v90 offset:20480
    v_mfma_f32_16x16x32_bf16 v[32:35], v[64:67], a[52:55], v[32:35]
    ds_read_b64_tr_b16 v[82:83], v90 offset:22528
    v_mfma_f32_16x16x32_bf16 v[48:51], v[64:67], a[56:59], v[48:51]
    buffer_load_dwordx4 a[44:47], v92, s[4:7], s3 offen offset:512 sc1
    v_mfma_f32_16x16x32_bf16 v[20:23], v[68:71], a[48:51], v[20:23]
    ds_read_b64_tr_b16 v[84:85], v91 offset:20480
    v_mfma_f32_16x16x32_bf16 v[36:39], v[68:71], a[52:55], v[36:39]
    ds_read_b64_tr_b16 v[86:87], v91 offset:22528
    v_mfma_f32_16x16x32_bf16 v[52:55], v[68:71], a[56:59], v[52:55]
    s_waitcnt vmcnt(9) lgkmcnt(0)
    v_mfma_f32_16x16x32_bf16 v[8:11], v[72:75], a[0:3], v[8:11]
    s_add_u32 s3, s61, 534528
    buffer_load_dwordx4 a[48:51], v131, s[4:7], s3 offen offset:0 sc1
    v_mfma_f32_16x16x32_bf16 v[24:27], v[72:75], a[4:7], v[24:27]
    ds_read_b64_tr_b16 v[56:57], v88 offset:24576
    v_mfma_f32_16x16x32_bf16 v[40:43], v[72:75], a[8:11], v[40:43]
    ds_read_b64_tr_b16 v[58:59], v88 offset:26624
    v_mfma_f32_16x16x32_bf16 v[12:15], v[76:79], a[0:3], v[12:15]
    ds_read_b64_tr_b16 v[60:61], v89 offset:24576
    v_mfma_f32_16x16x32_bf16 v[28:31], v[76:79], a[4:7], v[28:31]
    buffer_load_dwordx4 a[52:55], v92, s[4:7], s3 offen offset:256 sc1
    v_mfma_f32_16x16x32_bf16 v[44:47], v[76:79], a[8:11], v[44:47]
    ds_read_b64_tr_b16 v[62:63], v89 offset:26624
    v_mfma_f32_16x16x32_bf16 v[16:19], v[80:83], a[0:3], v[16:19]
    ds_read_b64_tr_b16 v[64:65], v90 offset:24576
    v_mfma_f32_16x16x32_bf16 v[32:35], v[80:83], a[4:7], v[32:35]
    ds_read_b64_tr_b16 v[66:67], v90 offset:26624
    v_mfma_f32_16x16x32_bf16 v[48:51], v[80:83], a[8:11], v[48:51]
    buffer_load_dwordx4 a[56:59], v92, s[4:7], s3 offen offset:512 sc1
    v_mfma_f32_16x16x32_bf16 v[20:23], v[84:87], a[0:3], v[20:23]
    ds_read_b64_tr_b16 v[68:69], v91 offset:24576
    v_mfma_f32_16x16x32_bf16 v[36:39], v[84:87], a[4:7], v[36:39]
    ds_read_b64_tr_b16 v[70:71], v91 offset:26624
    v_mfma_f32_16x16x32_bf16 v[52:55], v[84:87], a[8:11], v[52:55]
    s_waitcnt vmcnt(9) lgkmcnt(0)
    v_mfma_f32_16x16x32_bf16 v[8:11], v[56:59], a[12:15], v[8:11]
    s_mul_i32 s61, s46, 129024
    s_add_u32 s3, s61, 737280
    buffer_load_dwordx4 a[0:3], v131, s[4:7], s3 offen offset:0 sc1
    v_mfma_f32_16x16x32_bf16 v[24:27], v[56:59], a[16:19], v[24:27]
    ds_read_b64_tr_b16 v[72:73], v88 offset:28672
    v_mfma_f32_16x16x32_bf16 v[40:43], v[56:59], a[20:23], v[40:43]
    ds_read_b64_tr_b16 v[74:75], v88 offset:30720
    v_mfma_f32_16x16x32_bf16 v[12:15], v[60:63], a[12:15], v[12:15]
    ds_read_b64_tr_b16 v[76:77], v89 offset:28672
    v_mfma_f32_16x16x32_bf16 v[28:31], v[60:63], a[16:19], v[28:31]
    buffer_load_dwordx4 a[4:7], v92, s[4:7], s3 offen offset:256 sc1
    v_mfma_f32_16x16x32_bf16 v[44:47], v[60:63], a[20:23], v[44:47]
    ds_read_b64_tr_b16 v[78:79], v89 offset:30720
    v_mfma_f32_16x16x32_bf16 v[16:19], v[64:67], a[12:15], v[16:19]
    ds_read_b64_tr_b16 v[80:81], v90 offset:28672
    v_mfma_f32_16x16x32_bf16 v[32:35], v[64:67], a[16:19], v[32:35]
    ds_read_b64_tr_b16 v[82:83], v90 offset:30720
    v_mfma_f32_16x16x32_bf16 v[48:51], v[64:67], a[20:23], v[48:51]
    buffer_load_dwordx4 a[8:11], v92, s[4:7], s3 offen offset:512 sc1
    v_mfma_f32_16x16x32_bf16 v[20:23], v[68:71], a[12:15], v[20:23]
    ds_read_b64_tr_b16 v[84:85], v91 offset:28672
    v_mfma_f32_16x16x32_bf16 v[36:39], v[68:71], a[16:19], v[36:39]
    ds_read_b64_tr_b16 v[86:87], v91 offset:30720
    v_mfma_f32_16x16x32_bf16 v[52:55], v[68:71], a[20:23], v[52:55]
    s_waitcnt vmcnt(9) lgkmcnt(0)
    v_mfma_f32_16x16x32_bf16 v[8:11], v[72:75], a[24:27], v[8:11]
    s_add_u32 s3, s61, 755712
    buffer_load_dwordx4 a[12:15], v131, s[4:7], s3 offen offset:0 sc1
    v_mfma_f32_16x16x32_bf16 v[24:27], v[72:75], a[28:31], v[24:27]
    ds_read_b64_tr_b16 v[56:57], v88 offset:32768
    v_mfma_f32_16x16x32_bf16 v[40:43], v[72:75], a[32:35], v[40:43]
    ds_read_b64_tr_b16 v[58:59], v88 offset:34816
    v_mfma_f32_16x16x32_bf16 v[12:15], v[76:79], a[24:27], v[12:15]
    ds_read_b64_tr_b16 v[60:61], v89 offset:32768
    v_mfma_f32_16x16x32_bf16 v[28:31], v[76:79], a[28:31], v[28:31]
    buffer_load_dwordx4 a[16:19], v92, s[4:7], s3 offen offset:256 sc1
    v_mfma_f32_16x16x32_bf16 v[44:47], v[76:79], a[32:35], v[44:47]
    ds_read_b64_tr_b16 v[62:63], v89 offset:34816
    v_mfma_f32_16x16x32_bf16 v[16:19], v[80:83], a[24:27], v[16:19]
    ds_read_b64_tr_b16 v[64:65], v90 offset:32768
    v_mfma_f32_16x16x32_bf16 v[32:35], v[80:83], a[28:31], v[32:35]
    ds_read_b64_tr_b16 v[66:67], v90 offset:34816
    v_mfma_f32_16x16x32_bf16 v[48:51], v[80:83], a[32:35], v[48:51]
    buffer_load_dwordx4 a[20:23], v92, s[4:7], s3 offen offset:512 sc1
    v_mfma_f32_16x16x32_bf16 v[20:23], v[84:87], a[24:27], v[20:23]
    ds_read_b64_tr_b16 v[68:69], v91 offset:32768
    v_mfma_f32_16x16x32_bf16 v[36:39], v[84:87], a[28:31], v[36:39]
    ds_read_b64_tr_b16 v[70:71], v91 offset:34816
    v_mfma_f32_16x16x32_bf16 v[52:55], v[84:87], a[32:35], v[52:55]
    s_waitcnt vmcnt(9) lgkmcnt(0)
    v_mfma_f32_16x16x32_bf16 v[8:11], v[56:59], a[36:39], v[8:11]
    s_add_u32 s3, s61, 774144
    buffer_load_dwordx4 a[24:27], v131, s[4:7], s3 offen offset:0 sc1
    v_mfma_f32_16x16x32_bf16 v[24:27], v[56:59], a[40:43], v[24:27]
    ds_read_b64_tr_b16 v[72:73], v88 offset:36864
    v_mfma_f32_16x16x32_bf16 v[40:43], v[56:59], a[44:47], v[40:43]
    ds_read_b64_tr_b16 v[74:75], v88 offset:38912
    v_mfma_f32_16x16x32_bf16 v[12:15], v[60:63], a[36:39], v[12:15]
    ds_read_b64_tr_b16 v[76:77], v89 offset:36864
    v_mfma_f32_16x16x32_bf16 v[28:31], v[60:63], a[40:43], v[28:31]
    buffer_load_dwordx4 a[28:31], v92, s[4:7], s3 offen offset:256 sc1
    v_mfma_f32_16x16x32_bf16 v[44:47], v[60:63], a[44:47], v[44:47]
    ds_read_b64_tr_b16 v[78:79], v89 offset:38912
    v_mfma_f32_16x16x32_bf16 v[16:19], v[64:67], a[36:39], v[16:19]
    ds_read_b64_tr_b16 v[80:81], v90 offset:36864
    v_mfma_f32_16x16x32_bf16 v[32:35], v[64:67], a[40:43], v[32:35]
    ds_read_b64_tr_b16 v[82:83], v90 offset:38912
    v_mfma_f32_16x16x32_bf16 v[48:51], v[64:67], a[44:47], v[48:51]
    buffer_load_dwordx4 a[32:35], v92, s[4:7], s3 offen offset:512 sc1
    v_mfma_f32_16x16x32_bf16 v[20:23], v[68:71], a[36:39], v[20:23]
    ds_read_b64_tr_b16 v[84:85], v91 offset:36864
    v_mfma_f32_16x16x32_bf16 v[36:39], v[68:71], a[40:43], v[36:39]
    ds_read_b64_tr_b16 v[86:87], v91 offset:38912
    v_mfma_f32_16x16x32_bf16 v[52:55], v[68:71], a[44:47], v[52:55]
    s_waitcnt vmcnt(9) lgkmcnt(0)
    s_barrier
    v_add_u32 v88, 4294885376, v88
    v_add_u32 v89, 4294885376, v89
    v_add_u32 v90, 4294885376, v90
    v_add_u32 v91, 4294885376, v91
    v_mfma_f32_16x16x32_bf16 v[8:11], v[72:75], a[48:51], v[8:11]
    s_add_u32 s3, s61, 792576
    buffer_load_dwordx4 a[36:39], v131, s[4:7], s3 offen offset:0 sc1
    v_mfma_f32_16x16x32_bf16 v[24:27], v[72:75], a[52:55], v[24:27]
    ds_read_b64_tr_b16 v[56:57], v88 offset:0
    v_mfma_f32_16x16x32_bf16 v[40:43], v[72:75], a[56:59], v[40:43]
    ds_read_b64_tr_b16 v[58:59], v88 offset:2048
    v_mfma_f32_16x16x32_bf16 v[12:15], v[76:79], a[48:51], v[12:15]
    ds_read_b64_tr_b16 v[60:61], v89 offset:0
    v_mfma_f32_16x16x32_bf16 v[28:31], v[76:79], a[52:55], v[28:31]
    buffer_load_dwordx4 a[40:43], v92, s[4:7], s3 offen offset:256 sc1
    v_mfma_f32_16x16x32_bf16 v[44:47], v[76:79], a[56:59], v[44:47]
    ds_read_b64_tr_b16 v[62:63], v89 offset:2048
    v_mfma_f32_16x16x32_bf16 v[16:19], v[80:83], a[48:51], v[16:19]
    ds_read_b64_tr_b16 v[64:65], v90 offset:0
    v_mfma_f32_16x16x32_bf16 v[32:35], v[80:83], a[52:55], v[32:35]
    ds_read_b64_tr_b16 v[66:67], v90 offset:2048
    v_mfma_f32_16x16x32_bf16 v[48:51], v[80:83], a[56:59], v[48:51]
    buffer_load_dwordx4 a[44:47], v92, s[4:7], s3 offen offset:512 sc1
    v_mfma_f32_16x16x32_bf16 v[20:23], v[84:87], a[48:51], v[20:23]
    ds_read_b64_tr_b16 v[68:69], v91 offset:0
    v_mfma_f32_16x16x32_bf16 v[36:39], v[84:87], a[52:55], v[36:39]
    ds_read_b64_tr_b16 v[70:71], v91 offset:2048
    v_mfma_f32_16x16x32_bf16 v[52:55], v[84:87], a[56:59], v[52:55]
    s_waitcnt vmcnt(9) lgkmcnt(0)
    v_mfma_f32_16x16x32_bf16 v[8:11], v[56:59], a[0:3], v[8:11]
    s_add_u32 s3, s61, 811008
    buffer_load_dwordx4 a[48:51], v131, s[4:7], s3 offen offset:0 sc1
    v_mfma_f32_16x16x32_bf16 v[24:27], v[56:59], a[4:7], v[24:27]
    ds_read_b64_tr_b16 v[72:73], v88 offset:4096
    v_mfma_f32_16x16x32_bf16 v[40:43], v[56:59], a[8:11], v[40:43]
    ds_read_b64_tr_b16 v[74:75], v88 offset:6144
    v_mfma_f32_16x16x32_bf16 v[12:15], v[60:63], a[0:3], v[12:15]
    ds_read_b64_tr_b16 v[76:77], v89 offset:4096
    v_mfma_f32_16x16x32_bf16 v[28:31], v[60:63], a[4:7], v[28:31]
    buffer_load_dwordx4 a[52:55], v92, s[4:7], s3 offen offset:256 sc1
    v_mfma_f32_16x16x32_bf16 v[44:47], v[60:63], a[8:11], v[44:47]
    ds_read_b64_tr_b16 v[78:79], v89 offset:6144
    v_mfma_f32_16x16x32_bf16 v[16:19], v[64:67], a[0:3], v[16:19]
    ds_read_b64_tr_b16 v[80:81], v90 offset:4096
    v_mfma_f32_16x16x32_bf16 v[32:35], v[64:67], a[4:7], v[32:35]
    ds_read_b64_tr_b16 v[82:83], v90 offset:6144
    v_mfma_f32_16x16x32_bf16 v[48:51], v[64:67], a[8:11], v[48:51]
    buffer_load_dwordx4 a[56:59], v92, s[4:7], s3 offen offset:512 sc1
    v_mfma_f32_16x16x32_bf16 v[20:23], v[68:71], a[0:3], v[20:23]
    ds_read_b64_tr_b16 v[84:85], v91 offset:4096
    v_mfma_f32_16x16x32_bf16 v[36:39], v[68:71], a[4:7], v[36:39]
    ds_read_b64_tr_b16 v[86:87], v91 offset:6144
    v_mfma_f32_16x16x32_bf16 v[52:55], v[68:71], a[8:11], v[52:55]
    s_waitcnt vmcnt(9) lgkmcnt(0)
    v_mfma_f32_16x16x32_bf16 v[8:11], v[72:75], a[12:15], v[8:11]
    s_add_u32 s3, s61, 829440
    buffer_load_dwordx4 a[0:3], v131, s[4:7], s3 offen offset:0 sc1
    v_mfma_f32_16x16x32_bf16 v[24:27], v[72:75], a[16:19], v[24:27]
    ds_read_b64_tr_b16 v[56:57], v88 offset:8192
    v_mfma_f32_16x16x32_bf16 v[40:43], v[72:75], a[20:23], v[40:43]
    ds_read_b64_tr_b16 v[58:59], v88 offset:10240
    v_mfma_f32_16x16x32_bf16 v[12:15], v[76:79], a[12:15], v[12:15]
    ds_read_b64_tr_b16 v[60:61], v89 offset:8192
    v_mfma_f32_16x16x32_bf16 v[28:31], v[76:79], a[16:19], v[28:31]
    buffer_load_dwordx4 a[4:7], v92, s[4:7], s3 offen offset:256 sc1
    v_mfma_f32_16x16x32_bf16 v[44:47], v[76:79], a[20:23], v[44:47]
    ds_read_b64_tr_b16 v[62:63], v89 offset:10240
    v_mfma_f32_16x16x32_bf16 v[16:19], v[80:83], a[12:15], v[16:19]
    ds_read_b64_tr_b16 v[64:65], v90 offset:8192
    v_mfma_f32_16x16x32_bf16 v[32:35], v[80:83], a[16:19], v[32:35]
    ds_read_b64_tr_b16 v[66:67], v90 offset:10240
    v_mfma_f32_16x16x32_bf16 v[48:51], v[80:83], a[20:23], v[48:51]
    buffer_load_dwordx4 a[8:11], v92, s[4:7], s3 offen offset:512 sc1
    v_mfma_f32_16x16x32_bf16 v[20:23], v[84:87], a[12:15], v[20:23]
    ds_read_b64_tr_b16 v[68:69], v91 offset:8192
    v_mfma_f32_16x16x32_bf16 v[36:39], v[84:87], a[16:19], v[36:39]
    ds_read_b64_tr_b16 v[70:71], v91 offset:10240
    v_mfma_f32_16x16x32_bf16 v[52:55], v[84:87], a[20:23], v[52:55]
    s_waitcnt vmcnt(9) lgkmcnt(0)
    v_mfma_f32_16x16x32_bf16 v[8:11], v[56:59], a[24:27], v[8:11]
    s_add_u32 s3, s61, 847872
    buffer_load_dwordx4 a[12:15], v131, s[4:7], s3 offen offset:0 sc1
    v_mfma_f32_16x16x32_bf16 v[24:27], v[56:59], a[28:31], v[24:27]
    ds_read_b64_tr_b16 v[72:73], v88 offset:12288
    v_mfma_f32_16x16x32_bf16 v[40:43], v[56:59], a[32:35], v[40:43]
    ds_read_b64_tr_b16 v[74:75], v88 offset:14336
    v_mfma_f32_16x16x32_bf16 v[12:15], v[60:63], a[24:27], v[12:15]
    ds_read_b64_tr_b16 v[76:77], v89 offset:12288
    v_mfma_f32_16x16x32_bf16 v[28:31], v[60:63], a[28:31], v[28:31]
    buffer_load_dwordx4 a[16:19], v92, s[4:7], s3 offen offset:256 sc1
    v_mfma_f32_16x16x32_bf16 v[44:47], v[60:63], a[32:35], v[44:47]
    ds_read_b64_tr_b16 v[78:79], v89 offset:14336
    v_mfma_f32_16x16x32_bf16 v[16:19], v[64:67], a[24:27], v[16:19]
    ds_read_b64_tr_b16 v[80:81], v90 offset:12288
    v_mfma_f32_16x16x32_bf16 v[32:35], v[64:67], a[28:31], v[32:35]
    ds_read_b64_tr_b16 v[82:83], v90 offset:14336
    v_mfma_f32_16x16x32_bf16 v[48:51], v[64:67], a[32:35], v[48:51]
    buffer_load_dwordx4 a[20:23], v92, s[4:7], s3 offen offset:512 sc1
    v_mfma_f32_16x16x32_bf16 v[20:23], v[68:71], a[24:27], v[20:23]
    ds_read_b64_tr_b16 v[84:85], v91 offset:12288
    v_mfma_f32_16x16x32_bf16 v[36:39], v[68:71], a[28:31], v[36:39]
    ds_read_b64_tr_b16 v[86:87], v91 offset:14336
    v_mfma_f32_16x16x32_bf16 v[52:55], v[68:71], a[32:35], v[52:55]
    s_waitcnt vmcnt(9) lgkmcnt(0)
    v_mfma_f32_16x16x32_bf16 v[8:11], v[72:75], a[36:39], v[8:11]
    ds_read_b64_tr_b16 v[56:57], v88 offset:16384
    v_mfma_f32_16x16x32_bf16 v[24:27], v[72:75], a[40:43], v[24:27]
    ds_read_b64_tr_b16 v[58:59], v88 offset:18432
    v_mfma_f32_16x16x32_bf16 v[40:43], v[72:75], a[44:47], v[40:43]
    ds_read_b64_tr_b16 v[60:61], v89 offset:16384
    v_mfma_f32_16x16x32_bf16 v[12:15], v[76:79], a[36:39], v[12:15]
    ds_read_b64_tr_b16 v[62:63], v89 offset:18432
    v_mfma_f32_16x16x32_bf16 v[28:31], v[76:79], a[40:43], v[28:31]
    ds_read_b64_tr_b16 v[64:65], v90 offset:16384
    v_mfma_f32_16x16x32_bf16 v[44:47], v[76:79], a[44:47], v[44:47]
    ds_read_b64_tr_b16 v[66:67], v90 offset:18432
    v_mfma_f32_16x16x32_bf16 v[16:19], v[80:83], a[36:39], v[16:19]
    ds_read_b64_tr_b16 v[68:69], v91 offset:16384
    v_mfma_f32_16x16x32_bf16 v[32:35], v[80:83], a[40:43], v[32:35]
    ds_read_b64_tr_b16 v[70:71], v91 offset:18432
    v_mfma_f32_16x16x32_bf16 v[48:51], v[80:83], a[44:47], v[48:51]
    v_mfma_f32_16x16x32_bf16 v[20:23], v[84:87], a[36:39], v[20:23]
    v_mfma_f32_16x16x32_bf16 v[36:39], v[84:87], a[40:43], v[36:39]
    v_mfma_f32_16x16x32_bf16 v[52:55], v[84:87], a[44:47], v[52:55]
    s_waitcnt vmcnt(6) lgkmcnt(0)
    v_mfma_f32_16x16x32_bf16 v[16:19], v[64:67], a[48:51], v[16:19]
    ds_read_b64_tr_b16 v[80:81], v90 offset:20480
    ds_read_b64_tr_b16 v[82:83], v90 offset:22528
    v_mfma_f32_16x16x32_bf16 v[32:35], v[64:67], a[52:55], v[32:35]
    ds_read_b64_tr_b16 v[84:85], v91 offset:20480
    ds_read_b64_tr_b16 v[86:87], v91 offset:22528
    v_mfma_f32_16x16x32_bf16 v[48:51], v[64:67], a[56:59], v[48:51]
    v_mfma_f32_16x16x32_bf16 v[20:23], v[68:71], a[48:51], v[20:23]
    v_mfma_f32_16x16x32_bf16 v[36:39], v[68:71], a[52:55], v[36:39]
    v_mfma_f32_16x16x32_bf16 v[52:55], v[68:71], a[56:59], v[52:55]
    s_waitcnt vmcnt(3) lgkmcnt(0)
    v_mfma_f32_16x16x32_bf16 v[16:19], v[80:83], a[0:3], v[16:19]
    ds_read_b64_tr_b16 v[64:65], v90 offset:24576
    ds_read_b64_tr_b16 v[66:67], v90 offset:26624
    v_mfma_f32_16x16x32_bf16 v[32:35], v[80:83], a[4:7], v[32:35]
    ds_read_b64_tr_b16 v[68:69], v91 offset:24576
    ds_read_b64_tr_b16 v[70:71], v91 offset:26624
    v_mfma_f32_16x16x32_bf16 v[48:51], v[80:83], a[8:11], v[48:51]
    v_mfma_f32_16x16x32_bf16 v[20:23], v[84:87], a[0:3], v[20:23]
    v_mfma_f32_16x16x32_bf16 v[36:39], v[84:87], a[4:7], v[36:39]
    v_mfma_f32_16x16x32_bf16 v[52:55], v[84:87], a[8:11], v[52:55]
    s_waitcnt vmcnt(0) lgkmcnt(0)
    v_mfma_f32_16x16x32_bf16 v[16:19], v[64:67], a[12:15], v[16:19]
    ds_read_b64_tr_b16 v[72:73], v88 offset:20480
    ds_read_b64_tr_b16 v[74:75], v88 offset:22528
    v_mfma_f32_16x16x32_bf16 v[32:35], v[64:67], a[16:19], v[32:35]
    ds_read_b64_tr_b16 v[76:77], v89 offset:20480
    ds_read_b64_tr_b16 v[78:79], v89 offset:22528
    v_mfma_f32_16x16x32_bf16 v[48:51], v[64:67], a[20:23], v[48:51]
    ds_read_b64_tr_b16 v[80:81], v88 offset:24576
    ds_read_b64_tr_b16 v[82:83], v88 offset:26624
    v_mfma_f32_16x16x32_bf16 v[20:23], v[68:71], a[12:15], v[20:23]
    ds_read_b64_tr_b16 v[84:85], v89 offset:24576
    ds_read_b64_tr_b16 v[86:87], v89 offset:26624
    v_mfma_f32_16x16x32_bf16 v[36:39], v[68:71], a[16:19], v[36:39]
    v_mfma_f32_16x16x32_bf16 v[52:55], v[68:71], a[20:23], v[52:55]
    v_mfma_f32_16x16x32_bf16 v[8:11], v[56:59], a[48:51], v[8:11]
    v_mfma_f32_16x16x32_bf16 v[24:27], v[56:59], a[52:55], v[24:27]
    ds_write_b128 v93, v[16:19] offset:0
    v_mfma_f32_16x16x32_bf16 v[40:43], v[56:59], a[56:59], v[40:43]
    v_mfma_f32_16x16x32_bf16 v[12:15], v[60:63], a[48:51], v[12:15]
    ds_write_b128 v93, v[32:35] offset:2048
    v_mfma_f32_16x16x32_bf16 v[28:31], v[60:63], a[52:55], v[28:31]
    v_mfma_f32_16x16x32_bf16 v[44:47], v[60:63], a[56:59], v[44:47]
    ds_write_b128 v93, v[48:51] offset:4096
    s_waitcnt lgkmcnt(3)
    v_mfma_f32_16x16x32_bf16 v[8:11], v[72:75], a[0:3], v[8:11]
    v_mfma_f32_16x16x32_bf16 v[24:27], v[72:75], a[4:7], v[24:27]
    ds_write_b128 v93, v[20:23] offset:1024
    v_mfma_f32_16x16x32_bf16 v[40:43], v[72:75], a[8:11], v[40:43]
    v_mfma_f32_16x16x32_bf16 v[12:15], v[76:79], a[0:3], v[12:15]
    ds_write_b128 v93, v[36:39] offset:3072
    v_mfma_f32_16x16x32_bf16 v[28:31], v[76:79], a[4:7], v[28:31]
    v_mfma_f32_16x16x32_bf16 v[44:47], v[76:79], a[8:11], v[44:47]
    ds_write_b128 v93, v[52:55] offset:5120
    v_mfma_f32_16x16x32_bf16 v[8:11], v[80:83], a[12:15], v[8:11]
    v_mfma_f32_16x16x32_bf16 v[24:27], v[80:83], a[16:19], v[24:27]
    v_mfma_f32_16x16x32_bf16 v[40:43], v[80:83], a[20:23], v[40:43]
    v_mfma_f32_16x16x32_bf16 v[12:15], v[84:87], a[12:15], v[12:15]
    v_mfma_f32_16x16x32_bf16 v[28:31], v[84:87], a[16:19], v[28:31]
    v_mfma_f32_16x16x32_bf16 v[44:47], v[84:87], a[20:23], v[44:47]
    s_waitcnt lgkmcnt(0)
    s_barrier
    ds_read_b128 v[16:19], v94 offset:0
    ds_read_b128 v[20:23], v94 offset:1024
    ds_read_b128 v[32:35], v94 offset:2048
    ds_read_b128 v[36:39], v94 offset:3072
    ds_read_b128 v[48:51], v94 offset:4096
    ds_read_b128 v[52:55], v94 offset:5120
    s_waitcnt lgkmcnt(4)
    v_pk_add_f32 v[8:9], v[8:9], v[16:17]
    v_pk_add_f32 v[10:11], v[10:11], v[18:19]
    v_pk_add_f32 v[12:13], v[12:13], v[20:21]
    v_pk_add_f32 v[14:15], v[14:15], v[22:23]
    s_waitcnt lgkmcnt(2)
    v_pk_add_f32 v[24:25], v[24:25], v[32:33]
    v_pk_add_f32 v[26:27], v[26:27], v[34:35]
    v_pk_add_f32 v[28:29], v[28:29], v[36:37]
    v_pk_add_f32 v[30:31], v[30:31], v[38:39]
    s_waitcnt lgkmcnt(0)
    v_pk_add_f32 v[40:41], v[40:41], v[48:49]
    v_pk_add_f32 v[42:43], v[42:43], v[50:51]
    v_pk_add_f32 v[44:45], v[44:45], v[52:53]
    v_pk_add_f32 v[46:47], v[46:47], v[54:55]
    v_cvt_pk_bf16_f32 v8, v8, v9
    v_cvt_pk_bf16_f32 v9, v10, v11
    v_cvt_pk_bf16_f32 v10, v12, v13
    v_cvt_pk_bf16_f32 v11, v14, v15
    v_cvt_pk_bf16_f32 v24, v24, v25
    v_cvt_pk_bf16_f32 v25, v26, v27
    v_cvt_pk_bf16_f32 v26, v28, v29
    v_cvt_pk_bf16_f32 v27, v30, v31
    v_cvt_pk_bf16_f32 v40, v40, v41
    v_cvt_pk_bf16_f32 v41, v42, v43
    v_cvt_pk_bf16_f32 v42, v44, v45
    v_cvt_pk_bf16_f32 v43, v46, v47
    v_permlane16_swap_b32 v8, v10
    v_permlane16_swap_b32 v9, v11
    s_cmp_lg_u32 s55, 0
    s_cbranch_scc1 L_du_85
    s_mov_b32 s3, 0
    buffer_store_dwordx4 v[8:11], v96, s[8:11], s3 offen
L_du_85:
    v_permlane16_swap_b32 v24, v26
    v_permlane16_swap_b32 v25, v27
    s_mov_b32 s3, 20480
    buffer_store_dwordx4 v[24:27], v96, s[8:11], s3 offen
    v_permlane16_swap_b32 v40, v42
    v_permlane16_swap_b32 v41, v43
    s_mov_b32 s3, 40960
    buffer_store_dwordx4 v[40:43], v96, s[8:11], s3 offen
    s_endpgm
L_codeend:
.if L_codeend - sequential_preLN__sliding_local_dilated__mixer_s_mlp__prompt_kernel < 49408
.fill (49408 - (L_codeend - sequential_preLN__sliding_local_dilated__mixer_s_mlp__prompt_kernel)) / 4, 4, 0xbf800000
.endif
.section .rodata,"a"
.p2align 6
.amdhsa_kernel sequential_preLN__sliding_local_dilated__mixer_s_mlp__prompt_kernel
  .amdhsa_next_free_vgpr 256
  .amdhsa_next_free_sgpr 102
  .amdhsa_accum_offset 160
  .amdhsa_group_segment_fixed_size 0
  .amdhsa_kernarg_size 88
  .amdhsa_user_sgpr_count 2
  .amdhsa_user_sgpr_kernarg_segment_ptr 1
  .amdhsa_system_sgpr_workgroup_id_x 1
  .amdhsa_float_denorm_mode_32 3
.end_amdhsa_kernel
```
